```python
import torch

def _softmax(x, axis=-1):
    return torch.softmax(x, dim=axis)
def _gelu(x):
    return torch.nn.functional.gelu(x, approximate="tanh")
def _silu(x):
    return torch.nn.functional.silu(x)
def _sigmoid(x):
    return torch.sigmoid(x)
def _layernorm(x, axis=-1, eps=1e-5):
    m = x.mean(dim=axis, keepdim=True)
    v = x.var(dim=axis, keepdim=True, unbiased=False)
    return (x - m) / torch.sqrt(v + eps)
def _scatter_add(tgt, idx, src, axis=0):
    return tgt.clone().index_add_(axis, idx, src)
def _segment_sum(src, seg, n):
    out = torch.zeros((n,) + src.shape[1:], dtype=src.dtype)
    return out.index_add_(0, seg, src)
def _pad(x, pw):
    flat = tuple(v for pair in reversed(pw) for v in pair)
    return torch.nn.functional.pad(x, flat)

kernel_name = 'sequential_preLN__mha_block__dense_activation_silu__prompt'

def setup_inputs():

    _w = (lambda a: (lambda t: t.to(torch.bfloat16) if t.is_floating_point() else t)(torch.as_tensor(a)))
    def _A_setup():
        B, S, D, H = 1, 2048, 448, 16
        return {
            "x": _w((lambda *s: torch.randn(*s, dtype=torch.bfloat16) * 0.05)(B, S, D)),
            "wqkv": _w((lambda *s: torch.randn(*s, dtype=torch.bfloat16) * 0.05)(D, 3 * D)),
            "wo": _w((lambda *s: torch.randn(*s, dtype=torch.bfloat16) * 0.05)(D, D)),
        }
    _A_in = _A_setup()

    def _B_setup():
        B, S, D, F = 1, 2048, 448, 1792
        return {
            "x": _w((lambda *s: torch.randn(*s, dtype=torch.bfloat16) * 0.05)(B, S, D)),
            "w1": _w((lambda *s: torch.randn(*s, dtype=torch.bfloat16) * 0.8)(D, F) * (D ** -0.5)),
            "w2": _w((lambda *s: torch.randn(*s, dtype=torch.bfloat16) * 0.2)(F, D) * (F ** -0.5)),
        }
    _B_in = _B_setup()

    return {
        "A_x": _A_in["x"],
        "A_wqkv": _A_in["wqkv"],
        "A_wo": _A_in["wo"],
        "B_x": _B_in["x"],
        "B_w1": _B_in["w1"],
        "B_w2": _B_in["w2"],
    }

def reference(A_x, A_wqkv, A_wo, B_x, B_w1, B_w2):
    def _A_ref(x, wqkv, wo):
        B, S, D = x.shape
        H = 16
        Dh = D // H
        qkv = (lambda x, *d: x.permute(*d))((x @ wqkv).reshape(B, S, 3, H, Dh), 2, 0, 3, 1, 4)
        q, k, v = qkv[0], qkv[1], qkv[2]
        scores = torch.einsum("bhqd,bhkd->bhqk", q, k) * (Dh ** -0.5)
        p = _softmax(scores, axis=-1)
        o = torch.einsum("bhqk,bhkd->bhqd", p, v)
        return (lambda x, *d: x.permute(*d))(o, 0, 2, 1, 3).reshape(B, S, D) @ wo

    def _B_ref(x, w1, w2):
        h = torch.einsum("bsd,df->bsf", x, w1)
        h = _silu(h)
        out = torch.einsum("bsf,fd->bsd", h, w2)
        return out

    x = A_x
    h = x + _A_ref(_layernorm(x, axis=-1), A_wqkv, A_wo)
    h2 = h + _B_ref(_layernorm(h, axis=-1), B_w1, B_w2)
    return h2
```

```asm
; @launch grid=(256,1,1) block=(256,1,1) lds=162304
.amdgcn_target "amdgcn-amd-amdhsa--gfx950"
.text
.globl sequential_preLN__mha_block__dense_activation_silu__prompt_kernel
.p2align 8
.type sequential_preLN__mha_block__dense_activation_silu__prompt_kernel,@function
sequential_preLN__mha_block__dense_activation_silu__prompt_kernel:
  s_cmp_ge_u32 s2, 256
  s_cbranch_scc1 KF_END
  s_load_dwordx4 s[4:7], s[0:1], 0
  s_load_dwordx2 s[8:9], s[0:1], 16
  s_load_dwordx4 s[12:15], s[0:1], 32
  s_load_dwordx2 s[10:11], s[0:1], 64
  s_load_dwordx4 s[56:59], s[0:1], 48
  s_memrealtime s[30:31]
  s_getpc_b64 s[60:61]
K1_PC:
  v_and_b32 v1, 63, v0
  v_lshrrev_b32 v2, 6, v0
  v_and_b32 v3, 3, v0
  v_lshl_add_u32 v3, v3, 2, v2
  v_readfirstlane_b32 s16, v2
  s_and_b32 s17, s2, 7
  s_lshr_b32 s18, s2, 3
  v_lshl_add_u32 v3, v3, 5, s18
  v_lshlrev_b32 v3, 7, v3
  v_min_u32 v3, KF_CODE_END-K1_PC-4, v3
  global_load_dword v253, v3, s[60:61]
  s_lshr_b32 s19, s17, 1
  s_lshl_b32 s22, s19, 9
  s_lshl_b32 s19, s19, 2
  s_and_b32 s20, s18, 3
  s_add_u32 s19, s19, s20
  s_and_b32 s20, s17, 1
  s_mul_i32 s24, s20, 1280
  s_lshl_b32 s20, s20, 3
  s_lshr_b32 s21, s18, 2
  s_add_u32 s20, s20, s21
  s_lshl_b32 s21, s19, 2
  s_add_u32 s21, s21, s16
  v_lshrrev_b32 v6, 2, v1
  v_mul_u32_u24 v4, 896, v6
  v_and_b32 v7, 3, v1
  v_lshl_add_u32 v8, v7, 7, v4
  v_min_u32 v7, 2, v7
  v_lshl_add_u32 v9, v7, 7, v4
  v_mul_u32_u24 v5, 187, v1
  v_lshrrev_b32 v5, 11, v5
  v_mul_u32_u24 v7, 11, v5
  v_sub_u32 v7, v1, v7
  v_min_u32 v4, 3, v5
  v_mul_u32_u24 v4, 2688, v4
  v_lshl_add_u32 v4, v7, 7, v4
  v_min_u32 v5, 2, v5
  v_mul_u32_u24 v5, 2688, v5
  v_lshl_add_u32 v5, v7, 7, v5
  s_lshl_b32 s23, s18, 1
  s_add_u32 s23, s23, s16
  s_sub_u32 s23, s23, 1
  s_mul_i32 s54, s23, 10752
  s_add_u32 s54, s54, s24
  s_mul_i32 s55, s23, 8064
  s_add_u32 s55, s55, s24
  s_add_u32 s55, s55, 688128
  s_cmp_eq_u32 s16, 3
  s_cselect_b32 s54, 1073741824, s54
  s_cselect_b32 s55, 1073741824, s55
  s_lshl_b32 s23, s18, 4
  s_add_u32 s22, s22, s23
  s_mul_i32 s22, s22, 896
  s_add_u32 s23, s22, 512
  s_cmp_eq_u32 s16, 0
  s_cselect_b32 s54, s22, s54
  s_cselect_b32 s55, s23, s55
  s_cselect_b64 s[62:63], -1, 0
  v_cndmask_b32 v4, v4, v8, s[62:63]
  v_cndmask_b32 v5, v5, v9, s[62:63]
  v_mul_u32_u24 v2, 896, v6
  v_lshrrev_b32 v7, 4, v1
  v_xor_b32 v7, v7, v1
  v_and_b32 v7, 3, v7
  v_lshl_add_u32 v2, v7, 4, v2
  s_mul_i32 s48, s21, 28672
  s_add_u32 s49, s48, 14336
  s_mov_b32 s47, 0x00020000
  s_mov_b32 s46, 1204224
  s_cmp_eq_u32 s16, 0
  s_cselect_b32 s46, 1835008, s46
  s_waitcnt lgkmcnt(0)
  s_cselect_b32 s44, s4, s6
  s_cselect_b32 s45, s5, s7
  s_mov_b32 s28, s58
  s_mov_b32 s29, s59
  buffer_load_dword v253, v4, s[44:47], s54 offen
  s_or_b32 s30, s30, 1
  v_mov_b32 v254, s30
  v_mov_b32 v247, 0
  s_or_b32 s31, s2, s16
  s_cbranch_scc1 K1_NOTOK
  global_store_dword v247, v254, s[28:29] sc1
K1_NOTOK:
  s_mov_b32 s32, s4
  s_mov_b32 s33, s5
  s_mov_b32 s34, 1835008
  s_mov_b32 s35, 0x00020000
  buffer_load_dwordx4 v[16:19], v2, s[32:35], s48 offen offset:0
  buffer_load_dwordx4 v[20:23], v2, s[32:35], s49 offen offset:0
  buffer_load_dwordx4 v[24:27], v2, s[32:35], s48 offen offset:64
  buffer_load_dwordx4 v[28:31], v2, s[32:35], s49 offen offset:64
  buffer_load_dwordx4 v[32:35], v2, s[32:35], s48 offen offset:128
  buffer_load_dwordx4 v[36:39], v2, s[32:35], s49 offen offset:128
  buffer_load_dwordx4 v[40:43], v2, s[32:35], s48 offen offset:192
  buffer_load_dwordx4 v[44:47], v2, s[32:35], s49 offen offset:192
  s_mov_b32 s36, s6
  s_mov_b32 s37, s7
  s_mov_b32 s38, 1204224
  s_mov_b32 s39, 0x00020000
  v_add_u32 v9, 0, v1
  v_mul_u32_u24 v10, 171, v9
  v_lshrrev_b32 v10, 11, v10
  v_mul_u32_u24 v11, 12, v10
  v_sub_u32 v11, v9, v11
  v_mul_u32_u24 v10, 2688, v10
  v_lshl_add_u32 v244, v11, 4, v10
  v_add_u32 v9, 64, v1
  v_mul_u32_u24 v10, 171, v9
  v_lshrrev_b32 v10, 11, v10
  v_mul_u32_u24 v11, 12, v10
  v_sub_u32 v11, v9, v11
  v_mul_u32_u24 v10, 2688, v10
  v_lshl_add_u32 v245, v11, 4, v10
  v_subrev_u32 v245, 1024, v245
  v_add_u32 v9, 128, v1
  v_mul_u32_u24 v10, 171, v9
  v_lshrrev_b32 v10, 11, v10
  v_mul_u32_u24 v11, 12, v10
  v_sub_u32 v11, v9, v11
  v_mul_u32_u24 v10, 2688, v10
  v_lshl_add_u32 v246, v11, 4, v10
  v_subrev_u32 v246, 2048, v246
  s_mul_i32 s50, s16, 43008
  s_mul_i32 s51, s20, 168
  s_add_u32 s50, s50, s51
  s_mul_i32 s51, s16, 3072
  s_add_u32 m0, s51, 0
  s_nop 0
  buffer_load_dwordx4 v244, s[36:39], s50 offen offset:0 lds
  buffer_load_dwordx4 v245, s[36:39], s50 offen offset:1024 lds
  buffer_load_dwordx4 v246, s[36:39], s50 offen offset:2048 lds
  s_add_u32 s50, s50, 172032
  s_mov_b32 s40, s10
  s_mov_b32 s41, s11
  s_mov_b32 s42, 25165824
  s_mov_b32 s43, 0x00020000
  s_lshl_b32 s26, s2, 2
  s_add_u32 s26, s26, s16
  s_lshl_b32 s27, s26, 10
  s_add_u32 s27, s27, 10485760
  s_cmp_lt_u32 s26, 256
  s_cselect_b32 s27, s27, 1073741824
  s_lshl_b32 s26, s26, 12
  s_add_u32 s26, s26, 6291456
  v_lshlrev_b32 v14, 4, v1
  v_mov_b32 v236, -1
  v_mov_b32 v237, -1
  v_mov_b32 v238, -1
  v_mov_b32 v239, -1
  s_mul_i32 s22, s16, 14336
  s_add_u32 s22, s22, 86016
  v_lshl_add_u32 v3, v1, 4, s22
  v_bfe_u32 v10, v1, 2, 2
  v_lshrrev_b32 v11, 5, v1
  v_bfe_u32 v12, v1, 4, 1
  v_and_b32 v13, 3, v1
  v_lshlrev_b32 v13, 3, v13
  v_lshl_add_u32 v13, v12, 5, v13
  v_lshl_add_u32 v15, v11, 3, v10
  v_mul_u32_u24 v15, 192, v15
  v_add_u32 v15, v15, v13
  s_mov_b32 s52, 0
  s_mov_b32 s53, -1
  v_mov_b32 v252, 0x3f803f80
  v_mov_b32 v128, 0
  v_mov_b32 v129, 0
  v_mov_b32 v130, 0
  v_mov_b32 v131, 0
  v_mov_b32 v132, 0
  v_mov_b32 v133, 0
  v_mov_b32 v134, 0
  v_mov_b32 v135, 0
  v_mov_b32 v136, 0
  v_mov_b32 v137, 0
  v_mov_b32 v138, 0
  v_mov_b32 v139, 0
  v_mov_b32 v140, 0
  v_mov_b32 v141, 0
  v_mov_b32 v142, 0
  v_mov_b32 v143, 0
  v_mov_b32 v144, 0
  v_mov_b32 v145, 0
  v_mov_b32 v146, 0
  v_mov_b32 v147, 0
  v_mov_b32 v148, 0
  v_mov_b32 v149, 0
  v_mov_b32 v150, 0
  v_mov_b32 v151, 0
  v_mov_b32 v152, 0
  v_mov_b32 v153, 0
  v_mov_b32 v154, 0
  v_mov_b32 v155, 0
  v_mov_b32 v156, 0
  v_mov_b32 v157, 0
  v_mov_b32 v158, 0
  v_mov_b32 v159, 0
  v_mov_b32 v160, 0
  v_mov_b32 v161, 0
  v_mov_b32 v162, 0
  v_mov_b32 v163, 0
  v_mov_b32 v164, 0
  v_mov_b32 v165, 0
  v_mov_b32 v166, 0
  v_mov_b32 v167, 0
  v_mov_b32 v168, 0
  v_mov_b32 v169, 0
  v_mov_b32 v170, 0
  v_mov_b32 v171, 0
  v_mov_b32 v172, 0
  v_mov_b32 v173, 0
  v_mov_b32 v174, 0
  v_mov_b32 v175, 0
  v_mov_b32 v208, 0
  v_mov_b32 v209, 0
  v_mov_b32 v210, 0
  v_mov_b32 v211, 0
  s_mul_i32 s30, s20, 3
  s_add_u32 s31, s30, 0
  s_and_b32 s56, s31, 15
  s_lshl_b32 s56, s56, 6
  s_add_u32 s56, s56, s21
  s_lshr_b32 s71, s31, 4
  s_lshl_b32 s57, s56, 11
  s_lshl_b32 s56, s56, 12
  s_add_u32 s56, s56, 2097152
  s_cmp_eq_u32 s71, 2
  s_cselect_b32 s31, 2048, 0
  s_add_u32 s56, s56, s31
  s_cmp_eq_u32 s71, 0
  s_cselect_b32 s62, s57, s56
  s_cselect_b32 s65, 0x3e8b97f6, 1.0
  s_cselect_b32 s68, 0, 0x3f80
  s_add_u32 s31, s30, 1
  s_and_b32 s56, s31, 15
  s_lshl_b32 s56, s56, 6
  s_add_u32 s56, s56, s21
  s_lshr_b32 s72, s31, 4
  s_lshl_b32 s57, s56, 11
  s_lshl_b32 s56, s56, 12
  s_add_u32 s56, s56, 2097152
  s_cmp_eq_u32 s72, 2
  s_cselect_b32 s31, 2048, 0
  s_add_u32 s56, s56, s31
  s_cmp_eq_u32 s72, 0
  s_cselect_b32 s63, s57, s56
  s_cselect_b32 s66, 0x3e8b97f6, 1.0
  s_cselect_b32 s69, 0, 0x3f80
  s_add_u32 s31, s30, 2
  s_and_b32 s56, s31, 15
  s_lshl_b32 s56, s56, 6
  s_add_u32 s56, s56, s21
  s_lshr_b32 s73, s31, 4
  s_lshl_b32 s57, s56, 11
  s_lshl_b32 s56, s56, 12
  s_add_u32 s56, s56, 2097152
  s_cmp_eq_u32 s73, 2
  s_cselect_b32 s31, 2048, 0
  s_add_u32 s56, s56, s31
  s_cmp_eq_u32 s73, 0
  s_cselect_b32 s64, s57, s56
  s_cselect_b32 s67, 0x3e8b97f6, 1.0
  s_cselect_b32 s70, 0, 0x3f80
  buffer_load_dwordx4 v[48:51], v2, s[32:35], s48 offen offset:256
  buffer_load_dwordx4 v[52:55], v2, s[32:35], s49 offen offset:256
  buffer_load_dwordx4 v[56:59], v2, s[32:35], s48 offen offset:320
  buffer_load_dwordx4 v[60:63], v2, s[32:35], s49 offen offset:320
  buffer_load_dwordx4 v[64:67], v2, s[32:35], s48 offen offset:384
  buffer_load_dwordx4 v[68:71], v2, s[32:35], s49 offen offset:384
  s_waitcnt vmcnt(16)
  ds_write_b128 v3, v[16:19] offset:0
  s_add_u32 m0, s51, 12288
  s_nop 0
  buffer_load_dwordx4 v244, s[36:39], s50 offen offset:0 lds
  v_dot2c_f32_bf16 v208, v16, v252
  v_dot2c_f32_bf16 v209, v16, v16
  v_dot2c_f32_bf16 v208, v17, v252
  v_dot2c_f32_bf16 v209, v17, v17
  v_dot2c_f32_bf16 v208, v18, v252
  v_dot2c_f32_bf16 v209, v18, v18
  v_dot2c_f32_bf16 v208, v19, v252
  v_dot2c_f32_bf16 v209, v19, v19
  s_waitcnt vmcnt(16)
  ds_write_b128 v3, v[20:23] offset:1024
  buffer_load_dwordx4 v245, s[36:39], s50 offen offset:1024 lds
  v_dot2c_f32_bf16 v210, v20, v252
  v_dot2c_f32_bf16 v211, v20, v20
  v_dot2c_f32_bf16 v210, v21, v252
  v_dot2c_f32_bf16 v211, v21, v21
  v_dot2c_f32_bf16 v210, v22, v252
  v_dot2c_f32_bf16 v211, v22, v22
  v_dot2c_f32_bf16 v210, v23, v252
  v_dot2c_f32_bf16 v211, v23, v23
  s_waitcnt vmcnt(16)
  ds_write_b128 v3, v[24:27] offset:2048
  buffer_load_dwordx4 v246, s[36:39], s50 offen offset:2048 lds
  s_add_u32 s50, s50, 172032
  v_dot2c_f32_bf16 v208, v24, v252
  v_dot2c_f32_bf16 v209, v24, v24
  v_dot2c_f32_bf16 v208, v25, v252
  v_dot2c_f32_bf16 v209, v25, v25
  v_dot2c_f32_bf16 v208, v26, v252
  v_dot2c_f32_bf16 v209, v26, v26
  v_dot2c_f32_bf16 v208, v27, v252
  v_dot2c_f32_bf16 v209, v27, v27
  s_waitcnt vmcnt(16)
  ds_write_b128 v3, v[28:31] offset:3072
  s_add_u32 m0, s51, 24576
  s_nop 0
  buffer_load_dwordx4 v244, s[36:39], s50 offen offset:0 lds
  v_dot2c_f32_bf16 v210, v28, v252
  v_dot2c_f32_bf16 v211, v28, v28
  v_dot2c_f32_bf16 v210, v29, v252
  v_dot2c_f32_bf16 v211, v29, v29
  v_dot2c_f32_bf16 v210, v30, v252
  v_dot2c_f32_bf16 v211, v30, v30
  v_dot2c_f32_bf16 v210, v31, v252
  v_dot2c_f32_bf16 v211, v31, v31
  s_waitcnt vmcnt(16)
  ds_write_b128 v3, v[32:35] offset:4096
  buffer_load_dwordx4 v245, s[36:39], s50 offen offset:1024 lds
  v_dot2c_f32_bf16 v208, v32, v252
  v_dot2c_f32_bf16 v209, v32, v32
  v_dot2c_f32_bf16 v208, v33, v252
  v_dot2c_f32_bf16 v209, v33, v33
  v_dot2c_f32_bf16 v208, v34, v252
  v_dot2c_f32_bf16 v209, v34, v34
  v_dot2c_f32_bf16 v208, v35, v252
  v_dot2c_f32_bf16 v209, v35, v35
  s_waitcnt vmcnt(16)
  ds_write_b128 v3, v[36:39] offset:5120
  buffer_load_dwordx4 v246, s[36:39], s50 offen offset:2048 lds
  s_add_u32 s50, s50, 172032
  v_dot2c_f32_bf16 v210, v36, v252
  v_dot2c_f32_bf16 v211, v36, v36
  v_dot2c_f32_bf16 v210, v37, v252
  v_dot2c_f32_bf16 v211, v37, v37
  v_dot2c_f32_bf16 v210, v38, v252
  v_dot2c_f32_bf16 v211, v38, v38
  v_dot2c_f32_bf16 v210, v39, v252
  v_dot2c_f32_bf16 v211, v39, v39
  s_waitcnt vmcnt(16)
  ds_write_b128 v3, v[40:43] offset:6144
  s_add_u32 m0, s51, 36864
  s_nop 0
  buffer_load_dwordx4 v244, s[36:39], s50 offen offset:0 lds
  v_dot2c_f32_bf16 v208, v40, v252
  v_dot2c_f32_bf16 v209, v40, v40
  v_dot2c_f32_bf16 v208, v41, v252
  v_dot2c_f32_bf16 v209, v41, v41
  v_dot2c_f32_bf16 v208, v42, v252
  v_dot2c_f32_bf16 v209, v42, v42
  v_dot2c_f32_bf16 v208, v43, v252
  v_dot2c_f32_bf16 v209, v43, v43
  s_waitcnt vmcnt(16)
  ds_write_b128 v3, v[44:47] offset:7168
  buffer_load_dwordx4 v245, s[36:39], s50 offen offset:1024 lds
  v_dot2c_f32_bf16 v210, v44, v252
  v_dot2c_f32_bf16 v211, v44, v44
  v_dot2c_f32_bf16 v210, v45, v252
  v_dot2c_f32_bf16 v211, v45, v45
  v_dot2c_f32_bf16 v210, v46, v252
  v_dot2c_f32_bf16 v211, v46, v46
  v_dot2c_f32_bf16 v210, v47, v252
  v_dot2c_f32_bf16 v211, v47, v47
  s_waitcnt vmcnt(13)
  ds_write_b128 v3, v[48:51] offset:8192
  buffer_load_dwordx4 v246, s[36:39], s50 offen offset:2048 lds
  s_add_u32 s50, s50, 172032
  v_dot2c_f32_bf16 v208, v48, v252
  v_dot2c_f32_bf16 v209, v48, v48
  v_dot2c_f32_bf16 v208, v49, v252
  v_dot2c_f32_bf16 v209, v49, v49
  v_dot2c_f32_bf16 v208, v50, v252
  v_dot2c_f32_bf16 v209, v50, v50
  v_dot2c_f32_bf16 v208, v51, v252
  v_dot2c_f32_bf16 v209, v51, v51
  s_waitcnt vmcnt(13)
  ds_write_b128 v3, v[52:55] offset:9216
  buffer_load_dword v253, v5, s[44:47], s55 offen
  v_dot2c_f32_bf16 v210, v52, v252
  v_dot2c_f32_bf16 v211, v52, v52
  v_dot2c_f32_bf16 v210, v53, v252
  v_dot2c_f32_bf16 v211, v53, v53
  v_dot2c_f32_bf16 v210, v54, v252
  v_dot2c_f32_bf16 v211, v54, v54
  v_dot2c_f32_bf16 v210, v55, v252
  v_dot2c_f32_bf16 v211, v55, v55
  s_waitcnt vmcnt(13)
  ds_write_b128 v3, v[56:59] offset:10240
  v_dot2c_f32_bf16 v208, v56, v252
  v_dot2c_f32_bf16 v209, v56, v56
  v_dot2c_f32_bf16 v208, v57, v252
  v_dot2c_f32_bf16 v209, v57, v57
  v_dot2c_f32_bf16 v208, v58, v252
  v_dot2c_f32_bf16 v209, v58, v58
  v_dot2c_f32_bf16 v208, v59, v252
  v_dot2c_f32_bf16 v209, v59, v59
  s_waitcnt vmcnt(12)
  ds_write_b128 v3, v[60:63] offset:11264
  v_dot2c_f32_bf16 v210, v60, v252
  v_dot2c_f32_bf16 v211, v60, v60
  v_dot2c_f32_bf16 v210, v61, v252
  v_dot2c_f32_bf16 v211, v61, v61
  v_dot2c_f32_bf16 v210, v62, v252
  v_dot2c_f32_bf16 v211, v62, v62
  v_dot2c_f32_bf16 v210, v63, v252
  v_dot2c_f32_bf16 v211, v63, v63
  s_waitcnt vmcnt(11)
  ds_write_b128 v3, v[64:67] offset:12288
  v_dot2c_f32_bf16 v208, v64, v252
  v_dot2c_f32_bf16 v209, v64, v64
  v_dot2c_f32_bf16 v208, v65, v252
  v_dot2c_f32_bf16 v209, v65, v65
  v_dot2c_f32_bf16 v208, v66, v252
  v_dot2c_f32_bf16 v209, v66, v66
  v_dot2c_f32_bf16 v208, v67, v252
  v_dot2c_f32_bf16 v209, v67, v67
  s_waitcnt vmcnt(10)
  ds_write_b128 v3, v[68:71] offset:13312
  v_dot2c_f32_bf16 v210, v68, v252
  v_dot2c_f32_bf16 v211, v68, v68
  v_dot2c_f32_bf16 v210, v69, v252
  v_dot2c_f32_bf16 v211, v69, v69
  v_dot2c_f32_bf16 v210, v70, v252
  v_dot2c_f32_bf16 v211, v70, v70
  v_dot2c_f32_bf16 v210, v71, v252
  v_dot2c_f32_bf16 v211, v71, v71
  s_lshl_b32 s29, s16, 8
  s_add_u32 s29, s29, s2
  s_lshl_b32 s25, s29, 2
  s_add_u32 s25, s25, 10747904
  s_mov_b32 s57, 1073741824
  s_mov_b64 s[30:31], 0
  s_mov_b64 s[74:75], 0
  s_mov_b32 s23, 0
  s_mov_b32 s46, 1605632
  s_cmp_lt_u32 s29, 448
  s_cbranch_scc0 K1_U2
  s_mov_b32 s44, s12
  s_mov_b32 s45, s13
  s_mov_b32 s24, 3584
  s_lshr_b32 s58, s29, 3
  s_bfe_u32 s59, s29, 0x20001
  s_mul_i32 s54, s59, 401408
  s_lshl_b32 s55, s58, 6
  s_add_u32 s54, s54, s55
  s_mul_i32 s55, s58, 28672
  s_mul_i32 s59, s59, 7168
  s_add_u32 s55, s55, s59
  s_add_u32 s55, s55, 12582912
  s_lshl_b32 s57, s58, 10
  s_and_b32 s59, s29, 7
  s_lshl_b32 s59, s59, 2
  s_add_u32 s57, s57, s59
  s_add_u32 s57, s57, 14417920
  s_mov_b32 s23, 172032
  s_mov_b32 s56, s55
  s_bitcmp1_b32 s29, 0
  s_cbranch_scc0 K1_UG
  s_add_u32 s54, s54, 200704
  s_add_u32 s55, s55, 4096
  s_mov_b32 s56, 1073741824
  s_mov_b64 s[74:75], -1
  s_branch K1_UG
K1_U2:
  s_sub_u32 s29, s29, 448
  s_cmp_lt_u32 s29, 448
  s_cbranch_scc1 K1_U2B
  s_mov_b32 s44, s8
  s_mov_b32 s45, s9
  s_mov_b32 s46, 401408
  s_mov_b32 s24, 64
  s_sub_u32 s54, s29, 448
  s_lshl_b32 s54, s54, 12
  s_mov_b32 s55, 1073741824
  s_mov_b32 s56, 1073741824
  s_branch K1_UG
K1_U2B:
  s_mov_b32 s44, s14
  s_mov_b32 s45, s15
  s_mov_b32 s24, 896
  s_mul_i32 s58, s29, 2341
  s_lshr_b32 s58, s58, 16
  s_mul_i32 s59, s58, 28
  s_sub_u32 s59, s29, s59
  s_lshl_b32 s55, s29, 12
  s_add_u32 s55, s55, 14680064
  s_mul_i32 s54, s59, 57344
  s_lshr_b32 s59, s58, 1
  s_mul_i32 s59, s59, 112
  s_add_u32 s54, s54, s59
  s_mov_b32 s56, s55
  s_bitcmp1_b32 s58, 0
  s_cbranch_scc0 K1_UG
  s_add_u32 s54, s54, 64
  s_mov_b32 s30, 0x88888888
  s_mov_b32 s31, 0x88888888
K1_UG:
  v_and_b32 v228, 3, v1
  v_lshlrev_b32 v228, 4, v228
  v_mad_u32_u24 v228, v6, s24, v228
  v_mov_b32 v230, 1073741824
  v_cndmask_b32 v228, v228, v230, s[30:31]
  v_mul_lo_u32 v229, v11, s23
  v_add_u32 v229, v229, v228
  v_cndmask_b32 v229, v229, v230, s[74:75]
  s_lshl_b32 s24, s24, 4
  s_lshl_b32 s23, s16, 12
  s_add_u32 s23, s23, 145920
  v_bfe_u32 v230, v1, 2, 2
  v_lshl_add_u32 v230, v11, 2, v230
  v_lshl_add_u32 v230, v230, 6, v13
  v_add_u32 v230, s23, v230
  v_and_b32 v231, 15, v1
  v_lshlrev_b32 v231, 5, v231
  v_and_b32 v5, 31, v1
  v_lshrrev_b32 v10, 4, v5
  v_lshlrev_b32 v10, 10, v10
  v_and_b32 v12, 15, v1
  v_lshl_add_u32 v10, v12, 6, v10
  v_add_u32 v10, s22, v10
  v_bfe_u32 v12, v1, 2, 2
  v_xor_b32 v4, v11, v12
  v_lshl_add_u32 v4, v4, 4, v10
  v_xor_b32 v12, 32, v4
  v_lshlrev_b32 v5, 4, v1
  v_lshrrev_b32 v10, 4, v1
  v_xor_b32 v10, v10, v1
  v_and_b32 v10, 1, v10
  v_cmp_eq_u32 vcc, 0, v10
  s_nop 1
  v_cndmask_b32 v240, 0, v252, vcc
  v_mov_b32 v241, v240
  v_mov_b32 v242, v240
  v_mov_b32 v243, v240
  s_waitcnt vmcnt(1)
  s_waitcnt lgkmcnt(0)
  s_barrier
  ds_read_b128 v[200:203], v4 offset:0
  ds_read_b64_tr_b16 v[176:177], v15 offset:0
  ds_read_b64_tr_b16 v[178:179], v15 offset:768
  ds_read_b64_tr_b16 v[180:181], v15 offset:56
  ds_read_b64_tr_b16 v[182:183], v15 offset:824
  ds_read_b64_tr_b16 v[184:185], v15 offset:112
  ds_read_b64_tr_b16 v[186:187], v15 offset:880
  s_waitcnt lgkmcnt(4)
  v_mfma_f32_32x32x16_bf16 v[128:143], v[176:179], v[200:203], v[128:143]
  ds_read_b128 v[204:207], v12 offset:0
  ds_read_b64_tr_b16 v[188:189], v15 offset:3072
  ds_read_b64_tr_b16 v[190:191], v15 offset:3840
  s_waitcnt lgkmcnt(5)
  v_mfma_f32_32x32x16_bf16 v[144:159], v[180:183], v[200:203], v[144:159]
  ds_read_b64_tr_b16 v[192:193], v15 offset:3128
  ds_read_b64_tr_b16 v[194:195], v15 offset:3896
  buffer_load_dwordx4 v[72:75], v2, s[32:35], s48 offen offset:448
  s_waitcnt lgkmcnt(5)
  v_mfma_f32_32x32x16_bf16 v[160:175], v[184:187], v[200:203], v[160:175]
  ds_read_b64_tr_b16 v[196:197], v15 offset:3184
  ds_read_b64_tr_b16 v[198:199], v15 offset:3952
  buffer_load_dwordx4 v[76:79], v2, s[32:35], s49 offen offset:448
  s_waitcnt lgkmcnt(4)
  v_mfma_f32_32x32x16_bf16 v[128:143], v[188:191], v[204:207], v[128:143]
  ds_read_b128 v[200:203], v4 offset:2048
  ds_read_b64_tr_b16 v[176:177], v15 offset:6144
  ds_read_b64_tr_b16 v[178:179], v15 offset:6912
  s_waitcnt lgkmcnt(5)
  v_mfma_f32_32x32x16_bf16 v[144:159], v[192:195], v[204:207], v[144:159]
  ds_read_b64_tr_b16 v[180:181], v15 offset:6200
  ds_read_b64_tr_b16 v[182:183], v15 offset:6968
  buffer_load_dwordx4 v[80:83], v2, s[32:35], s48 offen offset:512
  s_waitcnt lgkmcnt(5)
  v_mfma_f32_32x32x16_bf16 v[160:175], v[196:199], v[204:207], v[160:175]
  ds_read_b64_tr_b16 v[184:185], v15 offset:6256
  ds_read_b64_tr_b16 v[186:187], v15 offset:7024
  buffer_load_dwordx4 v[84:87], v2, s[32:35], s49 offen offset:512
  s_waitcnt lgkmcnt(4)
  v_mfma_f32_32x32x16_bf16 v[128:143], v[176:179], v[200:203], v[128:143]
  ds_read_b128 v[204:207], v12 offset:2048
  ds_read_b64_tr_b16 v[188:189], v15 offset:9216
  ds_read_b64_tr_b16 v[190:191], v15 offset:9984
  s_waitcnt lgkmcnt(5)
  v_mfma_f32_32x32x16_bf16 v[144:159], v[180:183], v[200:203], v[144:159]
  ds_read_b64_tr_b16 v[192:193], v15 offset:9272
  ds_read_b64_tr_b16 v[194:195], v15 offset:10040
  buffer_load_dwordx4 v[88:91], v2, s[32:35], s48 offen offset:576
  s_waitcnt lgkmcnt(5)
  v_mfma_f32_32x32x16_bf16 v[160:175], v[184:187], v[200:203], v[160:175]
  ds_read_b64_tr_b16 v[196:197], v15 offset:9328
  ds_read_b64_tr_b16 v[198:199], v15 offset:10096
  buffer_load_dwordx4 v[92:95], v2, s[32:35], s49 offen offset:576
  s_waitcnt lgkmcnt(4)
  v_mfma_f32_32x32x16_bf16 v[128:143], v[188:191], v[204:207], v[128:143]
  ds_read_b128 v[200:203], v4 offset:4096
  ds_read_b64_tr_b16 v[176:177], v15 offset:12288
  ds_read_b64_tr_b16 v[178:179], v15 offset:13056
  s_waitcnt lgkmcnt(5)
  v_mfma_f32_32x32x16_bf16 v[144:159], v[192:195], v[204:207], v[144:159]
  ds_read_b64_tr_b16 v[180:181], v15 offset:12344
  ds_read_b64_tr_b16 v[182:183], v15 offset:13112
  buffer_load_dwordx4 v[96:99], v2, s[32:35], s48 offen offset:640
  s_waitcnt lgkmcnt(5)
  v_mfma_f32_32x32x16_bf16 v[160:175], v[196:199], v[204:207], v[160:175]
  ds_read_b64_tr_b16 v[184:185], v15 offset:12400
  ds_read_b64_tr_b16 v[186:187], v15 offset:13168
  buffer_load_dwordx4 v[100:103], v2, s[32:35], s49 offen offset:640
  s_waitcnt lgkmcnt(4)
  v_mfma_f32_32x32x16_bf16 v[128:143], v[176:179], v[200:203], v[128:143]
  ds_read_b128 v[204:207], v12 offset:4096
  ds_read_b64_tr_b16 v[188:189], v15 offset:15360
  ds_read_b64_tr_b16 v[190:191], v15 offset:16128
  s_waitcnt lgkmcnt(5)
  v_mfma_f32_32x32x16_bf16 v[144:159], v[180:183], v[200:203], v[144:159]
  ds_read_b64_tr_b16 v[192:193], v15 offset:15416
  ds_read_b64_tr_b16 v[194:195], v15 offset:16184
  buffer_load_dwordx4 v[104:107], v2, s[32:35], s48 offen offset:704
  s_waitcnt lgkmcnt(5)
  v_mfma_f32_32x32x16_bf16 v[160:175], v[184:187], v[200:203], v[160:175]
  ds_read_b64_tr_b16 v[196:197], v15 offset:15472
  ds_read_b64_tr_b16 v[198:199], v15 offset:16240
  buffer_load_dwordx4 v[108:111], v2, s[32:35], s49 offen offset:704
  s_waitcnt lgkmcnt(4)
  v_mfma_f32_32x32x16_bf16 v[128:143], v[188:191], v[204:207], v[128:143]
  ds_read_b128 v[200:203], v4 offset:6144
  ds_read_b64_tr_b16 v[176:177], v15 offset:18432
  ds_read_b64_tr_b16 v[178:179], v15 offset:19200
  s_waitcnt lgkmcnt(5)
  v_mfma_f32_32x32x16_bf16 v[144:159], v[192:195], v[204:207], v[144:159]
  ds_read_b64_tr_b16 v[180:181], v15 offset:18488
  ds_read_b64_tr_b16 v[182:183], v15 offset:19256
  buffer_load_dwordx4 v[112:115], v2, s[32:35], s48 offen offset:768
  s_waitcnt lgkmcnt(5)
  v_mfma_f32_32x32x16_bf16 v[160:175], v[196:199], v[204:207], v[160:175]
  ds_read_b64_tr_b16 v[184:185], v15 offset:18544
  ds_read_b64_tr_b16 v[186:187], v15 offset:19312
  buffer_load_dwordx4 v[116:119], v2, s[32:35], s49 offen offset:768
  s_waitcnt lgkmcnt(4)
  v_mfma_f32_32x32x16_bf16 v[128:143], v[176:179], v[200:203], v[128:143]
  ds_read_b128 v[204:207], v12 offset:6144
  ds_read_b64_tr_b16 v[188:189], v15 offset:21504
  ds_read_b64_tr_b16 v[190:191], v15 offset:22272
  s_waitcnt lgkmcnt(5)
  v_mfma_f32_32x32x16_bf16 v[144:159], v[180:183], v[200:203], v[144:159]
  ds_read_b64_tr_b16 v[192:193], v15 offset:21560
  ds_read_b64_tr_b16 v[194:195], v15 offset:22328
  buffer_load_dwordx4 v[120:123], v2, s[32:35], s48 offen offset:832
  s_waitcnt lgkmcnt(5)
  v_mfma_f32_32x32x16_bf16 v[160:175], v[184:187], v[200:203], v[160:175]
  ds_read_b64_tr_b16 v[196:197], v15 offset:21616
  ds_read_b64_tr_b16 v[198:199], v15 offset:22384
  buffer_load_dwordx4 v[124:127], v2, s[32:35], s49 offen offset:832
  s_waitcnt lgkmcnt(4)
  v_mfma_f32_32x32x16_bf16 v[128:143], v[188:191], v[204:207], v[128:143]
  ds_read_b128 v[200:203], v4 offset:8192
  ds_read_b64_tr_b16 v[176:177], v15 offset:24576
  ds_read_b64_tr_b16 v[178:179], v15 offset:25344
  s_waitcnt lgkmcnt(5)
  v_mfma_f32_32x32x16_bf16 v[144:159], v[192:195], v[204:207], v[144:159]
  ds_read_b64_tr_b16 v[180:181], v15 offset:24632
  ds_read_b64_tr_b16 v[182:183], v15 offset:25400
  s_add_u32 m0, s51, 49152
  s_nop 0
  buffer_load_dwordx4 v244, s[36:39], s50 offen offset:0 lds
  s_waitcnt lgkmcnt(5)
  v_mfma_f32_32x32x16_bf16 v[160:175], v[196:199], v[204:207], v[160:175]
  ds_read_b64_tr_b16 v[184:185], v15 offset:24688
  ds_read_b64_tr_b16 v[186:187], v15 offset:25456
  buffer_load_dwordx4 v245, s[36:39], s50 offen offset:1024 lds
  s_waitcnt lgkmcnt(4)
  v_mfma_f32_32x32x16_bf16 v[128:143], v[176:179], v[200:203], v[128:143]
  ds_read_b128 v[204:207], v12 offset:8192
  ds_read_b64_tr_b16 v[188:189], v15 offset:27648
  ds_read_b64_tr_b16 v[190:191], v15 offset:28416
  s_waitcnt lgkmcnt(5)
  v_mfma_f32_32x32x16_bf16 v[144:159], v[180:183], v[200:203], v[144:159]
  ds_read_b64_tr_b16 v[192:193], v15 offset:27704
  ds_read_b64_tr_b16 v[194:195], v15 offset:28472
  buffer_load_dwordx4 v246, s[36:39], s50 offen offset:2048 lds
  s_add_u32 s50, s50, 172032
  s_waitcnt lgkmcnt(5)
  v_mfma_f32_32x32x16_bf16 v[160:175], v[184:187], v[200:203], v[160:175]
  ds_read_b64_tr_b16 v[196:197], v15 offset:27760
  ds_read_b64_tr_b16 v[198:199], v15 offset:28528
  s_add_u32 m0, s51, 61440
  s_nop 0
  buffer_load_dwordx4 v244, s[36:39], s50 offen offset:0 lds
  s_waitcnt lgkmcnt(4)
  v_mfma_f32_32x32x16_bf16 v[128:143], v[188:191], v[204:207], v[128:143]
  ds_read_b128 v[200:203], v4 offset:10240
  ds_read_b64_tr_b16 v[176:177], v15 offset:30720
  ds_read_b64_tr_b16 v[178:179], v15 offset:31488
  s_waitcnt lgkmcnt(5)
  v_mfma_f32_32x32x16_bf16 v[144:159], v[192:195], v[204:207], v[144:159]
  ds_read_b64_tr_b16 v[180:181], v15 offset:30776
  ds_read_b64_tr_b16 v[182:183], v15 offset:31544
  buffer_load_dwordx4 v245, s[36:39], s50 offen offset:1024 lds
  s_waitcnt lgkmcnt(5)
  v_mfma_f32_32x32x16_bf16 v[160:175], v[196:199], v[204:207], v[160:175]
  ds_read_b64_tr_b16 v[184:185], v15 offset:30832
  ds_read_b64_tr_b16 v[186:187], v15 offset:31600
  buffer_load_dwordx4 v246, s[36:39], s50 offen offset:2048 lds
  s_add_u32 s50, s50, 172032
  s_waitcnt lgkmcnt(4)
  v_mfma_f32_32x32x16_bf16 v[128:143], v[176:179], v[200:203], v[128:143]
  ds_read_b128 v[204:207], v12 offset:10240
  ds_read_b64_tr_b16 v[188:189], v15 offset:33792
  ds_read_b64_tr_b16 v[190:191], v15 offset:34560
  s_waitcnt lgkmcnt(5)
  v_mfma_f32_32x32x16_bf16 v[144:159], v[180:183], v[200:203], v[144:159]
  ds_read_b64_tr_b16 v[192:193], v15 offset:33848
  ds_read_b64_tr_b16 v[194:195], v15 offset:34616
  s_add_u32 m0, s51, 73728
  s_nop 0
  buffer_load_dwordx4 v244, s[36:39], s50 offen offset:0 lds
  s_waitcnt lgkmcnt(5)
  v_mfma_f32_32x32x16_bf16 v[160:175], v[184:187], v[200:203], v[160:175]
  ds_read_b64_tr_b16 v[196:197], v15 offset:33904
  ds_read_b64_tr_b16 v[198:199], v15 offset:34672
  buffer_load_dwordx4 v245, s[36:39], s50 offen offset:1024 lds
  s_waitcnt lgkmcnt(4)
  v_mfma_f32_32x32x16_bf16 v[128:143], v[188:191], v[204:207], v[128:143]
  ds_read_b128 v[200:203], v4 offset:12288
  ds_read_b64_tr_b16 v[176:177], v15 offset:36864
  ds_read_b64_tr_b16 v[178:179], v15 offset:37632
  s_waitcnt lgkmcnt(5)
  v_mfma_f32_32x32x16_bf16 v[144:159], v[192:195], v[204:207], v[144:159]
  ds_read_b64_tr_b16 v[180:181], v15 offset:36920
  ds_read_b64_tr_b16 v[182:183], v15 offset:37688
  buffer_load_dwordx4 v246, s[36:39], s50 offen offset:2048 lds
  s_add_u32 s50, s50, 172032
  s_waitcnt lgkmcnt(5)
  v_mfma_f32_32x32x16_bf16 v[160:175], v[196:199], v[204:207], v[160:175]
  ds_read_b64_tr_b16 v[184:185], v15 offset:36976
  ds_read_b64_tr_b16 v[186:187], v15 offset:37744
  buffer_store_dwordx4 v[236:239], v14, s[40:43], s26 offen offset:0 sc1
  s_waitcnt lgkmcnt(4)
  v_mfma_f32_32x32x16_bf16 v[128:143], v[176:179], v[200:203], v[128:143]
  ds_read_b128 v[204:207], v12 offset:12288
  ds_read_b64_tr_b16 v[188:189], v15 offset:39936
  ds_read_b64_tr_b16 v[190:191], v15 offset:40704
  s_waitcnt lgkmcnt(5)
  v_mfma_f32_32x32x16_bf16 v[144:159], v[180:183], v[200:203], v[144:159]
  ds_read_b64_tr_b16 v[192:193], v15 offset:39992
  ds_read_b64_tr_b16 v[194:195], v15 offset:40760
  buffer_store_dwordx4 v[236:239], v14, s[40:43], s26 offen offset:1024 sc1
  s_waitcnt lgkmcnt(5)
  v_mfma_f32_32x32x16_bf16 v[160:175], v[184:187], v[200:203], v[160:175]
  ds_read_b64_tr_b16 v[196:197], v15 offset:40048
  ds_read_b64_tr_b16 v[198:199], v15 offset:40816
  buffer_store_dwordx4 v[236:239], v14, s[40:43], s26 offen offset:2048 sc1
  s_waitcnt lgkmcnt(4)
  v_mfma_f32_32x32x16_bf16 v[128:143], v[188:191], v[204:207], v[128:143]
  s_waitcnt lgkmcnt(2)
  v_mfma_f32_32x32x16_bf16 v[144:159], v[192:195], v[204:207], v[144:159]
  buffer_store_dwordx4 v[236:239], v14, s[40:43], s26 offen offset:3072 sc1
  s_waitcnt lgkmcnt(0)
  v_mfma_f32_32x32x16_bf16 v[160:175], v[196:199], v[204:207], v[160:175]
  buffer_store_dwordx4 v[236:239], v14, s[40:43], s27 offen sc1
  s_waitcnt vmcnt(22)
  ds_write_b128 v3, v[72:75] offset:0
  v_dot2c_f32_bf16 v208, v72, v252
  v_dot2c_f32_bf16 v209, v72, v72
  v_dot2c_f32_bf16 v208, v73, v252
  v_dot2c_f32_bf16 v209, v73, v73
  v_dot2c_f32_bf16 v208, v74, v252
  v_dot2c_f32_bf16 v209, v74, v74
  v_dot2c_f32_bf16 v208, v75, v252
  v_dot2c_f32_bf16 v209, v75, v75
  s_waitcnt vmcnt(21)
  ds_write_b128 v3, v[76:79] offset:1024
  v_dot2c_f32_bf16 v210, v76, v252
  v_dot2c_f32_bf16 v211, v76, v76
  v_dot2c_f32_bf16 v210, v77, v252
  v_dot2c_f32_bf16 v211, v77, v77
  v_dot2c_f32_bf16 v210, v78, v252
  v_dot2c_f32_bf16 v211, v78, v78
  v_dot2c_f32_bf16 v210, v79, v252
  v_dot2c_f32_bf16 v211, v79, v79
  s_waitcnt vmcnt(20)
  ds_write_b128 v3, v[80:83] offset:2048
  v_dot2c_f32_bf16 v208, v80, v252
  v_dot2c_f32_bf16 v209, v80, v80
  v_dot2c_f32_bf16 v208, v81, v252
  v_dot2c_f32_bf16 v209, v81, v81
  v_dot2c_f32_bf16 v208, v82, v252
  v_dot2c_f32_bf16 v209, v82, v82
  v_dot2c_f32_bf16 v208, v83, v252
  v_dot2c_f32_bf16 v209, v83, v83
  s_waitcnt vmcnt(19)
  ds_write_b128 v3, v[84:87] offset:3072
  v_dot2c_f32_bf16 v210, v84, v252
  v_dot2c_f32_bf16 v211, v84, v84
  v_dot2c_f32_bf16 v210, v85, v252
  v_dot2c_f32_bf16 v211, v85, v85
  v_dot2c_f32_bf16 v210, v86, v252
  v_dot2c_f32_bf16 v211, v86, v86
  v_dot2c_f32_bf16 v210, v87, v252
  v_dot2c_f32_bf16 v211, v87, v87
  s_waitcnt vmcnt(18)
  ds_write_b128 v3, v[88:91] offset:4096
  v_dot2c_f32_bf16 v208, v88, v252
  v_dot2c_f32_bf16 v209, v88, v88
  v_dot2c_f32_bf16 v208, v89, v252
  v_dot2c_f32_bf16 v209, v89, v89
  v_dot2c_f32_bf16 v208, v90, v252
  v_dot2c_f32_bf16 v209, v90, v90
  v_dot2c_f32_bf16 v208, v91, v252
  v_dot2c_f32_bf16 v209, v91, v91
  s_waitcnt vmcnt(17)
  ds_write_b128 v3, v[92:95] offset:5120
  v_dot2c_f32_bf16 v210, v92, v252
  v_dot2c_f32_bf16 v211, v92, v92
  v_dot2c_f32_bf16 v210, v93, v252
  v_dot2c_f32_bf16 v211, v93, v93
  v_dot2c_f32_bf16 v210, v94, v252
  v_dot2c_f32_bf16 v211, v94, v94
  v_dot2c_f32_bf16 v210, v95, v252
  v_dot2c_f32_bf16 v211, v95, v95
  s_waitcnt vmcnt(16)
  ds_write_b128 v3, v[96:99] offset:6144
  v_dot2c_f32_bf16 v208, v96, v252
  v_dot2c_f32_bf16 v209, v96, v96
  v_dot2c_f32_bf16 v208, v97, v252
  v_dot2c_f32_bf16 v209, v97, v97
  v_dot2c_f32_bf16 v208, v98, v252
  v_dot2c_f32_bf16 v209, v98, v98
  v_dot2c_f32_bf16 v208, v99, v252
  v_dot2c_f32_bf16 v209, v99, v99
  s_waitcnt vmcnt(15)
  ds_write_b128 v3, v[100:103] offset:7168
  v_dot2c_f32_bf16 v210, v100, v252
  v_dot2c_f32_bf16 v211, v100, v100
  v_dot2c_f32_bf16 v210, v101, v252
  v_dot2c_f32_bf16 v211, v101, v101
  v_dot2c_f32_bf16 v210, v102, v252
  v_dot2c_f32_bf16 v211, v102, v102
  v_dot2c_f32_bf16 v210, v103, v252
  v_dot2c_f32_bf16 v211, v103, v103
  s_waitcnt vmcnt(14)
  ds_write_b128 v3, v[104:107] offset:8192
  v_dot2c_f32_bf16 v208, v104, v252
  v_dot2c_f32_bf16 v209, v104, v104
  v_dot2c_f32_bf16 v208, v105, v252
  v_dot2c_f32_bf16 v209, v105, v105
  v_dot2c_f32_bf16 v208, v106, v252
  v_dot2c_f32_bf16 v209, v106, v106
  v_dot2c_f32_bf16 v208, v107, v252
  v_dot2c_f32_bf16 v209, v107, v107
  s_waitcnt vmcnt(13)
  ds_write_b128 v3, v[108:111] offset:9216
  v_dot2c_f32_bf16 v210, v108, v252
  v_dot2c_f32_bf16 v211, v108, v108
  v_dot2c_f32_bf16 v210, v109, v252
  v_dot2c_f32_bf16 v211, v109, v109
  v_dot2c_f32_bf16 v210, v110, v252
  v_dot2c_f32_bf16 v211, v110, v110
  v_dot2c_f32_bf16 v210, v111, v252
  v_dot2c_f32_bf16 v211, v111, v111
  s_waitcnt vmcnt(12)
  ds_write_b128 v3, v[112:115] offset:10240
  v_dot2c_f32_bf16 v208, v112, v252
  v_dot2c_f32_bf16 v209, v112, v112
  v_dot2c_f32_bf16 v208, v113, v252
  v_dot2c_f32_bf16 v209, v113, v113
  v_dot2c_f32_bf16 v208, v114, v252
  v_dot2c_f32_bf16 v209, v114, v114
  v_dot2c_f32_bf16 v208, v115, v252
  v_dot2c_f32_bf16 v209, v115, v115
  s_waitcnt vmcnt(11)
  ds_write_b128 v3, v[116:119] offset:11264
  v_dot2c_f32_bf16 v210, v116, v252
  v_dot2c_f32_bf16 v211, v116, v116
  v_dot2c_f32_bf16 v210, v117, v252
  v_dot2c_f32_bf16 v211, v117, v117
  v_dot2c_f32_bf16 v210, v118, v252
  v_dot2c_f32_bf16 v211, v118, v118
  v_dot2c_f32_bf16 v210, v119, v252
  v_dot2c_f32_bf16 v211, v119, v119
  s_waitcnt vmcnt(10)
  ds_write_b128 v3, v[120:123] offset:12288
  v_dot2c_f32_bf16 v208, v120, v252
  v_dot2c_f32_bf16 v209, v120, v120
  v_dot2c_f32_bf16 v208, v121, v252
  v_dot2c_f32_bf16 v209, v121, v121
  v_dot2c_f32_bf16 v208, v122, v252
  v_dot2c_f32_bf16 v209, v122, v122
  v_dot2c_f32_bf16 v208, v123, v252
  v_dot2c_f32_bf16 v209, v123, v123
  s_waitcnt vmcnt(9)
  ds_write_b128 v3, v[124:127] offset:13312
  v_dot2c_f32_bf16 v210, v124, v252
  v_dot2c_f32_bf16 v211, v124, v124
  v_dot2c_f32_bf16 v210, v125, v252
  v_dot2c_f32_bf16 v211, v125, v125
  v_dot2c_f32_bf16 v210, v126, v252
  v_dot2c_f32_bf16 v211, v126, v126
  v_dot2c_f32_bf16 v210, v127, v252
  v_dot2c_f32_bf16 v211, v127, v127
  v_add_f32_dpp v208, v208, v208 quad_perm:[1,0,3,2] row_mask:0xf bank_mask:0xf
  v_add_f32_dpp v209, v209, v209 quad_perm:[1,0,3,2] row_mask:0xf bank_mask:0xf
  v_add_f32_dpp v210, v210, v210 quad_perm:[1,0,3,2] row_mask:0xf bank_mask:0xf
  v_add_f32_dpp v211, v211, v211 quad_perm:[1,0,3,2] row_mask:0xf bank_mask:0xf
  v_add_f32_dpp v208, v208, v208 quad_perm:[2,3,0,1] row_mask:0xf bank_mask:0xf
  v_add_f32_dpp v209, v209, v209 quad_perm:[2,3,0,1] row_mask:0xf bank_mask:0xf
  v_add_f32_dpp v210, v210, v210 quad_perm:[2,3,0,1] row_mask:0xf bank_mask:0xf
  v_add_f32_dpp v211, v211, v211 quad_perm:[2,3,0,1] row_mask:0xf bank_mask:0xf
  s_lshl_b32 s30, s16, 8
  s_add_u32 s30, s30, 143360
  v_lshl_add_u32 v9, v6, 3, s30
  ds_write_b64 v9, v[208:209]
  ds_write_b64 v9, v[210:211] offset:128
  v_and_b32 v9, 31, v1
  v_lshl_add_u32 v9, v9, 3, s30
  ds_read_b64 v[208:209], v9
  s_mul_i32 s30, s16, 21504
  v_add_u32 v10, s30, v15
  s_lshl_b32 s30, s16, 2
  s_add_u32 s30, s30, 144384
  v_and_b32 v9, 15, v1
  v_lshl_add_u32 v9, v9, 4, s30
  s_waitcnt vmcnt(0)
  s_waitcnt lgkmcnt(0)
  s_barrier
  s_load_dwordx2 s[28:29], s[0:1], 56
  s_load_dwordx2 s[58:59], s[0:1], 48
  s_waitcnt lgkmcnt(0)
  global_load_dword v246, v247, s[28:29] sc1
  s_add_u32 m0, s23, 0
  s_nop 0
  buffer_load_dwordx4 v228, s[44:47], s54 offen lds
  s_add_u32 s54, s54, s24
  s_add_u32 m0, s23, 1024
  s_nop 0
  buffer_load_dwordx4 v228, s[44:47], s54 offen lds
  s_add_u32 s54, s54, s24
  s_add_u32 m0, s23, 2048
  s_nop 0
  buffer_load_dwordx4 v228, s[44:47], s54 offen lds
  s_add_u32 s54, s54, s24
  s_add_u32 m0, s23, 3072
  s_nop 0
  buffer_load_dwordx4 v229, s[44:47], s54 offen lds
  ds_read_b64_tr_b16 v[16:17], v10 offset:0
  ds_read_b64_tr_b16 v[18:19], v10 offset:768
  ds_read_b64_tr_b16 v[20:21], v10 offset:56
  ds_read_b64_tr_b16 v[22:23], v10 offset:824
  ds_read_b64_tr_b16 v[24:25], v10 offset:112
  ds_read_b64_tr_b16 v[26:27], v10 offset:880
  ds_read_b64_tr_b16 v[28:29], v10 offset:3072
  ds_read_b64_tr_b16 v[30:31], v10 offset:3840
  ds_read_b64_tr_b16 v[32:33], v10 offset:3128
  ds_read_b64_tr_b16 v[34:35], v10 offset:3896
  ds_read_b64_tr_b16 v[36:37], v10 offset:3184
  ds_read_b64_tr_b16 v[38:39], v10 offset:3952
  s_waitcnt lgkmcnt(10)
  v_mfma_f32_16x16x32_bf16 v[104:107], v[240:243], v[16:19], 0
  ds_read_b64_tr_b16 v[40:41], v10 offset:6144
  ds_read_b64_tr_b16 v[42:43], v10 offset:6912
  s_waitcnt lgkmcnt(10)
  v_mfma_f32_16x16x32_bf16 v[108:111], v[240:243], v[20:23], 0
  ds_read_b64_tr_b16 v[44:45], v10 offset:6200
  ds_read_b64_tr_b16 v[46:47], v10 offset:6968
  s_waitcnt lgkmcnt(10)
  v_mfma_f32_16x16x32_bf16 v[112:115], v[240:243], v[24:27], 0
  ds_read_b64_tr_b16 v[48:49], v10 offset:6256
  ds_read_b64_tr_b16 v[50:51], v10 offset:7024
  s_waitcnt lgkmcnt(10)
  v_mfma_f32_16x16x32_bf16 v[104:107], v[240:243], v[28:31], v[104:107]
  ds_read_b64_tr_b16 v[52:53], v10 offset:9216
  ds_read_b64_tr_b16 v[54:55], v10 offset:9984
  s_waitcnt lgkmcnt(10)
  v_mfma_f32_16x16x32_bf16 v[108:111], v[240:243], v[32:35], v[108:111]
  ds_read_b64_tr_b16 v[56:57], v10 offset:9272
  ds_read_b64_tr_b16 v[58:59], v10 offset:10040
  s_waitcnt lgkmcnt(10)
  v_mfma_f32_16x16x32_bf16 v[112:115], v[240:243], v[36:39], v[112:115]
  ds_read_b64_tr_b16 v[60:61], v10 offset:9328
  ds_read_b64_tr_b16 v[62:63], v10 offset:10096
  s_waitcnt lgkmcnt(10)
  v_mfma_f32_16x16x32_bf16 v[104:107], v[240:243], v[40:43], v[104:107]
  ds_read_b64_tr_b16 v[64:65], v10 offset:12288
  ds_read_b64_tr_b16 v[66:67], v10 offset:13056
  s_waitcnt lgkmcnt(10)
  v_mfma_f32_16x16x32_bf16 v[108:111], v[240:243], v[44:47], v[108:111]
  ds_read_b64_tr_b16 v[68:69], v10 offset:12344
  ds_read_b64_tr_b16 v[70:71], v10 offset:13112
  s_waitcnt lgkmcnt(10)
  v_mfma_f32_16x16x32_bf16 v[112:115], v[240:243], v[48:51], v[112:115]
  ds_read_b64_tr_b16 v[72:73], v10 offset:12400
  ds_read_b64_tr_b16 v[74:75], v10 offset:13168
  s_waitcnt lgkmcnt(10)
  v_mfma_f32_16x16x32_bf16 v[104:107], v[240:243], v[52:55], v[104:107]
  ds_read_b64_tr_b16 v[76:77], v10 offset:15360
  ds_read_b64_tr_b16 v[78:79], v10 offset:16128
  s_waitcnt lgkmcnt(10)
  v_mfma_f32_16x16x32_bf16 v[108:111], v[240:243], v[56:59], v[108:111]
  ds_read_b64_tr_b16 v[80:81], v10 offset:15416
  ds_read_b64_tr_b16 v[82:83], v10 offset:16184
  s_waitcnt lgkmcnt(10)
  v_mfma_f32_16x16x32_bf16 v[112:115], v[240:243], v[60:63], v[112:115]
  ds_read_b64_tr_b16 v[84:85], v10 offset:15472
  ds_read_b64_tr_b16 v[86:87], v10 offset:16240
  s_waitcnt lgkmcnt(10)
  v_mfma_f32_16x16x32_bf16 v[104:107], v[240:243], v[64:67], v[104:107]
  ds_read_b64_tr_b16 v[88:89], v10 offset:18432
  ds_read_b64_tr_b16 v[90:91], v10 offset:19200
  s_waitcnt lgkmcnt(10)
  v_mfma_f32_16x16x32_bf16 v[108:111], v[240:243], v[68:71], v[108:111]
  ds_read_b64_tr_b16 v[92:93], v10 offset:18488
  ds_read_b64_tr_b16 v[94:95], v10 offset:19256
  s_waitcnt lgkmcnt(10)
  v_mfma_f32_16x16x32_bf16 v[112:115], v[240:243], v[72:75], v[112:115]
  ds_read_b64_tr_b16 v[96:97], v10 offset:18544
  ds_read_b64_tr_b16 v[98:99], v10 offset:19312
  s_waitcnt lgkmcnt(10)
  v_mfma_f32_16x16x32_bf16 v[104:107], v[240:243], v[76:79], v[104:107]
  v_mul_f32 v208, 0x3b124925, v208
  v_mul_f32 v209, 0x3b124925, v209
  s_waitcnt lgkmcnt(8)
  v_mfma_f32_16x16x32_bf16 v[108:111], v[240:243], v[80:83], v[108:111]
  v_fma_f32 v209, -v208, v208, v209
  v_max_f32 v209, 0, v209
  s_waitcnt lgkmcnt(6)
  v_mfma_f32_16x16x32_bf16 v[112:115], v[240:243], v[84:87], v[112:115]
  v_cvt_pk_bf16_f32 v210, -v208, -v208
  v_cvt_pk_bf16_f32 v100, v209, v209
  s_waitcnt lgkmcnt(4)
  v_mfma_f32_16x16x32_bf16 v[104:107], v[240:243], v[88:91], v[104:107]
  v_and_b32 v100, 0xffff0000, v100
  v_add_f32 v100, 0x3727c5ac, v100
  s_waitcnt lgkmcnt(2)
  v_mfma_f32_16x16x32_bf16 v[108:111], v[240:243], v[92:95], v[108:111]
  v_cvt_pk_bf16_f32 v100, v100, v100
  v_and_b32 v100, 0xffff0000, v100
  s_waitcnt lgkmcnt(0)
  v_mfma_f32_16x16x32_bf16 v[112:115], v[240:243], v[96:99], v[112:115]
  v_sqrt_f32 v100, v100
  v_add_u32 v15, 43008, v15
  ds_write_b32 v9, v104 offset:0
  ds_write_b32 v9, v105 offset:256
  ds_write_b32 v9, v108 offset:512
  ds_write_b32 v9, v109 offset:768
  s_nop 1
  ds_write_b32 v9, v112 offset:1024
  ds_write_b32 v9, v113 offset:1280
  ds_read_b128 v[200:203], v4 offset:0
  ds_read_b64_tr_b16 v[176:177], v15 offset:0
  ds_read_b64_tr_b16 v[178:179], v15 offset:768
  ds_read_b64_tr_b16 v[180:181], v15 offset:56
  ds_read_b64_tr_b16 v[182:183], v15 offset:824
  ds_read_b64_tr_b16 v[184:185], v15 offset:112
  ds_read_b64_tr_b16 v[186:187], v15 offset:880
  s_waitcnt lgkmcnt(4)
  v_mfma_f32_32x32x16_bf16 v[128:143], v[176:179], v[200:203], v[128:143]
  ds_read_b128 v[204:207], v12 offset:0
  ds_read_b64_tr_b16 v[188:189], v15 offset:3072
  ds_read_b64_tr_b16 v[190:191], v15 offset:3840
  v_cvt_pk_bf16_f32 v100, v100, v100
  s_waitcnt lgkmcnt(5)
  v_mfma_f32_32x32x16_bf16 v[144:159], v[180:183], v[200:203], v[144:159]
  ds_read_b64_tr_b16 v[192:193], v15 offset:3128
  ds_read_b64_tr_b16 v[194:195], v15 offset:3896
  v_and_b32 v100, 0xffff0000, v100
  v_rcp_f32 v211, v100
  s_waitcnt lgkmcnt(5)
  v_mfma_f32_32x32x16_bf16 v[160:175], v[184:187], v[200:203], v[160:175]
  ds_read_b64_tr_b16 v[196:197], v15 offset:3184
  ds_read_b64_tr_b16 v[198:199], v15 offset:3952
  v_and_b32 v9, 31, v1
  v_lshlrev_b32 v9, 4, v9
  s_waitcnt lgkmcnt(4)
  v_mfma_f32_32x32x16_bf16 v[128:143], v[188:191], v[204:207], v[128:143]
  ds_read_b128 v[200:203], v4 offset:2048
  ds_read_b64_tr_b16 v[176:177], v15 offset:6144
  ds_read_b64_tr_b16 v[178:179], v15 offset:6912
  v_add_u32 v9, 144384, v9
  s_waitcnt lgkmcnt(5)
  v_mfma_f32_32x32x16_bf16 v[144:159], v[192:195], v[204:207], v[144:159]
  ds_read_b64_tr_b16 v[180:181], v15 offset:6200
  ds_read_b64_tr_b16 v[182:183], v15 offset:6968
  v_mov_b32 v28, v210
  v_mov_b32 v29, 0
  s_waitcnt lgkmcnt(5)
  v_mfma_f32_32x32x16_bf16 v[160:175], v[196:199], v[204:207], v[160:175]
  ds_read_b64_tr_b16 v[184:185], v15 offset:6256
  ds_read_b64_tr_b16 v[186:187], v15 offset:7024
  v_mov_b32 v30, 0
  v_mov_b32 v31, 0
  s_waitcnt lgkmcnt(4)
  v_mfma_f32_32x32x16_bf16 v[128:143], v[176:179], v[200:203], v[128:143]
  ds_read_b128 v[204:207], v12 offset:2048
  ds_read_b64_tr_b16 v[188:189], v15 offset:9216
  ds_read_b64_tr_b16 v[190:191], v15 offset:9984
  v_and_b32 v2, 31, v1
  s_waitcnt lgkmcnt(5)
  v_mfma_f32_32x32x16_bf16 v[144:159], v[180:183], v[200:203], v[144:159]
  ds_read_b64_tr_b16 v[192:193], v15 offset:9272
  ds_read_b64_tr_b16 v[194:195], v15 offset:10040
  v_mul_u32_u24 v2, 72, v2
  v_lshl_add_u32 v2, v11, 3, v2
  s_waitcnt lgkmcnt(5)
  v_mfma_f32_32x32x16_bf16 v[160:175], v[184:187], v[200:203], v[160:175]
  ds_read_b64_tr_b16 v[196:197], v15 offset:9328
  ds_read_b64_tr_b16 v[198:199], v15 offset:10096
  v_add_u32 v2, s22, v2
  v_bfe_u32 v10, v1, 2, 2
  s_waitcnt lgkmcnt(4)
  v_mfma_f32_32x32x16_bf16 v[128:143], v[188:191], v[204:207], v[128:143]
  ds_read_b128 v[200:203], v4 offset:4096
  ds_read_b64_tr_b16 v[176:177], v15 offset:12288
  ds_read_b64_tr_b16 v[178:179], v15 offset:13056
  v_lshl_add_u32 v10, v11, 2, v10
  s_waitcnt lgkmcnt(5)
  v_mfma_f32_32x32x16_bf16 v[144:159], v[192:195], v[204:207], v[144:159]
  ds_read_b64_tr_b16 v[180:181], v15 offset:12344
  ds_read_b64_tr_b16 v[182:183], v15 offset:13112
  v_mul_u32_u24 v10, 72, v10
  v_add3_u32 v10, v10, v13, s22
  s_waitcnt lgkmcnt(5)
  v_mfma_f32_32x32x16_bf16 v[160:175], v[196:199], v[204:207], v[160:175]
  ds_read_b64_tr_b16 v[184:185], v15 offset:12400
  ds_read_b64_tr_b16 v[186:187], v15 offset:13168
  v_mul_f32 v116, s65, v211
  v_mul_f32 v118, s66, v211
  s_waitcnt lgkmcnt(0)
  s_barrier
  ds_read_b128 v[16:19], v9 offset:0
  ds_read_b128 v[20:23], v9 offset:512
  ds_read_b128 v[24:27], v9 offset:1024
  v_mfma_f32_32x32x16_bf16 v[128:143], v[176:179], v[200:203], v[128:143]
  ds_read_b128 v[204:207], v12 offset:4096
  ds_read_b64_tr_b16 v[188:189], v15 offset:15360
  ds_read_b64_tr_b16 v[190:191], v15 offset:16128
  v_mul_f32 v120, s67, v211
  v_mfma_f32_32x32x16_bf16 v[144:159], v[180:183], v[200:203], v[144:159]
  ds_read_b64_tr_b16 v[192:193], v15 offset:15416
  ds_read_b64_tr_b16 v[194:195], v15 offset:16184
  v_mov_b32 v124, s68
  v_mov_b32 v125, s69
  v_mfma_f32_32x32x16_bf16 v[160:175], v[184:187], v[200:203], v[160:175]
  ds_read_b64_tr_b16 v[196:197], v15 offset:15472
  ds_read_b64_tr_b16 v[198:199], v15 offset:16240
  v_mov_b32 v126, s70
  s_waitcnt lgkmcnt(4)
  v_mfma_f32_32x32x16_bf16 v[128:143], v[188:191], v[204:207], v[128:143]
  ds_read_b128 v[200:203], v4 offset:6144
  ds_read_b64_tr_b16 v[176:177], v15 offset:18432
  ds_read_b64_tr_b16 v[178:179], v15 offset:19200
  s_waitcnt lgkmcnt(5)
  v_mfma_f32_32x32x16_bf16 v[144:159], v[192:195], v[204:207], v[144:159]
  ds_read_b64_tr_b16 v[180:181], v15 offset:18488
  ds_read_b64_tr_b16 v[182:183], v15 offset:19256
  s_waitcnt lgkmcnt(5)
  v_mfma_f32_32x32x16_bf16 v[160:175], v[196:199], v[204:207], v[160:175]
  ds_read_b64_tr_b16 v[184:185], v15 offset:18544
  ds_read_b64_tr_b16 v[186:187], v15 offset:19312
  s_waitcnt lgkmcnt(4)
  v_mfma_f32_32x32x16_bf16 v[128:143], v[176:179], v[200:203], v[128:143]
  ds_read_b128 v[204:207], v12 offset:6144
  ds_read_b64_tr_b16 v[188:189], v15 offset:21504
  ds_read_b64_tr_b16 v[190:191], v15 offset:22272
  v_add_f32 v16, v16, v17
  s_waitcnt lgkmcnt(5)
  v_mfma_f32_32x32x16_bf16 v[144:159], v[180:183], v[200:203], v[144:159]
  ds_read_b64_tr_b16 v[192:193], v15 offset:21560
  ds_read_b64_tr_b16 v[194:195], v15 offset:22328
  v_add_f32 v18, v18, v19
  v_add_f32 v16, v16, v18
  s_waitcnt lgkmcnt(5)
  v_mfma_f32_32x32x16_bf16 v[160:175], v[184:187], v[200:203], v[160:175]
  ds_read_b64_tr_b16 v[196:197], v15 offset:21616
  ds_read_b64_tr_b16 v[198:199], v15 offset:22384
  v_cvt_pk_bf16_f32 v17, v16, v16
  v_and_b32 v17, 0xffff0000, v17
  s_waitcnt lgkmcnt(4)
  v_mfma_f32_32x32x16_bf16 v[128:143], v[188:191], v[204:207], v[128:143]
  ds_read_b128 v[200:203], v4 offset:8192
  ds_read_b64_tr_b16 v[176:177], v15 offset:24576
  ds_read_b64_tr_b16 v[178:179], v15 offset:25344
  v_sub_f32 v17, v16, v17
  s_waitcnt lgkmcnt(5)
  v_mfma_f32_32x32x16_bf16 v[144:159], v[192:195], v[204:207], v[144:159]
  ds_read_b64_tr_b16 v[180:181], v15 offset:24632
  ds_read_b64_tr_b16 v[182:183], v15 offset:25400
  v_cvt_pk_bf16_f32 v16, v16, v17
  v_cndmask_b32 v16, v16, 0, s[52:53]
  s_waitcnt lgkmcnt(5)
  v_mfma_f32_32x32x16_bf16 v[160:175], v[196:199], v[204:207], v[160:175]
  ds_read_b64_tr_b16 v[184:185], v15 offset:24688
  ds_read_b64_tr_b16 v[186:187], v15 offset:25456
  v_mov_b32 v17, 0
  v_mov_b32 v18, 0
  s_waitcnt lgkmcnt(4)
  v_mfma_f32_32x32x16_bf16 v[128:143], v[176:179], v[200:203], v[128:143]
  ds_read_b128 v[204:207], v12 offset:8192
  ds_read_b64_tr_b16 v[188:189], v15 offset:27648
  ds_read_b64_tr_b16 v[190:191], v15 offset:28416
  v_mov_b32 v19, 0
  s_waitcnt lgkmcnt(5)
  v_mfma_f32_32x32x16_bf16 v[144:159], v[180:183], v[200:203], v[144:159]
  ds_read_b64_tr_b16 v[192:193], v15 offset:27704
  ds_read_b64_tr_b16 v[194:195], v15 offset:28472
  v_add_f32 v20, v20, v21
  v_add_f32 v22, v22, v23
  s_waitcnt lgkmcnt(5)
  v_mfma_f32_32x32x16_bf16 v[160:175], v[184:187], v[200:203], v[160:175]
  ds_read_b64_tr_b16 v[196:197], v15 offset:27760
  ds_read_b64_tr_b16 v[198:199], v15 offset:28528
  v_add_f32 v20, v20, v22
  v_cvt_pk_bf16_f32 v21, v20, v20
  s_waitcnt lgkmcnt(4)
  v_mfma_f32_32x32x16_bf16 v[128:143], v[188:191], v[204:207], v[128:143]
  ds_read_b128 v[200:203], v4 offset:10240
  ds_read_b64_tr_b16 v[176:177], v15 offset:30720
  ds_read_b64_tr_b16 v[178:179], v15 offset:31488
  v_and_b32 v21, 0xffff0000, v21
  s_waitcnt lgkmcnt(5)
  v_mfma_f32_32x32x16_bf16 v[144:159], v[192:195], v[204:207], v[144:159]
  ds_read_b64_tr_b16 v[180:181], v15 offset:30776
  ds_read_b64_tr_b16 v[182:183], v15 offset:31544
  v_sub_f32 v21, v20, v21
  v_cvt_pk_bf16_f32 v20, v20, v21
  s_waitcnt lgkmcnt(5)
  v_mfma_f32_32x32x16_bf16 v[160:175], v[196:199], v[204:207], v[160:175]
  ds_read_b64_tr_b16 v[184:185], v15 offset:30832
  ds_read_b64_tr_b16 v[186:187], v15 offset:31600
  v_cndmask_b32 v20, v20, 0, s[52:53]
  v_mov_b32 v21, 0
  s_waitcnt lgkmcnt(4)
  v_mfma_f32_32x32x16_bf16 v[128:143], v[176:179], v[200:203], v[128:143]
  ds_read_b128 v[204:207], v12 offset:10240
  ds_read_b64_tr_b16 v[188:189], v15 offset:33792
  ds_read_b64_tr_b16 v[190:191], v15 offset:34560
  v_mov_b32 v22, 0
  s_waitcnt lgkmcnt(5)
  v_mfma_f32_32x32x16_bf16 v[144:159], v[180:183], v[200:203], v[144:159]
  ds_read_b64_tr_b16 v[192:193], v15 offset:33848
  ds_read_b64_tr_b16 v[194:195], v15 offset:34616
  v_mov_b32 v23, 0
  v_add_f32 v24, v24, v25
  s_waitcnt lgkmcnt(5)
  v_mfma_f32_32x32x16_bf16 v[160:175], v[184:187], v[200:203], v[160:175]
  ds_read_b64_tr_b16 v[196:197], v15 offset:33904
  ds_read_b64_tr_b16 v[198:199], v15 offset:34672
  v_add_f32 v26, v26, v27
  v_add_f32 v24, v24, v26
  s_waitcnt lgkmcnt(4)
  v_mfma_f32_32x32x16_bf16 v[128:143], v[188:191], v[204:207], v[128:143]
  ds_read_b128 v[200:203], v4 offset:12288
  ds_read_b64_tr_b16 v[176:177], v15 offset:36864
  ds_read_b64_tr_b16 v[178:179], v15 offset:37632
  v_cvt_pk_bf16_f32 v25, v24, v24
  s_waitcnt lgkmcnt(5)
  v_mfma_f32_32x32x16_bf16 v[144:159], v[192:195], v[204:207], v[144:159]
  ds_read_b64_tr_b16 v[180:181], v15 offset:36920
  ds_read_b64_tr_b16 v[182:183], v15 offset:37688
  v_and_b32 v25, 0xffff0000, v25
  v_sub_f32 v25, v24, v25
  s_waitcnt lgkmcnt(5)
  v_mfma_f32_32x32x16_bf16 v[160:175], v[196:199], v[204:207], v[160:175]
  ds_read_b64_tr_b16 v[184:185], v15 offset:36976
  ds_read_b64_tr_b16 v[186:187], v15 offset:37744
  v_cvt_pk_bf16_f32 v24, v24, v25
  v_cndmask_b32 v24, v24, 0, s[52:53]
  s_waitcnt lgkmcnt(4)
  v_mfma_f32_32x32x16_bf16 v[128:143], v[176:179], v[200:203], v[128:143]
  ds_read_b128 v[204:207], v12 offset:12288
  ds_read_b64_tr_b16 v[188:189], v15 offset:39936
  ds_read_b64_tr_b16 v[190:191], v15 offset:40704
  v_mov_b32 v25, 0
  s_waitcnt lgkmcnt(5)
  v_mfma_f32_32x32x16_bf16 v[144:159], v[180:183], v[200:203], v[144:159]
  ds_read_b64_tr_b16 v[192:193], v15 offset:39992
  ds_read_b64_tr_b16 v[194:195], v15 offset:40760
  v_mov_b32 v26, 0
  v_mov_b32 v27, 0
  s_waitcnt lgkmcnt(5)
  v_mfma_f32_32x32x16_bf16 v[160:175], v[184:187], v[200:203], v[160:175]
  ds_read_b64_tr_b16 v[196:197], v15 offset:40048
  ds_read_b64_tr_b16 v[198:199], v15 offset:40816
  s_waitcnt lgkmcnt(4)
  v_mfma_f32_32x32x16_bf16 v[128:143], v[188:191], v[204:207], v[128:143]
  s_waitcnt lgkmcnt(2)
  v_mfma_f32_32x32x16_bf16 v[144:159], v[192:195], v[204:207], v[144:159]
  s_waitcnt lgkmcnt(0)
  v_mfma_f32_32x32x16_bf16 v[160:175], v[196:199], v[204:207], v[160:175]
  v_mfma_f32_32x32x16_bf16 v[128:143], v[16:19], v[28:31], v[128:143]
  v_mfma_f32_32x32x16_bf16 v[144:159], v[20:23], v[28:31], v[144:159]
  v_mfma_f32_32x32x16_bf16 v[160:175], v[24:27], v[28:31], v[160:175]
  s_nop 9
  v_pk_mul_f32 v[128:129], v[128:129], v[116:117] op_sel_hi:[1,0]
  v_pk_mul_f32 v[130:131], v[130:131], v[116:117] op_sel_hi:[1,0]
  v_pk_mul_f32 v[132:133], v[132:133], v[116:117] op_sel_hi:[1,0]
  v_pk_mul_f32 v[134:135], v[134:135], v[116:117] op_sel_hi:[1,0]
  v_pk_mul_f32 v[136:137], v[136:137], v[116:117] op_sel_hi:[1,0]
  v_pk_mul_f32 v[138:139], v[138:139], v[116:117] op_sel_hi:[1,0]
  v_pk_mul_f32 v[140:141], v[140:141], v[116:117] op_sel_hi:[1,0]
  v_pk_mul_f32 v[142:143], v[142:143], v[116:117] op_sel_hi:[1,0]
  v_cvt_pk_bf16_f32 v32, v128, v129
  v_cvt_pk_bf16_f32 v33, v130, v131
  v_cvt_pk_bf16_f32 v34, v132, v133
  v_cvt_pk_bf16_f32 v35, v134, v135
  v_cvt_pk_bf16_f32 v36, v136, v137
  v_cvt_pk_bf16_f32 v37, v138, v139
  v_cvt_pk_bf16_f32 v38, v140, v141
  v_cvt_pk_bf16_f32 v39, v142, v143
  v_cndmask_b32 v38, v38, v124, s[52:53]
  v_cndmask_b32 v39, v39, 0, s[52:53]
  s_cmp_eq_u32 s71, 2
  s_cbranch_scc0 K1_ED0
  ds_write_b64 v2, v[32:33] offset:0
  ds_write_b64 v2, v[34:35] offset:16
  ds_write_b64 v2, v[36:37] offset:32
  ds_write_b64 v2, v[38:39] offset:48
  s_waitcnt lgkmcnt(0)
  ds_read_b64_tr_b16 v[32:33], v10 offset:0
  ds_read_b64_tr_b16 v[34:35], v10 offset:576
  ds_read_b64_tr_b16 v[36:37], v10 offset:1152
  ds_read_b64_tr_b16 v[38:39], v10 offset:1728
  s_waitcnt lgkmcnt(0)
K1_ED0:
  buffer_store_dwordx4 v[32:35], v5, s[40:43], s62 offen offset:0 sc1
  buffer_store_dwordx4 v[36:39], v5, s[40:43], s62 offen offset:1024 sc1
  v_pk_mul_f32 v[144:145], v[144:145], v[118:119] op_sel_hi:[1,0]
  v_pk_mul_f32 v[146:147], v[146:147], v[118:119] op_sel_hi:[1,0]
  v_pk_mul_f32 v[148:149], v[148:149], v[118:119] op_sel_hi:[1,0]
  v_pk_mul_f32 v[150:151], v[150:151], v[118:119] op_sel_hi:[1,0]
  v_pk_mul_f32 v[152:153], v[152:153], v[118:119] op_sel_hi:[1,0]
  v_pk_mul_f32 v[154:155], v[154:155], v[118:119] op_sel_hi:[1,0]
  v_pk_mul_f32 v[156:157], v[156:157], v[118:119] op_sel_hi:[1,0]
  v_pk_mul_f32 v[158:159], v[158:159], v[118:119] op_sel_hi:[1,0]
  v_cvt_pk_bf16_f32 v40, v144, v145
  v_cvt_pk_bf16_f32 v41, v146, v147
  v_cvt_pk_bf16_f32 v42, v148, v149
  v_cvt_pk_bf16_f32 v43, v150, v151
  v_cvt_pk_bf16_f32 v44, v152, v153
  v_cvt_pk_bf16_f32 v45, v154, v155
  v_cvt_pk_bf16_f32 v46, v156, v157
  v_cvt_pk_bf16_f32 v47, v158, v159
  v_cndmask_b32 v46, v46, v125, s[52:53]
  v_cndmask_b32 v47, v47, 0, s[52:53]
  s_cmp_eq_u32 s72, 2
  s_cbranch_scc0 K1_ED1
  ds_write_b64 v2, v[40:41] offset:0
  ds_write_b64 v2, v[42:43] offset:16
  ds_write_b64 v2, v[44:45] offset:32
  ds_write_b64 v2, v[46:47] offset:48
  s_waitcnt lgkmcnt(0)
  ds_read_b64_tr_b16 v[40:41], v10 offset:0
  ds_read_b64_tr_b16 v[42:43], v10 offset:576
  ds_read_b64_tr_b16 v[44:45], v10 offset:1152
  ds_read_b64_tr_b16 v[46:47], v10 offset:1728
  s_waitcnt lgkmcnt(0)
K1_ED1:
  buffer_store_dwordx4 v[40:43], v5, s[40:43], s63 offen offset:0 sc1
  buffer_store_dwordx4 v[44:47], v5, s[40:43], s63 offen offset:1024 sc1
  v_pk_mul_f32 v[160:161], v[160:161], v[120:121] op_sel_hi:[1,0]
  v_pk_mul_f32 v[162:163], v[162:163], v[120:121] op_sel_hi:[1,0]
  v_pk_mul_f32 v[164:165], v[164:165], v[120:121] op_sel_hi:[1,0]
  v_pk_mul_f32 v[166:167], v[166:167], v[120:121] op_sel_hi:[1,0]
  v_pk_mul_f32 v[168:169], v[168:169], v[120:121] op_sel_hi:[1,0]
  v_pk_mul_f32 v[170:171], v[170:171], v[120:121] op_sel_hi:[1,0]
  v_pk_mul_f32 v[172:173], v[172:173], v[120:121] op_sel_hi:[1,0]
  v_pk_mul_f32 v[174:175], v[174:175], v[120:121] op_sel_hi:[1,0]
  v_cvt_pk_bf16_f32 v48, v160, v161
  v_cvt_pk_bf16_f32 v49, v162, v163
  v_cvt_pk_bf16_f32 v50, v164, v165
  v_cvt_pk_bf16_f32 v51, v166, v167
  v_cvt_pk_bf16_f32 v52, v168, v169
  v_cvt_pk_bf16_f32 v53, v170, v171
  v_cvt_pk_bf16_f32 v54, v172, v173
  v_cvt_pk_bf16_f32 v55, v174, v175
  v_cndmask_b32 v54, v54, v126, s[52:53]
  v_cndmask_b32 v55, v55, 0, s[52:53]
  s_cmp_eq_u32 s73, 2
  s_cbranch_scc0 K1_ED2
  ds_write_b64 v2, v[48:49] offset:0
  ds_write_b64 v2, v[50:51] offset:16
  ds_write_b64 v2, v[52:53] offset:32
  ds_write_b64 v2, v[54:55] offset:48
  s_waitcnt lgkmcnt(0)
  ds_read_b64_tr_b16 v[48:49], v10 offset:0
  ds_read_b64_tr_b16 v[50:51], v10 offset:576
  ds_read_b64_tr_b16 v[52:53], v10 offset:1152
  ds_read_b64_tr_b16 v[54:55], v10 offset:1728
  s_waitcnt lgkmcnt(0)
K1_ED2:
  buffer_store_dwordx4 v[48:51], v5, s[40:43], s64 offen offset:0 sc1
  buffer_store_dwordx4 v[52:55], v5, s[40:43], s64 offen offset:1024 sc1
  s_mov_b32 s4, s8
  s_mov_b32 s5, s9
  s_mov_b32 s6, 401408
  s_mov_b32 s7, 0x00020000
  s_mov_b32 s36, s58
  s_mov_b32 s37, s59
  s_mov_b32 s38, 1835008
  s_mov_b32 s39, 0x00020000
  s_mov_b32 s8, s55
  s_mov_b32 s9, s56
  s_mov_b32 s10, s57
  s_mov_b32 s11, s25
  s_lshl_b32 s12, s19, 4
  s_add_u32 s12, s12, s20
  s_lshl_b32 s13, s12, 2
  s_add_u32 s13, s13, 11599872
  s_lshl_b32 s12, s12, 7
  s_add_u32 s12, s12, 11534336
  s_cmp_eq_u32 s16, 0
  s_cselect_b32 s12, s12, 1073741824
  s_cselect_b32 s13, s13, 1073741824
  v_lshlrev_b32 v2, 4, v1
  v_add_u32 v10, 4096, v2
  s_and_b32 s17, s2, 7
  s_lshl_b32 s19, s17, 2
  s_lshl_b32 s17, s17, 1
  s_bfe_u32 s18, s2, 0x10003
  s_add_u32 s17, s17, s18
  s_lshr_b32 s18, s2, 4
  s_lshl_b32 s70, s17, 6
  s_lshl_b32 s71, s18, 2
  s_add_u32 s71, s71, s70
  s_lshl_b32 s24, s71, 11
  s_lshl_b32 s21, s16, 4
  s_add_u32 s21, s21, s70
  s_lshl_b32 s21, s21, 12
  s_add_u32 s21, s21, 2097152
  v_add_u32 v175, s21, v2
  s_and_b32 s21, s18, 0
  s_lshl_b32 s21, s21, 12
  s_bfe_u32 s70, s2, 0x20003
  s_add_u32 s19, s19, s70
  s_lshr_b32 s20, s2, 5
  s_mov_b32 s52, 0
  s_mov_b32 s53, -1
  s_mov_b32 s69, 0
  s_mov_b32 s72, 0
  s_lshl_b32 s70, s70, 1
  s_add_u32 s70, s70, s20
  s_lshl_b32 s70, s70, 12
  s_and_b32 s70, s70, 0
  s_sub_u32 s71, s70, 28672
  s_cselect_b32 s70, s70, s71
  v_add_u32 v3, s70, v2
  s_add_u32 s70, s70, 4096
  s_sub_u32 s71, s70, 28672
  s_cselect_b32 s70, s70, s71
  v_add_u32 v4, s70, v2
  s_add_u32 s70, s70, 4096
  s_sub_u32 s71, s70, 28672
  s_cselect_b32 s70, s70, s71
  v_add_u32 v5, s70, v2
  s_add_u32 s70, s70, 4096
  s_sub_u32 s71, s70, 28672
  s_cselect_b32 s70, s70, s71
  v_add_u32 v6, s70, v2
  s_add_u32 s70, s70, 4096
  s_sub_u32 s71, s70, 28672
  s_cselect_b32 s70, s70, s71
  v_add_u32 v7, s70, v2
  s_add_u32 s70, s70, 4096
  s_sub_u32 s71, s70, 28672
  s_cselect_b32 s70, s70, s71
  v_add_u32 v8, s70, v2
  s_add_u32 s70, s70, 4096
  s_sub_u32 s71, s70, 28672
  s_cselect_b32 s70, s70, s71
  v_add_u32 v9, s70, v2
  s_add_u32 s70, s70, 4096
  v_lshrrev_b32 v180, 2, v1
  v_and_b32 v180, 4, v180
  v_xor_b32 v180, v180, v1
  v_and_b32 v180, 7, v180
  v_cmp_eq_u32 vcc, 7, v180
  v_lshrrev_b32 v181, 3, v1
  v_mul_u32_u24 v181, 896, v181
  v_lshl_add_u32 v180, v180, 4, v181
  v_mov_b32 v181, 1073741824
  v_cndmask_b32 v180, v180, v181, vcc
  s_mul_i32 s47, s16, 14336
  s_mul_i32 s46, s16, 100352
  s_mul_i32 s71, s20, 112
  s_add_u32 s46, s46, s71
  s_lshr_b32 s25, s19, 1
  s_lshl_b32 s25, s25, 2
  s_and_b32 s70, s19, 1
  s_add_u32 s25, s25, s70
  s_mul_i32 s70, s20, 7
  s_add_u32 s70, s70, s16
  s_mul_i32 s44, s70, 28672
  s_add_u32 s44, s44, 12582912
  s_add_u32 s45, s44, 114688
  s_lshl_b32 s63, s70, 10
  s_add_u32 s63, s63, 14417920
  s_add_u32 s64, s63, 4096
  s_mul_i32 s48, s25, 56
  s_add_u32 s48, s48, s70
  s_lshl_b32 s48, s48, 11
  s_add_u32 s48, s48, 16777216
  s_add_u32 s49, s48, 8192
  s_add_u32 s50, s48, 229376
  s_add_u32 s51, s50, 8192
  s_cmp_eq_u32 s16, 3
  s_cselect_b32 s45, 1073741824, s45
  s_cselect_b32 s64, 1073741824, s64
  s_cselect_b32 s49, 1073741824, s49
  s_cselect_b32 s51, 1073741824, s51
  s_cselect_b64 s[74:75], -1, 0
  v_mov_b32 v252, -1
  v_mov_b32 v253, -1
  v_mov_b32 v254, -1
  v_mov_b32 v255, -1
  s_add_u32 s70, s17, 16
  s_mul_i32 s70, s70, 43
  s_lshr_b32 s70, s70, 7
  s_add_u32 s71, s17, 32
  s_mul_i32 s71, s71, 43
  s_lshr_b32 s71, s71, 7
  s_sub_u32 s71, s71, s70
  s_lshl_b32 s62, s16, 6
  s_add_u32 s70, s70, s62
  v_bfe_u32 v178, v1, 2, 1
  v_mul_u32_u24 v178, s71, v178
  v_and_b32 v179, 3, v1
  v_lshl_add_u32 v178, v179, 4, v178
  v_add_u32 v178, s70, v178
  s_mul_i32 s70, s17, 43
  s_lshr_b32 s70, s70, 7
  s_lshl_b32 s71, s18, 4
  s_add_u32 s70, s70, s71
  v_mov_b32 v179, s70
  v_cmp_gt_u32 vcc, 8, v1
  s_nop 1
  v_cndmask_b32 v178, v179, v178, vcc
  v_lshlrev_b32 v178, 7, v178
  v_add_u32 v178, 11534336, v178
  s_waitcnt vmcnt(0)
  s_branch K1_TOK2
K1_TOK:
  s_waitcnt vmcnt(0)
K1_TOK2:
  v_readfirstlane_b32 s73, v246
  s_nop 0
  s_cmp_lg_u32 s73, 0
  s_cbranch_scc1 K1_TOKOK
  s_add_u32 s72, s72, 1
  s_cmp_gt_u32 s72, 200000
  s_cbranch_scc1 K1_TOKOK
  s_load_dwordx2 s[70:71], s[0:1], 56
  s_waitcnt lgkmcnt(0)
  global_load_dword v246, v247, s[70:71] sc1
  s_branch K1_TOK
K1_TOKOK:
  s_barrier
  buffer_store_dword v246, v247, s[40:43], s12 offen sc1
  buffer_store_dword v246, v247, s[40:43], s13 offen sc1
  ds_read_b64_tr_b16 v[212:213], v230 offset:0
  ds_read_b64_tr_b16 v[214:215], v230 offset:512
  ds_read_b64_tr_b16 v[216:217], v230 offset:1024
  ds_read_b64_tr_b16 v[218:219], v230 offset:1536
  ds_read_b64_tr_b16 v[220:221], v230 offset:2048
  ds_read_b64_tr_b16 v[222:223], v230 offset:2560
  ds_read_b64_tr_b16 v[224:225], v230 offset:3072
  ds_read_b64_tr_b16 v[226:227], v230 offset:3584
  s_lshl_b32 s70, s16, 10
  v_add_u32 v11, s70, v2
  s_and_b32 s70, s16, 1
  s_lshr_b32 s71, s16, 1
  s_lshl_b32 s62, s70, 14
  s_lshl_b32 s3, s71, 13
  s_add_u32 s3, s3, s62
  v_add_u32 v12, s3, v2
  v_or_b32 v14, 512, v2
  s_add_u32 s62, s62, 12288
  v_add_u32 v14, s62, v14
  s_lshl_b32 s62, s71, 14
  s_lshl_b32 s3, s70, 13
  s_add_u32 s3, s3, s62
  v_add_u32 v13, s3, v2
  s_lshl_b32 s62, s16, 8
  s_add_u32 s62, s62, 147456
  v_lshl_add_u32 v15, v1, 2, s62
  s_lshl_b32 s62, s70, 10
  s_add_u32 s62, s62, 147456
  v_lshl_add_u32 v248, v1, 2, s62
  s_lshl_b32 s62, s16, 2
  s_add_u32 s62, s62, 151552
  v_mov_b32 v249, s62
  v_mov_b32 v250, 151552
  s_lshl_b32 s23, s18, 2
  s_add_u32 s23, s23, s70
  s_lshl_b32 s23, s23, 4
  s_add_u32 s23, s23, s17
  s_lshl_b32 s23, s23, 1
  s_add_u32 s23, s23, s71
  s_lshl_b32 s23, s23, 10
  s_add_u32 s23, s23, 6291456
  s_cmp_ge_u32 s16, 2
  s_cselect_b64 s[14:15], s[52:53], 0
  v_lshrrev_b32 v174, 5, v1
  v_and_b32 v251, 31, v1
  v_mul_u32_u24 v251, 896, v251
  v_lshl_add_u32 v251, v174, 4, v251
  s_mul_i32 s60, s25, 28672
  s_mul_i32 s71, s20, 112
  s_add_u32 s60, s60, s71
  s_lshl_b32 s71, s16, 5
  s_add_u32 s60, s60, s71
  s_add_u32 s61, s60, 57344
  s_lshl_b32 s54, s25, 2
  s_add_u32 s54, s54, s16
  s_lshl_b32 s54, s54, 13
  s_add_u32 s54, s54, 6291456
  s_add_u32 s55, s54, 65536
  s_mul_i32 s70, s20, 7
  s_add_u32 s70, s70, s16
  s_lshl_b32 s70, s70, 3
  s_cmp_eq_u32 s16, 3
  s_cselect_b32 s71, 0, 24
  s_cselect_b32 s62, 7, 15
  v_bfe_u32 v181, v1, 3, 1
  v_mul_u32_u24 v181, s71, v181
  v_and_b32 v176, s62, v1
  v_add3_u32 v181, v181, v176, s70
  s_mul_i32 s70, s20, 56
  s_mul_i32 s71, s16, 7
  s_add_u32 s70, s70, s71
  s_add_u32 s70, s70, 448
  v_and_b32 v176, 15, v1
  v_min_u32 v176, 6, v176
  v_mul_u32_u24 v177, 28, v174
  v_add3_u32 v176, v176, v177, s70
  v_cmp_gt_u32 vcc, 16, v1
  s_nop 1
  v_cndmask_b32 v181, v176, v181, vcc
  v_lshlrev_b32 v181, 2, v181
  v_add_u32 v181, 10747904, v181
  v_mov_b32 v176, 0
  v_mov_b32 v177, 0
  v_add_u32 v179, 11599872, v2
  v_lshlrev_b32 v174, 3, v1
  v_add_u32 v174, 122880, v174
  v_bfe_u32 v173, v1, 2, 2
  v_lshrrev_b32 v172, 5, v1
  v_lshl_add_u32 v172, v172, 2, v173
  v_lshlrev_b32 v172, 7, v172
  v_lshrrev_b32 v173, 1, v173
  v_lshl_add_u32 v172, v173, 6, v172
  v_bfe_u32 v173, v1, 4, 1
  v_lshl_add_u32 v172, v173, 5, v172
  v_and_b32 v173, 3, v1
  v_lshl_add_u32 v172, v173, 3, v172
  s_add_u32 s71, s47, 65536
  v_add_u32 v172, s71, v172
  v_xor_b32 v173, 64, v172
  s_lshr_b32 s71, s20, 1
  s_mul_i32 s71, s71, 7
  s_mul_i32 s26, s25, 28
  s_add_u32 s71, s71, s26
  s_lshl_b32 s71, s71, 10
  s_add_u32 s71, s71, 8388608
  s_and_b32 s27, s20, 1
  s_lshl_b32 s26, s27, 2
  s_add_u32 s26, s26, s16
  s_lshl_b32 s26, s26, 10
  s_add_u32 s26, s26, s71
  s_lshl_b32 s27, s27, 3
  s_add_u32 s27, s27, s71
  s_add_u32 s27, s27, 3072
  s_cmp_eq_u32 s16, 3
  s_cselect_b32 s26, 1073741824, s26
  s_cselect_b32 s27, s27, 1073741824
  s_add_u32 s28, s26, 57344
  s_add_u32 s29, s27, 57344
  s_lshl_b32 s30, s25, 3
  s_add_u32 s30, s30, s20
  s_lshl_b32 s30, s30, 2
  s_add_u32 s30, s30, s16
  s_lshl_b32 s30, s30, 8
  s_add_u32 s30, s30, 10223616
  s_add_u32 s31, s30, 16384
  v_and_b32 v182, 31, v1
  v_lshlrev_b32 v182, 3, v182
  s_lshl_b32 s58, s25, 2
  s_add_u32 s58, s58, s16
  s_mul_i32 s56, s58, 7168
  s_add_u32 s56, s56, 8388608
  s_add_u32 s57, s56, 57344
  s_lshl_b32 s58, s58, 11
  s_add_u32 s58, s58, 10223616
  s_add_u32 s59, s58, 16384
  s_mul_i32 s71, s16, 28672
  s_mul_i32 s67, s20, 229376
  s_add_u32 s67, s67, s71
  s_add_u32 s67, s67, 14680064
  s_add_u32 s68, s67, 114688
  s_mul_i32 s65, s25, 114688
  s_add_u32 s65, s65, s71
  s_add_u32 s65, s65, 16777216
  s_add_u32 s66, s65, 229376
  s_waitcnt lgkmcnt(0)
  v_mfma_f32_16x16x32_bf16 v[232:235], v[240:243], v[212:215], 0
  v_mfma_f32_16x16x32_bf16 v[232:235], v[240:243], v[216:219], v[232:235]
  v_mfma_f32_16x16x32_bf16 v[232:235], v[240:243], v[220:223], v[232:235]
  v_mfma_f32_16x16x32_bf16 v[232:235], v[240:243], v[224:227], v[232:235]
  ds_write_b64 v174, v[176:177]
  buffer_store_dwordx4 v[212:215], v2, s[40:43], s8 offen offset:0 sc1
  buffer_store_dwordx4 v[216:219], v2, s[40:43], s8 offen offset:1024 sc1
  buffer_store_dwordx4 v[220:223], v2, s[40:43], s8 offen offset:2048 sc1
  buffer_store_dwordx4 v[224:227], v2, s[40:43], s9 offen offset:3072 sc1
  s_nop 2
  buffer_store_dword v232, v231, s[40:43], s10 offen offset:0 sc1
  buffer_store_dword v233, v231, s[40:43], s10 offen offset:512 sc1
  s_add_u32 m0, s47, 65536
  s_nop 0
  buffer_load_dwordx4 v180, s[4:7], s46 offen offset:0 lds
  s_add_u32 s46, s46, 6144
  buffer_load_dwordx4 v180, s[4:7], s46 offen offset:1024 lds
  s_add_u32 s46, s46, 6144
  buffer_load_dwordx4 v180, s[4:7], s46 offen offset:2048 lds
  s_add_u32 s46, s46, 6144
  buffer_load_dwordx4 v180, s[4:7], s46 offen offset:3072 lds
  s_add_u32 s46, s46, 10240
  s_add_u32 m0, s47, 69632
  s_nop 0
  buffer_load_dwordx4 v180, s[4:7], s46 offen offset:0 lds
  s_add_u32 s46, s46, 6144
  buffer_load_dwordx4 v180, s[4:7], s46 offen offset:1024 lds
  s_add_u32 s46, s46, 6144
KF_QP:
  buffer_load_dword v184, v178, s[40:43], 0 offen sc1
  s_add_u32 s72, s72, 1
  s_waitcnt vmcnt(0)
  v_cmp_ne_u32 vcc, s73, v184
  s_cmp_gt_u32 s72, 200000
  s_cbranch_scc1 KF_QPD
  s_nop 2
  s_cbranch_vccnz KF_QP
KF_QPD:
  s_mov_b32 s72, 0
  buffer_load_dwordx4 v[16:19], v2, s[40:43], s24 offen offset:0 sc1
  buffer_load_dwordx4 v[20:23], v2, s[40:43], s24 offen offset:1024 sc1
  buffer_load_dwordx4 a[0:3], v175, s[40:43], s21 offen offset:0 sc1
  buffer_load_dwordx4 a[4:7], v175, s[40:43], s21 offen offset:1024 sc1
  buffer_load_dwordx4 v[24:27], v2, s[40:43], s24 offen offset:2048 sc1
  buffer_load_dwordx4 v[28:31], v2, s[40:43], s24 offen offset:3072 sc1
  buffer_load_dwordx4 v[32:35], v10, s[40:43], s24 offen offset:0 sc1
  buffer_load_dwordx4 v[36:39], v10, s[40:43], s24 offen offset:1024 sc1
  buffer_load_dwordx4 v[40:43], v10, s[40:43], s24 offen offset:2048 sc1
  buffer_load_dwordx4 v[44:47], v10, s[40:43], s24 offen offset:3072 sc1
  buffer_load_dwordx4 a[8:11], v175, s[40:43], s21 offen offset:2048 sc1
  buffer_load_dwordx4 a[12:15], v175, s[40:43], s21 offen offset:3072 sc1
  s_add_u32 s21, s21, 4096
  buffer_store_dword v246, v247, s[40:43], s11 offen sc1
  buffer_load_dwordx4 a[16:19], v175, s[40:43], s21 offen offset:0 sc1
  buffer_load_dwordx4 a[20:23], v175, s[40:43], s21 offen offset:1024 sc1
  buffer_load_dwordx4 a[24:27], v175, s[40:43], s21 offen offset:2048 sc1
  buffer_load_dwordx4 a[28:31], v175, s[40:43], s21 offen offset:3072 sc1
  s_add_u32 s21, s21, 4096
  s_waitcnt vmcnt(12)
  v_mfma_f32_32x32x16_bf16 v[48:63], a[0:3], v[16:19], 0
  v_mfma_f32_32x32x16_bf16 v[48:63], a[4:7], v[20:23], v[48:63]
  s_waitcnt vmcnt(10)
  v_mfma_f32_32x32x16_bf16 v[64:79], a[0:3], v[24:27], 0
  v_mfma_f32_32x32x16_bf16 v[64:79], a[4:7], v[28:31], v[64:79]
  s_waitcnt vmcnt(8)
  v_mfma_f32_32x32x16_bf16 v[80:95], a[0:3], v[32:35], 0
  v_mfma_f32_32x32x16_bf16 v[80:95], a[4:7], v[36:39], v[80:95]
  s_waitcnt vmcnt(6)
  v_mfma_f32_32x32x16_bf16 v[96:111], a[0:3], v[40:43], 0
  v_mfma_f32_32x32x16_bf16 v[96:111], a[4:7], v[44:47], v[96:111]
  buffer_load_dwordx4 a[32:35], v175, s[40:43], s21 offen offset:0 sc1
  buffer_load_dwordx4 a[36:39], v175, s[40:43], s21 offen offset:1024 sc1
  buffer_load_dwordx4 a[40:43], v175, s[40:43], s21 offen offset:2048 sc1
  buffer_load_dwordx4 a[44:47], v175, s[40:43], s21 offen offset:3072 sc1
  s_add_u32 s21, s21, 4096
  v_max3_f32 v156, v48, v49, v50
  v_max3_f32 v156, v156, v51, v52
  v_max3_f32 v156, v156, v53, v54
  v_max3_f32 v156, v156, v55, v56
  v_max3_f32 v156, v156, v57, v58
  v_max3_f32 v156, v156, v59, v60
  v_max3_f32 v156, v156, v61, v62
  v_max_f32 v156, v156, v63
  v_mov_b32 v160, v156
  s_nop 1
  v_permlane32_swap_b32 v156, v160
  v_max_f32 v156, v156, v160
  v_max3_f32 v157, v64, v65, v66
  v_max3_f32 v157, v157, v67, v68
  v_max3_f32 v157, v157, v69, v70
  v_max3_f32 v157, v157, v71, v72
  v_max3_f32 v157, v157, v73, v74
  v_max3_f32 v157, v157, v75, v76
  v_max3_f32 v157, v157, v77, v78
  v_max_f32 v157, v157, v79
  v_mov_b32 v161, v157
  s_nop 1
  v_permlane32_swap_b32 v157, v161
  v_max_f32 v157, v157, v161
  v_max3_f32 v158, v80, v81, v82
  v_max3_f32 v158, v158, v83, v84
  v_max3_f32 v158, v158, v85, v86
  v_max3_f32 v158, v158, v87, v88
  v_max3_f32 v158, v158, v89, v90
  v_max3_f32 v158, v158, v91, v92
  v_max3_f32 v158, v158, v93, v94
  v_max_f32 v158, v158, v95
  v_mov_b32 v162, v158
  s_nop 1
  v_permlane32_swap_b32 v158, v162
  v_max_f32 v158, v158, v162
  v_max3_f32 v159, v96, v97, v98
  v_max3_f32 v159, v159, v99, v100
  v_max3_f32 v159, v159, v101, v102
  v_max3_f32 v159, v159, v103, v104
  v_max3_f32 v159, v159, v105, v106
  v_max3_f32 v159, v159, v107, v108
  v_max3_f32 v159, v159, v109, v110
  v_max_f32 v159, v159, v111
  v_mov_b32 v163, v159
  s_nop 1
  v_permlane32_swap_b32 v159, v163
  v_max_f32 v159, v159, v163
  v_cvt_pk_bf16_f32 v156, -v156, -v156
  v_and_b32 v152, 0xffff0000, v156
  v_and_b32 v156, 0xffff, v156
  v_cndmask_b32 v22, v22, v156, s[52:53]
  v_cvt_pk_bf16_f32 v157, -v157, -v157
  v_and_b32 v153, 0xffff0000, v157
  v_and_b32 v157, 0xffff, v157
  v_cndmask_b32 v30, v30, v157, s[52:53]
  v_cvt_pk_bf16_f32 v158, -v158, -v158
  v_and_b32 v154, 0xffff0000, v158
  v_and_b32 v158, 0xffff, v158
  v_cndmask_b32 v38, v38, v158, s[52:53]
  v_cvt_pk_bf16_f32 v159, -v159, -v159
  v_and_b32 v155, 0xffff0000, v159
  v_and_b32 v159, 0xffff, v159
  v_cndmask_b32 v46, v46, v159, s[52:53]
  v_mfma_f32_32x32x16_bf16 v[112:127], a[0:3], v[16:19], 0
  v_mfma_f32_32x32x16_bf16 v[112:127], a[4:7], v[20:23], v[112:127]
  v_mfma_f32_32x32x16_bf16 v[128:143], a[0:3], v[24:27], 0
  buffer_load_dwordx4 a[48:51], v175, s[40:43], s21 offen offset:0 sc1
  s_nop 9
  v_exp_f32 v112, v112
  v_exp_f32 v113, v113
  v_exp_f32 v114, v114
  v_exp_f32 v115, v115
  v_cvt_pk_bf16_f32 v144, v112, v113
  v_cvt_pk_bf16_f32 v145, v114, v115
  buffer_load_dwordx4 a[52:55], v175, s[40:43], s21 offen offset:1024 sc1
  v_exp_f32 v116, v116
  v_exp_f32 v117, v117
  v_exp_f32 v118, v118
  v_exp_f32 v119, v119
  v_cvt_pk_bf16_f32 v146, v116, v117
  v_cvt_pk_bf16_f32 v147, v118, v119
  v_mfma_f32_32x32x16_bf16 v[128:143], a[4:7], v[28:31], v[128:143]
  v_exp_f32 v120, v120
  v_exp_f32 v121, v121
  v_exp_f32 v122, v122
  v_exp_f32 v123, v123
  v_cvt_pk_bf16_f32 v148, v120, v121
  v_cvt_pk_bf16_f32 v149, v122, v123
  s_waitcnt vmcnt(10)
  v_mfma_f32_32x32x16_bf16 v[48:63], a[8:11], v[144:147], 0
  buffer_load_dwordx4 a[56:59], v175, s[40:43], s21 offen offset:2048 sc1
  v_exp_f32 v124, v124
  v_exp_f32 v125, v125
  v_exp_f32 v126, v126
  v_exp_f32 v127, v127
  v_cvt_pk_bf16_f32 v150, v124, v125
  v_cvt_pk_bf16_f32 v151, v126, v127
  s_waitcnt vmcnt(9)
  v_mfma_f32_32x32x16_bf16 v[112:127], a[16:19], v[16:19], 0
  buffer_load_dwordx4 a[60:63], v175, s[40:43], s21 offen offset:3072 sc1
  s_add_u32 s21, s21, 4096
  v_exp_f32 v128, v128
  v_exp_f32 v129, v129
  v_exp_f32 v130, v130
  v_exp_f32 v131, v131
  v_cvt_pk_bf16_f32 v144, v128, v129
  v_cvt_pk_bf16_f32 v145, v130, v131
  v_mfma_f32_32x32x16_bf16 v[48:63], a[12:15], v[148:151], v[48:63]
  buffer_load_dwordx4 a[64:67], v175, s[40:43], s21 offen offset:0 sc1
  v_exp_f32 v132, v132
  v_exp_f32 v133, v133
  v_exp_f32 v134, v134
  v_exp_f32 v135, v135
  v_cvt_pk_bf16_f32 v146, v132, v133
  v_cvt_pk_bf16_f32 v147, v134, v135
  v_mfma_f32_32x32x16_bf16 v[112:127], a[20:23], v[20:23], v[112:127]
  v_exp_f32 v136, v136
  v_exp_f32 v137, v137
  v_exp_f32 v138, v138
  v_exp_f32 v139, v139
  v_cvt_pk_bf16_f32 v148, v136, v137
  v_cvt_pk_bf16_f32 v149, v138, v139
  v_mfma_f32_32x32x16_bf16 v[64:79], a[8:11], v[144:147], 0
  buffer_load_dwordx4 a[68:71], v175, s[40:43], s21 offen offset:1024 sc1
  v_exp_f32 v140, v140
  v_exp_f32 v141, v141
  v_exp_f32 v142, v142
  v_exp_f32 v143, v143
  v_cvt_pk_bf16_f32 v150, v140, v141
  v_cvt_pk_bf16_f32 v151, v142, v143
  v_mfma_f32_32x32x16_bf16 v[128:143], a[16:19], v[24:27], 0
  buffer_load_dwordx4 a[72:75], v175, s[40:43], s21 offen offset:2048 sc1
  v_exp_f32 v112, v112
  v_exp_f32 v113, v113
  v_exp_f32 v114, v114
  v_exp_f32 v115, v115
  v_cvt_pk_bf16_f32 v144, v112, v113
  v_cvt_pk_bf16_f32 v145, v114, v115
  v_mfma_f32_32x32x16_bf16 v[64:79], a[12:15], v[148:151], v[64:79]
  buffer_load_dwordx4 a[76:79], v175, s[40:43], s21 offen offset:3072 sc1
  s_add_u32 s21, s21, 4096
  v_exp_f32 v116, v116
  v_exp_f32 v117, v117
  v_exp_f32 v118, v118
  v_exp_f32 v119, v119
  v_cvt_pk_bf16_f32 v146, v116, v117
  v_cvt_pk_bf16_f32 v147, v118, v119
  v_mfma_f32_32x32x16_bf16 v[128:143], a[20:23], v[28:31], v[128:143]
  v_exp_f32 v120, v120
  v_exp_f32 v121, v121
  v_exp_f32 v122, v122
  v_exp_f32 v123, v123
  v_cvt_pk_bf16_f32 v148, v120, v121
  v_cvt_pk_bf16_f32 v149, v122, v123
  s_waitcnt vmcnt(12)
  v_mfma_f32_32x32x16_bf16 v[48:63], a[24:27], v[144:147], v[48:63]
  buffer_load_dwordx4 a[80:83], v175, s[40:43], s21 offen offset:0 sc1
  v_exp_f32 v124, v124
  v_exp_f32 v125, v125
  v_exp_f32 v126, v126
  v_exp_f32 v127, v127
  v_cvt_pk_bf16_f32 v150, v124, v125
  v_cvt_pk_bf16_f32 v151, v126, v127
  s_waitcnt vmcnt(11)
  v_mfma_f32_32x32x16_bf16 v[112:127], a[32:35], v[16:19], 0
  buffer_load_dwordx4 a[84:87], v175, s[40:43], s21 offen offset:1024 sc1
  v_exp_f32 v128, v128
  v_exp_f32 v129, v129
  v_exp_f32 v130, v130
  v_exp_f32 v131, v131
  v_cvt_pk_bf16_f32 v144, v128, v129
  v_cvt_pk_bf16_f32 v145, v130, v131
  v_mfma_f32_32x32x16_bf16 v[48:63], a[28:31], v[148:151], v[48:63]
  buffer_load_dwordx4 a[88:91], v175, s[40:43], s21 offen offset:2048 sc1
  v_exp_f32 v132, v132
  v_exp_f32 v133, v133
  v_exp_f32 v134, v134
  v_exp_f32 v135, v135
  v_cvt_pk_bf16_f32 v146, v132, v133
  v_cvt_pk_bf16_f32 v147, v134, v135
  v_mfma_f32_32x32x16_bf16 v[112:127], a[36:39], v[20:23], v[112:127]
  v_exp_f32 v136, v136
  v_exp_f32 v137, v137
  v_exp_f32 v138, v138
  v_exp_f32 v139, v139
  v_cvt_pk_bf16_f32 v148, v136, v137
  v_cvt_pk_bf16_f32 v149, v138, v139
  v_mfma_f32_32x32x16_bf16 v[64:79], a[24:27], v[144:147], v[64:79]
  buffer_load_dwordx4 a[92:95], v175, s[40:43], s21 offen offset:3072 sc1
  s_add_u32 s21, s21, 4096
  v_exp_f32 v140, v140
  v_exp_f32 v141, v141
  v_exp_f32 v142, v142
  v_exp_f32 v143, v143
  v_cvt_pk_bf16_f32 v150, v140, v141
  v_cvt_pk_bf16_f32 v151, v142, v143
  v_mfma_f32_32x32x16_bf16 v[128:143], a[32:35], v[24:27], 0
  buffer_load_dwordx4 a[96:99], v175, s[40:43], s21 offen offset:0 sc1
  v_exp_f32 v112, v112
  v_exp_f32 v113, v113
  v_exp_f32 v114, v114
  v_exp_f32 v115, v115
  v_cvt_pk_bf16_f32 v144, v112, v113
  v_cvt_pk_bf16_f32 v145, v114, v115
  v_mfma_f32_32x32x16_bf16 v[64:79], a[28:31], v[148:151], v[64:79]
  buffer_load_dwordx4 a[100:103], v175, s[40:43], s21 offen offset:1024 sc1
  v_exp_f32 v116, v116
  v_exp_f32 v117, v117
  v_exp_f32 v118, v118
  v_exp_f32 v119, v119
  v_cvt_pk_bf16_f32 v146, v116, v117
  v_cvt_pk_bf16_f32 v147, v118, v119
  v_mfma_f32_32x32x16_bf16 v[128:143], a[36:39], v[28:31], v[128:143]
  v_exp_f32 v120, v120
  v_exp_f32 v121, v121
  v_exp_f32 v122, v122
  v_exp_f32 v123, v123
  v_cvt_pk_bf16_f32 v148, v120, v121
  v_cvt_pk_bf16_f32 v149, v122, v123
  s_waitcnt vmcnt(14)
  v_mfma_f32_32x32x16_bf16 v[48:63], a[40:43], v[144:147], v[48:63]
  buffer_load_dwordx4 a[104:107], v175, s[40:43], s21 offen offset:2048 sc1
  v_exp_f32 v124, v124
  v_exp_f32 v125, v125
  v_exp_f32 v126, v126
  v_exp_f32 v127, v127
  v_cvt_pk_bf16_f32 v150, v124, v125
  v_cvt_pk_bf16_f32 v151, v126, v127
  s_waitcnt vmcnt(13)
  v_mfma_f32_32x32x16_bf16 v[112:127], a[48:51], v[16:19], 0
  buffer_load_dwordx4 a[108:111], v175, s[40:43], s21 offen offset:3072 sc1
  s_add_u32 s21, s21, 4096
  v_exp_f32 v128, v128
  v_exp_f32 v129, v129
  v_exp_f32 v130, v130
  v_exp_f32 v131, v131
  v_cvt_pk_bf16_f32 v144, v128, v129
  v_cvt_pk_bf16_f32 v145, v130, v131
  v_mfma_f32_32x32x16_bf16 v[48:63], a[44:47], v[148:151], v[48:63]
  buffer_load_dwordx4 a[112:115], v175, s[40:43], s21 offen offset:0 sc1
  v_exp_f32 v132, v132
  v_exp_f32 v133, v133
  v_exp_f32 v134, v134
  v_exp_f32 v135, v135
  v_cvt_pk_bf16_f32 v146, v132, v133
  v_cvt_pk_bf16_f32 v147, v134, v135
  v_mfma_f32_32x32x16_bf16 v[112:127], a[52:55], v[20:23], v[112:127]
  v_exp_f32 v136, v136
  v_exp_f32 v137, v137
  v_exp_f32 v138, v138
  v_exp_f32 v139, v139
  v_cvt_pk_bf16_f32 v148, v136, v137
  v_cvt_pk_bf16_f32 v149, v138, v139
  v_mfma_f32_32x32x16_bf16 v[64:79], a[40:43], v[144:147], v[64:79]
  buffer_load_dwordx4 a[116:119], v175, s[40:43], s21 offen offset:1024 sc1
  v_exp_f32 v140, v140
  v_exp_f32 v141, v141
  v_exp_f32 v142, v142
  v_exp_f32 v143, v143
  v_cvt_pk_bf16_f32 v150, v140, v141
  v_cvt_pk_bf16_f32 v151, v142, v143
  v_mfma_f32_32x32x16_bf16 v[128:143], a[48:51], v[24:27], 0
  buffer_load_dwordx4 a[120:123], v175, s[40:43], s21 offen offset:2048 sc1
  v_exp_f32 v112, v112
  v_exp_f32 v113, v113
  v_exp_f32 v114, v114
  v_exp_f32 v115, v115
  v_cvt_pk_bf16_f32 v144, v112, v113
  v_cvt_pk_bf16_f32 v145, v114, v115
  v_mfma_f32_32x32x16_bf16 v[64:79], a[44:47], v[148:151], v[64:79]
  buffer_load_dwordx4 a[124:127], v175, s[40:43], s21 offen offset:3072 sc1
  s_add_u32 s21, s21, 4096
  v_exp_f32 v116, v116
  v_exp_f32 v117, v117
  v_exp_f32 v118, v118
  v_exp_f32 v119, v119
  v_cvt_pk_bf16_f32 v146, v116, v117
  v_cvt_pk_bf16_f32 v147, v118, v119
  v_mfma_f32_32x32x16_bf16 v[128:143], a[52:55], v[28:31], v[128:143]
  v_exp_f32 v120, v120
  v_exp_f32 v121, v121
  v_exp_f32 v122, v122
  v_exp_f32 v123, v123
  v_cvt_pk_bf16_f32 v148, v120, v121
  v_cvt_pk_bf16_f32 v149, v122, v123
  s_waitcnt vmcnt(16)
  v_mfma_f32_32x32x16_bf16 v[48:63], a[56:59], v[144:147], v[48:63]
  buffer_load_dwordx4 a[128:131], v175, s[40:43], s21 offen offset:0 sc1
  v_exp_f32 v124, v124
  v_exp_f32 v125, v125
  v_exp_f32 v126, v126
  v_exp_f32 v127, v127
  v_cvt_pk_bf16_f32 v150, v124, v125
  v_cvt_pk_bf16_f32 v151, v126, v127
  s_waitcnt vmcnt(15)
  v_mfma_f32_32x32x16_bf16 v[112:127], a[64:67], v[16:19], 0
  buffer_load_dwordx4 a[132:135], v175, s[40:43], s21 offen offset:1024 sc1
  v_exp_f32 v128, v128
  v_exp_f32 v129, v129
  v_exp_f32 v130, v130
  v_exp_f32 v131, v131
  v_cvt_pk_bf16_f32 v144, v128, v129
  v_cvt_pk_bf16_f32 v145, v130, v131
  v_mfma_f32_32x32x16_bf16 v[48:63], a[60:63], v[148:151], v[48:63]
  buffer_load_dwordx4 a[136:139], v175, s[40:43], s21 offen offset:2048 sc1
  v_exp_f32 v132, v132
  v_exp_f32 v133, v133
  v_exp_f32 v134, v134
  v_exp_f32 v135, v135
  v_cvt_pk_bf16_f32 v146, v132, v133
  v_cvt_pk_bf16_f32 v147, v134, v135
  v_mfma_f32_32x32x16_bf16 v[112:127], a[68:71], v[20:23], v[112:127]
  v_exp_f32 v136, v136
  v_exp_f32 v137, v137
  v_exp_f32 v138, v138
  v_exp_f32 v139, v139
  v_cvt_pk_bf16_f32 v148, v136, v137
  v_cvt_pk_bf16_f32 v149, v138, v139
  v_mfma_f32_32x32x16_bf16 v[64:79], a[56:59], v[144:147], v[64:79]
  buffer_load_dwordx4 a[140:143], v175, s[40:43], s21 offen offset:3072 sc1
  s_add_u32 s21, s21, 4096
  v_exp_f32 v140, v140
  v_exp_f32 v141, v141
  v_exp_f32 v142, v142
  v_exp_f32 v143, v143
  v_cvt_pk_bf16_f32 v150, v140, v141
  v_cvt_pk_bf16_f32 v151, v142, v143
  v_mfma_f32_32x32x16_bf16 v[128:143], a[64:67], v[24:27], 0
  buffer_load_dwordx4 a[144:147], v175, s[40:43], s21 offen offset:0 sc1
  v_exp_f32 v112, v112
  v_exp_f32 v113, v113
  v_exp_f32 v114, v114
  v_exp_f32 v115, v115
  v_cvt_pk_bf16_f32 v144, v112, v113
  v_cvt_pk_bf16_f32 v145, v114, v115
  v_mfma_f32_32x32x16_bf16 v[64:79], a[60:63], v[148:151], v[64:79]
  buffer_load_dwordx4 a[148:151], v175, s[40:43], s21 offen offset:1024 sc1
  v_exp_f32 v116, v116
  v_exp_f32 v117, v117
  v_exp_f32 v118, v118
  v_exp_f32 v119, v119
  v_cvt_pk_bf16_f32 v146, v116, v117
  v_cvt_pk_bf16_f32 v147, v118, v119
  v_mfma_f32_32x32x16_bf16 v[128:143], a[68:71], v[28:31], v[128:143]
  v_exp_f32 v120, v120
  v_exp_f32 v121, v121
  v_exp_f32 v122, v122
  v_exp_f32 v123, v123
  v_cvt_pk_bf16_f32 v148, v120, v121
  v_cvt_pk_bf16_f32 v149, v122, v123
  s_waitcnt vmcnt(18)
  v_mfma_f32_32x32x16_bf16 v[48:63], a[72:75], v[144:147], v[48:63]
  buffer_load_dwordx4 a[152:155], v175, s[40:43], s21 offen offset:2048 sc1
  v_exp_f32 v124, v124
  v_exp_f32 v125, v125
  v_exp_f32 v126, v126
  v_exp_f32 v127, v127
  v_cvt_pk_bf16_f32 v150, v124, v125
  v_cvt_pk_bf16_f32 v151, v126, v127
  s_waitcnt vmcnt(17)
  v_mfma_f32_32x32x16_bf16 v[112:127], a[80:83], v[16:19], 0
  buffer_load_dwordx4 a[156:159], v175, s[40:43], s21 offen offset:3072 sc1
  s_add_u32 s21, s21, 4096
  v_exp_f32 v128, v128
  v_exp_f32 v129, v129
  v_exp_f32 v130, v130
  v_exp_f32 v131, v131
  v_cvt_pk_bf16_f32 v144, v128, v129
  v_cvt_pk_bf16_f32 v145, v130, v131
  v_mfma_f32_32x32x16_bf16 v[48:63], a[76:79], v[148:151], v[48:63]
  buffer_load_dwordx4 a[160:163], v175, s[40:43], s21 offen offset:0 sc1
  v_exp_f32 v132, v132
  v_exp_f32 v133, v133
  v_exp_f32 v134, v134
  v_exp_f32 v135, v135
  v_cvt_pk_bf16_f32 v146, v132, v133
  v_cvt_pk_bf16_f32 v147, v134, v135
  v_mfma_f32_32x32x16_bf16 v[112:127], a[84:87], v[20:23], v[112:127]
  v_exp_f32 v136, v136
  v_exp_f32 v137, v137
  v_exp_f32 v138, v138
  v_exp_f32 v139, v139
  v_cvt_pk_bf16_f32 v148, v136, v137
  v_cvt_pk_bf16_f32 v149, v138, v139
  v_mfma_f32_32x32x16_bf16 v[64:79], a[72:75], v[144:147], v[64:79]
  buffer_load_dwordx4 a[164:167], v175, s[40:43], s21 offen offset:1024 sc1
  v_exp_f32 v140, v140
  v_exp_f32 v141, v141
  v_exp_f32 v142, v142
  v_exp_f32 v143, v143
  v_cvt_pk_bf16_f32 v150, v140, v141
  v_cvt_pk_bf16_f32 v151, v142, v143
  v_mfma_f32_32x32x16_bf16 v[128:143], a[80:83], v[24:27], 0
  buffer_load_dwordx4 a[168:171], v175, s[40:43], s21 offen offset:2048 sc1
  v_exp_f32 v112, v112
  v_exp_f32 v113, v113
  v_exp_f32 v114, v114
  v_exp_f32 v115, v115
  v_cvt_pk_bf16_f32 v144, v112, v113
  v_cvt_pk_bf16_f32 v145, v114, v115
  v_mfma_f32_32x32x16_bf16 v[64:79], a[76:79], v[148:151], v[64:79]
  buffer_load_dwordx4 a[172:175], v175, s[40:43], s21 offen offset:3072 sc1
  s_add_u32 s21, s21, 4096
  v_exp_f32 v116, v116
  v_exp_f32 v117, v117
  v_exp_f32 v118, v118
  v_exp_f32 v119, v119
  v_cvt_pk_bf16_f32 v146, v116, v117
  v_cvt_pk_bf16_f32 v147, v118, v119
  v_mfma_f32_32x32x16_bf16 v[128:143], a[84:87], v[28:31], v[128:143]
  v_exp_f32 v120, v120
  v_exp_f32 v121, v121
  v_exp_f32 v122, v122
  v_exp_f32 v123, v123
  v_cvt_pk_bf16_f32 v148, v120, v121
  v_cvt_pk_bf16_f32 v149, v122, v123
  s_waitcnt vmcnt(20)
  v_mfma_f32_32x32x16_bf16 v[48:63], a[88:91], v[144:147], v[48:63]
  buffer_load_dwordx4 a[176:179], v175, s[40:43], s21 offen offset:0 sc1
  v_exp_f32 v124, v124
  v_exp_f32 v125, v125
  v_exp_f32 v126, v126
  v_exp_f32 v127, v127
  v_cvt_pk_bf16_f32 v150, v124, v125
  v_cvt_pk_bf16_f32 v151, v126, v127
  s_waitcnt vmcnt(19)
  v_mfma_f32_32x32x16_bf16 v[112:127], a[96:99], v[16:19], 0
  buffer_load_dwordx4 a[180:183], v175, s[40:43], s21 offen offset:1024 sc1
  v_exp_f32 v128, v128
  v_exp_f32 v129, v129
  v_exp_f32 v130, v130
  v_exp_f32 v131, v131
  v_cvt_pk_bf16_f32 v144, v128, v129
  v_cvt_pk_bf16_f32 v145, v130, v131
  v_mfma_f32_32x32x16_bf16 v[48:63], a[92:95], v[148:151], v[48:63]
  buffer_load_dwordx4 a[184:187], v175, s[40:43], s21 offen offset:2048 sc1
  v_exp_f32 v132, v132
  v_exp_f32 v133, v133
  v_exp_f32 v134, v134
  v_exp_f32 v135, v135
  v_cvt_pk_bf16_f32 v146, v132, v133
  v_cvt_pk_bf16_f32 v147, v134, v135
  v_mfma_f32_32x32x16_bf16 v[112:127], a[100:103], v[20:23], v[112:127]
  v_exp_f32 v136, v136
  v_exp_f32 v137, v137
  v_exp_f32 v138, v138
  v_exp_f32 v139, v139
  v_cvt_pk_bf16_f32 v148, v136, v137
  v_cvt_pk_bf16_f32 v149, v138, v139
  v_mfma_f32_32x32x16_bf16 v[64:79], a[88:91], v[144:147], v[64:79]
  buffer_load_dwordx4 a[188:191], v175, s[40:43], s21 offen offset:3072 sc1
  s_add_u32 s21, s21, 4096
  v_exp_f32 v140, v140
  v_exp_f32 v141, v141
  v_exp_f32 v142, v142
  v_exp_f32 v143, v143
  v_cvt_pk_bf16_f32 v150, v140, v141
  v_cvt_pk_bf16_f32 v151, v142, v143
  v_mfma_f32_32x32x16_bf16 v[128:143], a[96:99], v[24:27], 0
  buffer_load_dwordx4 a[192:195], v175, s[40:43], s21 offen offset:0 sc1
  v_exp_f32 v112, v112
  v_exp_f32 v113, v113
  v_exp_f32 v114, v114
  v_exp_f32 v115, v115
  v_cvt_pk_bf16_f32 v144, v112, v113
  v_cvt_pk_bf16_f32 v145, v114, v115
  v_mfma_f32_32x32x16_bf16 v[64:79], a[92:95], v[148:151], v[64:79]
  v_exp_f32 v116, v116
  v_exp_f32 v117, v117
  v_exp_f32 v118, v118
  v_exp_f32 v119, v119
  v_cvt_pk_bf16_f32 v146, v116, v117
  v_cvt_pk_bf16_f32 v147, v118, v119
  v_mfma_f32_32x32x16_bf16 v[128:143], a[100:103], v[28:31], v[128:143]
  v_exp_f32 v120, v120
  v_exp_f32 v121, v121
  v_exp_f32 v122, v122
  v_exp_f32 v123, v123
  v_cvt_pk_bf16_f32 v148, v120, v121
  v_cvt_pk_bf16_f32 v149, v122, v123
  s_waitcnt vmcnt(21)
  v_mfma_f32_32x32x16_bf16 v[48:63], a[104:107], v[144:147], v[48:63]
  buffer_load_dwordx4 a[196:199], v175, s[40:43], s21 offen offset:1024 sc1
  v_exp_f32 v124, v124
  v_exp_f32 v125, v125
  v_exp_f32 v126, v126
  v_exp_f32 v127, v127
  v_cvt_pk_bf16_f32 v150, v124, v125
  v_cvt_pk_bf16_f32 v151, v126, v127
  s_waitcnt vmcnt(20)
  v_mfma_f32_32x32x16_bf16 v[112:127], a[112:115], v[16:19], 0
  buffer_load_dwordx4 a[200:203], v175, s[40:43], s21 offen offset:2048 sc1
  v_exp_f32 v128, v128
  v_exp_f32 v129, v129
  v_exp_f32 v130, v130
  v_exp_f32 v131, v131
  v_cvt_pk_bf16_f32 v144, v128, v129
  v_cvt_pk_bf16_f32 v145, v130, v131
  v_mfma_f32_32x32x16_bf16 v[48:63], a[108:111], v[148:151], v[48:63]
  v_exp_f32 v132, v132
  v_exp_f32 v133, v133
  v_exp_f32 v134, v134
  v_exp_f32 v135, v135
  v_cvt_pk_bf16_f32 v146, v132, v133
  v_cvt_pk_bf16_f32 v147, v134, v135
  v_mfma_f32_32x32x16_bf16 v[112:127], a[116:119], v[20:23], v[112:127]
  v_exp_f32 v136, v136
  v_exp_f32 v137, v137
  v_exp_f32 v138, v138
  v_exp_f32 v139, v139
  v_cvt_pk_bf16_f32 v148, v136, v137
  v_cvt_pk_bf16_f32 v149, v138, v139
  v_mfma_f32_32x32x16_bf16 v[64:79], a[104:107], v[144:147], v[64:79]
  buffer_load_dwordx4 a[204:207], v175, s[40:43], s21 offen offset:3072 sc1
  s_add_u32 s21, s21, 4096
  v_exp_f32 v140, v140
  v_exp_f32 v141, v141
  v_exp_f32 v142, v142
  v_exp_f32 v143, v143
  v_cvt_pk_bf16_f32 v150, v140, v141
  v_cvt_pk_bf16_f32 v151, v142, v143
  v_mfma_f32_32x32x16_bf16 v[128:143], a[112:115], v[24:27], 0
  buffer_load_dwordx4 a[208:211], v175, s[40:43], s21 offen offset:0 sc1
  v_exp_f32 v112, v112
  v_exp_f32 v113, v113
  v_exp_f32 v114, v114
  v_exp_f32 v115, v115
  v_cvt_pk_bf16_f32 v144, v112, v113
  v_cvt_pk_bf16_f32 v145, v114, v115
  v_mfma_f32_32x32x16_bf16 v[64:79], a[108:111], v[148:151], v[64:79]
  v_exp_f32 v116, v116
  v_exp_f32 v117, v117
  v_exp_f32 v118, v118
  v_exp_f32 v119, v119
  v_cvt_pk_bf16_f32 v146, v116, v117
  v_cvt_pk_bf16_f32 v147, v118, v119
  v_mfma_f32_32x32x16_bf16 v[128:143], a[116:119], v[28:31], v[128:143]
  v_exp_f32 v120, v120
  v_exp_f32 v121, v121
  v_exp_f32 v122, v122
  v_exp_f32 v123, v123
  v_cvt_pk_bf16_f32 v148, v120, v121
  v_cvt_pk_bf16_f32 v149, v122, v123
  s_waitcnt vmcnt(21)
  v_mfma_f32_32x32x16_bf16 v[48:63], a[120:123], v[144:147], v[48:63]
  buffer_load_dwordx4 a[212:215], v175, s[40:43], s21 offen offset:1024 sc1
  v_exp_f32 v124, v124
  v_exp_f32 v125, v125
  v_exp_f32 v126, v126
  v_exp_f32 v127, v127
  v_cvt_pk_bf16_f32 v150, v124, v125
  v_cvt_pk_bf16_f32 v151, v126, v127
  s_waitcnt vmcnt(20)
  v_mfma_f32_32x32x16_bf16 v[112:127], a[128:131], v[16:19], 0
  buffer_load_dwordx4 a[216:219], v175, s[40:43], s21 offen offset:2048 sc1
  v_exp_f32 v128, v128
  v_exp_f32 v129, v129
  v_exp_f32 v130, v130
  v_exp_f32 v131, v131
  v_cvt_pk_bf16_f32 v144, v128, v129
  v_cvt_pk_bf16_f32 v145, v130, v131
  v_mfma_f32_32x32x16_bf16 v[48:63], a[124:127], v[148:151], v[48:63]
  buffer_store_dwordx4 v[252:255], v2, s[40:43], s48 offen offset:0 sc1
  v_exp_f32 v132, v132
  v_exp_f32 v133, v133
  v_exp_f32 v134, v134
  v_exp_f32 v135, v135
  v_cvt_pk_bf16_f32 v146, v132, v133
  v_cvt_pk_bf16_f32 v147, v134, v135
  v_mfma_f32_32x32x16_bf16 v[112:127], a[132:135], v[20:23], v[112:127]
  v_exp_f32 v136, v136
  v_exp_f32 v137, v137
  v_exp_f32 v138, v138
  v_exp_f32 v139, v139
  v_cvt_pk_bf16_f32 v148, v136, v137
  v_cvt_pk_bf16_f32 v149, v138, v139
  v_mfma_f32_32x32x16_bf16 v[64:79], a[120:123], v[144:147], v[64:79]
  buffer_load_dwordx4 a[220:223], v175, s[40:43], s21 offen offset:3072 sc1
  s_add_u32 s21, s21, 4096
  v_exp_f32 v140, v140
  v_exp_f32 v141, v141
  v_exp_f32 v142, v142
  v_exp_f32 v143, v143
  v_cvt_pk_bf16_f32 v150, v140, v141
  v_cvt_pk_bf16_f32 v151, v142, v143
  v_mfma_f32_32x32x16_bf16 v[128:143], a[128:131], v[24:27], 0
  buffer_load_dwordx4 a[224:227], v175, s[40:43], s21 offen offset:0 sc1
  v_exp_f32 v112, v112
  v_exp_f32 v113, v113
  v_exp_f32 v114, v114
  v_exp_f32 v115, v115
  v_cvt_pk_bf16_f32 v144, v112, v113
  v_cvt_pk_bf16_f32 v145, v114, v115
  v_mfma_f32_32x32x16_bf16 v[64:79], a[124:127], v[148:151], v[64:79]
  v_exp_f32 v116, v116
  v_exp_f32 v117, v117
  v_exp_f32 v118, v118
  v_exp_f32 v119, v119
  v_cvt_pk_bf16_f32 v146, v116, v117
  v_cvt_pk_bf16_f32 v147, v118, v119
  v_mfma_f32_32x32x16_bf16 v[128:143], a[132:135], v[28:31], v[128:143]
  v_exp_f32 v120, v120
  v_exp_f32 v121, v121
  v_exp_f32 v122, v122
  v_exp_f32 v123, v123
  v_cvt_pk_bf16_f32 v148, v120, v121
  v_cvt_pk_bf16_f32 v149, v122, v123
  s_waitcnt vmcnt(21)
  v_mfma_f32_32x32x16_bf16 v[48:63], a[136:139], v[144:147], v[48:63]
  buffer_load_dwordx4 a[228:231], v175, s[40:43], s21 offen offset:1024 sc1
  v_exp_f32 v124, v124
  v_exp_f32 v125, v125
  v_exp_f32 v126, v126
  v_exp_f32 v127, v127
  v_cvt_pk_bf16_f32 v150, v124, v125
  v_cvt_pk_bf16_f32 v151, v126, v127
  s_waitcnt vmcnt(20)
  v_mfma_f32_32x32x16_bf16 v[112:127], a[144:147], v[16:19], 0
  buffer_load_dwordx4 a[232:235], v175, s[40:43], s21 offen offset:2048 sc1
  v_exp_f32 v128, v128
  v_exp_f32 v129, v129
  v_exp_f32 v130, v130
  v_exp_f32 v131, v131
  v_cvt_pk_bf16_f32 v144, v128, v129
  v_cvt_pk_bf16_f32 v145, v130, v131
  v_mfma_f32_32x32x16_bf16 v[48:63], a[140:143], v[148:151], v[48:63]
  buffer_store_dwordx4 v[252:255], v2, s[40:43], s48 offen offset:1024 sc1
  v_exp_f32 v132, v132
  v_exp_f32 v133, v133
  v_exp_f32 v134, v134
  v_exp_f32 v135, v135
  v_cvt_pk_bf16_f32 v146, v132, v133
  v_cvt_pk_bf16_f32 v147, v134, v135
  v_mfma_f32_32x32x16_bf16 v[112:127], a[148:151], v[20:23], v[112:127]
  v_exp_f32 v136, v136
  v_exp_f32 v137, v137
  v_exp_f32 v138, v138
  v_exp_f32 v139, v139
  v_cvt_pk_bf16_f32 v148, v136, v137
  v_cvt_pk_bf16_f32 v149, v138, v139
  v_mfma_f32_32x32x16_bf16 v[64:79], a[136:139], v[144:147], v[64:79]
  buffer_load_dwordx4 a[236:239], v175, s[40:43], s21 offen offset:3072 sc1
  s_add_u32 s21, s21, 4096
  v_exp_f32 v140, v140
  v_exp_f32 v141, v141
  v_exp_f32 v142, v142
  v_exp_f32 v143, v143
  v_cvt_pk_bf16_f32 v150, v140, v141
  v_cvt_pk_bf16_f32 v151, v142, v143
  v_mfma_f32_32x32x16_bf16 v[128:143], a[144:147], v[24:27], 0
  buffer_load_dwordx4 a[240:243], v175, s[40:43], s21 offen offset:0 sc1
  v_exp_f32 v112, v112
  v_exp_f32 v113, v113
  v_exp_f32 v114, v114
  v_exp_f32 v115, v115
  v_cvt_pk_bf16_f32 v144, v112, v113
  v_cvt_pk_bf16_f32 v145, v114, v115
  v_mfma_f32_32x32x16_bf16 v[64:79], a[140:143], v[148:151], v[64:79]
  v_exp_f32 v116, v116
  v_exp_f32 v117, v117
  v_exp_f32 v118, v118
  v_exp_f32 v119, v119
  v_cvt_pk_bf16_f32 v146, v116, v117
  v_cvt_pk_bf16_f32 v147, v118, v119
  v_mfma_f32_32x32x16_bf16 v[128:143], a[148:151], v[28:31], v[128:143]
  v_exp_f32 v120, v120
  v_exp_f32 v121, v121
  v_exp_f32 v122, v122
  v_exp_f32 v123, v123
  v_cvt_pk_bf16_f32 v148, v120, v121
  v_cvt_pk_bf16_f32 v149, v122, v123
  s_waitcnt vmcnt(21)
  v_mfma_f32_32x32x16_bf16 v[48:63], a[152:155], v[144:147], v[48:63]
  buffer_load_dwordx4 a[244:247], v175, s[40:43], s21 offen offset:1024 sc1
  v_exp_f32 v124, v124
  v_exp_f32 v125, v125
  v_exp_f32 v126, v126
  v_exp_f32 v127, v127
  v_cvt_pk_bf16_f32 v150, v124, v125
  v_cvt_pk_bf16_f32 v151, v126, v127
  s_waitcnt vmcnt(20)
  v_mfma_f32_32x32x16_bf16 v[112:127], a[160:163], v[16:19], 0
  buffer_load_dwordx4 a[248:251], v175, s[40:43], s21 offen offset:2048 sc1
  v_exp_f32 v128, v128
  v_exp_f32 v129, v129
  v_exp_f32 v130, v130
  v_exp_f32 v131, v131
  v_cvt_pk_bf16_f32 v144, v128, v129
  v_cvt_pk_bf16_f32 v145, v130, v131
  v_mfma_f32_32x32x16_bf16 v[48:63], a[156:159], v[148:151], v[48:63]
  buffer_store_dwordx4 v[252:255], v2, s[40:43], s49 offen offset:0 sc1
  v_exp_f32 v132, v132
  v_exp_f32 v133, v133
  v_exp_f32 v134, v134
  v_exp_f32 v135, v135
  v_cvt_pk_bf16_f32 v146, v132, v133
  v_cvt_pk_bf16_f32 v147, v134, v135
  v_mfma_f32_32x32x16_bf16 v[112:127], a[164:167], v[20:23], v[112:127]
  s_add_u32 m0, s47, 69632
  s_nop 0
  buffer_load_dwordx4 v180, s[4:7], s46 offen offset:2048 lds
  s_add_u32 s46, s46, 6144
  v_exp_f32 v136, v136
  v_exp_f32 v137, v137
  v_exp_f32 v138, v138
  v_exp_f32 v139, v139
  v_cvt_pk_bf16_f32 v148, v136, v137
  v_cvt_pk_bf16_f32 v149, v138, v139
  v_mfma_f32_32x32x16_bf16 v[64:79], a[152:155], v[144:147], v[64:79]
  buffer_load_dwordx4 a[252:255], v175, s[40:43], s21 offen offset:3072 sc1
  s_add_u32 s21, s21, 4096
  v_exp_f32 v140, v140
  v_exp_f32 v141, v141
  v_exp_f32 v142, v142
  v_exp_f32 v143, v143
  v_cvt_pk_bf16_f32 v150, v140, v141
  v_cvt_pk_bf16_f32 v151, v142, v143
  v_mfma_f32_32x32x16_bf16 v[128:143], a[160:163], v[24:27], 0
  v_exp_f32 v112, v112
  v_exp_f32 v113, v113
  v_exp_f32 v114, v114
  v_exp_f32 v115, v115
  v_cvt_pk_bf16_f32 v144, v112, v113
  v_cvt_pk_bf16_f32 v145, v114, v115
  v_mfma_f32_32x32x16_bf16 v[64:79], a[156:159], v[148:151], v[64:79]
  v_exp_f32 v116, v116
  v_exp_f32 v117, v117
  v_exp_f32 v118, v118
  v_exp_f32 v119, v119
  v_cvt_pk_bf16_f32 v146, v116, v117
  v_cvt_pk_bf16_f32 v147, v118, v119
  v_mfma_f32_32x32x16_bf16 v[128:143], a[164:167], v[28:31], v[128:143]
  buffer_load_dwordx4 v180, s[4:7], s46 offen offset:3072 lds
  s_add_u32 s46, s46, 10240
  v_exp_f32 v120, v120
  v_exp_f32 v121, v121
  v_exp_f32 v122, v122
  v_exp_f32 v123, v123
  v_cvt_pk_bf16_f32 v148, v120, v121
  v_cvt_pk_bf16_f32 v149, v122, v123
  s_waitcnt vmcnt(22)
  v_mfma_f32_32x32x16_bf16 v[48:63], a[168:171], v[144:147], v[48:63]
  v_exp_f32 v124, v124
  v_exp_f32 v125, v125
  v_exp_f32 v126, v126
  v_exp_f32 v127, v127
  v_cvt_pk_bf16_f32 v150, v124, v125
  v_cvt_pk_bf16_f32 v151, v126, v127
  s_waitcnt vmcnt(20)
  v_mfma_f32_32x32x16_bf16 v[112:127], a[176:179], v[16:19], 0
  v_exp_f32 v128, v128
  v_exp_f32 v129, v129
  v_exp_f32 v130, v130
  v_exp_f32 v131, v131
  v_cvt_pk_bf16_f32 v144, v128, v129
  v_cvt_pk_bf16_f32 v145, v130, v131
  v_mfma_f32_32x32x16_bf16 v[48:63], a[172:175], v[148:151], v[48:63]
  buffer_store_dwordx4 v[252:255], v2, s[40:43], s49 offen offset:1024 sc1
  v_exp_f32 v132, v132
  v_exp_f32 v133, v133
  v_exp_f32 v134, v134
  v_exp_f32 v135, v135
  v_cvt_pk_bf16_f32 v146, v132, v133
  v_cvt_pk_bf16_f32 v147, v134, v135
  v_mfma_f32_32x32x16_bf16 v[112:127], a[180:183], v[20:23], v[112:127]
  s_add_u32 m0, s47, 73728
  s_nop 0
  buffer_load_dwordx4 v180, s[4:7], s46 offen offset:0 lds
  s_add_u32 s46, s46, 6144
  v_exp_f32 v136, v136
  v_exp_f32 v137, v137
  v_exp_f32 v138, v138
  v_exp_f32 v139, v139
  v_cvt_pk_bf16_f32 v148, v136, v137
  v_cvt_pk_bf16_f32 v149, v138, v139
  v_mfma_f32_32x32x16_bf16 v[64:79], a[168:171], v[144:147], v[64:79]
  v_exp_f32 v140, v140
  v_exp_f32 v141, v141
  v_exp_f32 v142, v142
  v_exp_f32 v143, v143
  v_cvt_pk_bf16_f32 v150, v140, v141
  v_cvt_pk_bf16_f32 v151, v142, v143
  v_mfma_f32_32x32x16_bf16 v[128:143], a[176:179], v[24:27], 0
  v_exp_f32 v112, v112
  v_exp_f32 v113, v113
  v_exp_f32 v114, v114
  v_exp_f32 v115, v115
  v_cvt_pk_bf16_f32 v144, v112, v113
  v_cvt_pk_bf16_f32 v145, v114, v115
  v_mfma_f32_32x32x16_bf16 v[64:79], a[172:175], v[148:151], v[64:79]
  v_exp_f32 v116, v116
  v_exp_f32 v117, v117
  v_exp_f32 v118, v118
  v_exp_f32 v119, v119
  v_cvt_pk_bf16_f32 v146, v116, v117
  v_cvt_pk_bf16_f32 v147, v118, v119
  v_mfma_f32_32x32x16_bf16 v[128:143], a[180:183], v[28:31], v[128:143]
  buffer_load_dwordx4 v180, s[4:7], s46 offen offset:1024 lds
  s_add_u32 s46, s46, 6144
  v_exp_f32 v120, v120
  v_exp_f32 v121, v121
  v_exp_f32 v122, v122
  v_exp_f32 v123, v123
  v_cvt_pk_bf16_f32 v148, v120, v121
  v_cvt_pk_bf16_f32 v149, v122, v123
  s_waitcnt vmcnt(20)
  v_mfma_f32_32x32x16_bf16 v[48:63], a[184:187], v[144:147], v[48:63]
  v_exp_f32 v124, v124
  v_exp_f32 v125, v125
  v_exp_f32 v126, v126
  v_exp_f32 v127, v127
  v_cvt_pk_bf16_f32 v150, v124, v125
  v_cvt_pk_bf16_f32 v151, v126, v127
  s_waitcnt vmcnt(18)
  v_mfma_f32_32x32x16_bf16 v[112:127], a[192:195], v[16:19], 0
  v_exp_f32 v128, v128
  v_exp_f32 v129, v129
  v_exp_f32 v130, v130
  v_exp_f32 v131, v131
  v_cvt_pk_bf16_f32 v144, v128, v129
  v_cvt_pk_bf16_f32 v145, v130, v131
  v_mfma_f32_32x32x16_bf16 v[48:63], a[188:191], v[148:151], v[48:63]
  buffer_store_dwordx4 v[252:255], v2, s[40:43], s50 offen offset:0 sc1
  v_exp_f32 v132, v132
  v_exp_f32 v133, v133
  v_exp_f32 v134, v134
  v_exp_f32 v135, v135
  v_cvt_pk_bf16_f32 v146, v132, v133
  v_cvt_pk_bf16_f32 v147, v134, v135
  v_mfma_f32_32x32x16_bf16 v[112:127], a[196:199], v[20:23], v[112:127]
  buffer_load_dwordx4 v180, s[4:7], s46 offen offset:2048 lds
  s_add_u32 s46, s46, 6144
  v_exp_f32 v136, v136
  v_exp_f32 v137, v137
  v_exp_f32 v138, v138
  v_exp_f32 v139, v139
  v_cvt_pk_bf16_f32 v148, v136, v137
  v_cvt_pk_bf16_f32 v149, v138, v139
  v_mfma_f32_32x32x16_bf16 v[64:79], a[184:187], v[144:147], v[64:79]
  v_exp_f32 v140, v140
  v_exp_f32 v141, v141
  v_exp_f32 v142, v142
  v_exp_f32 v143, v143
  v_cvt_pk_bf16_f32 v150, v140, v141
  v_cvt_pk_bf16_f32 v151, v142, v143
  v_mfma_f32_32x32x16_bf16 v[128:143], a[192:195], v[24:27], 0
  v_exp_f32 v112, v112
  v_exp_f32 v113, v113
  v_exp_f32 v114, v114
  v_exp_f32 v115, v115
  v_cvt_pk_bf16_f32 v144, v112, v113
  v_cvt_pk_bf16_f32 v145, v114, v115
  v_mfma_f32_32x32x16_bf16 v[64:79], a[188:191], v[148:151], v[64:79]
  v_exp_f32 v116, v116
  v_exp_f32 v117, v117
  v_exp_f32 v118, v118
  v_exp_f32 v119, v119
  v_cvt_pk_bf16_f32 v146, v116, v117
  v_cvt_pk_bf16_f32 v147, v118, v119
  v_mfma_f32_32x32x16_bf16 v[128:143], a[196:199], v[28:31], v[128:143]
  buffer_load_dwordx4 v180, s[4:7], s46 offen offset:3072 lds
  s_add_u32 s46, s46, 10240
  v_exp_f32 v120, v120
  v_exp_f32 v121, v121
  v_exp_f32 v122, v122
  v_exp_f32 v123, v123
  v_cvt_pk_bf16_f32 v148, v120, v121
  v_cvt_pk_bf16_f32 v149, v122, v123
  s_waitcnt vmcnt(18)
  v_mfma_f32_32x32x16_bf16 v[48:63], a[200:203], v[144:147], v[48:63]
  v_exp_f32 v124, v124
  v_exp_f32 v125, v125
  v_exp_f32 v126, v126
  v_exp_f32 v127, v127
  v_cvt_pk_bf16_f32 v150, v124, v125
  v_cvt_pk_bf16_f32 v151, v126, v127
  s_waitcnt vmcnt(16)
  v_mfma_f32_32x32x16_bf16 v[112:127], a[208:211], v[16:19], 0
  v_exp_f32 v128, v128
  v_exp_f32 v129, v129
  v_exp_f32 v130, v130
  v_exp_f32 v131, v131
  v_cvt_pk_bf16_f32 v144, v128, v129
  v_cvt_pk_bf16_f32 v145, v130, v131
  v_mfma_f32_32x32x16_bf16 v[48:63], a[204:207], v[148:151], v[48:63]
  buffer_store_dwordx4 v[252:255], v2, s[40:43], s50 offen offset:1024 sc1
  v_exp_f32 v132, v132
  v_exp_f32 v133, v133
  v_exp_f32 v134, v134
  v_exp_f32 v135, v135
  v_cvt_pk_bf16_f32 v146, v132, v133
  v_cvt_pk_bf16_f32 v147, v134, v135
  v_mfma_f32_32x32x16_bf16 v[112:127], a[212:215], v[20:23], v[112:127]
  s_add_u32 m0, s47, 77824
  s_nop 0
  buffer_load_dwordx4 v180, s[4:7], s46 offen offset:0 lds
  s_add_u32 s46, s46, 6144
  v_exp_f32 v136, v136
  v_exp_f32 v137, v137
  v_exp_f32 v138, v138
  v_exp_f32 v139, v139
  v_cvt_pk_bf16_f32 v148, v136, v137
  v_cvt_pk_bf16_f32 v149, v138, v139
  v_mfma_f32_32x32x16_bf16 v[64:79], a[200:203], v[144:147], v[64:79]
  v_exp_f32 v140, v140
  v_exp_f32 v141, v141
  v_exp_f32 v142, v142
  v_exp_f32 v143, v143
  v_cvt_pk_bf16_f32 v150, v140, v141
  v_cvt_pk_bf16_f32 v151, v142, v143
  v_mfma_f32_32x32x16_bf16 v[128:143], a[208:211], v[24:27], 0
  v_exp_f32 v112, v112
  v_exp_f32 v113, v113
  v_exp_f32 v114, v114
  v_exp_f32 v115, v115
  v_cvt_pk_bf16_f32 v144, v112, v113
  v_cvt_pk_bf16_f32 v145, v114, v115
  v_mfma_f32_32x32x16_bf16 v[64:79], a[204:207], v[148:151], v[64:79]
  v_exp_f32 v116, v116
  v_exp_f32 v117, v117
  v_exp_f32 v118, v118
  v_exp_f32 v119, v119
  v_cvt_pk_bf16_f32 v146, v116, v117
  v_cvt_pk_bf16_f32 v147, v118, v119
  v_mfma_f32_32x32x16_bf16 v[128:143], a[212:215], v[28:31], v[128:143]
  buffer_load_dwordx4 v180, s[4:7], s46 offen offset:1024 lds
  s_add_u32 s46, s46, 6144
  v_exp_f32 v120, v120
  v_exp_f32 v121, v121
  v_exp_f32 v122, v122
  v_exp_f32 v123, v123
  v_cvt_pk_bf16_f32 v148, v120, v121
  v_cvt_pk_bf16_f32 v149, v122, v123
  s_waitcnt vmcnt(16)
  v_mfma_f32_32x32x16_bf16 v[48:63], a[216:219], v[144:147], v[48:63]
  v_exp_f32 v124, v124
  v_exp_f32 v125, v125
  v_exp_f32 v126, v126
  v_exp_f32 v127, v127
  v_cvt_pk_bf16_f32 v150, v124, v125
  v_cvt_pk_bf16_f32 v151, v126, v127
  s_waitcnt vmcnt(14)
  v_mfma_f32_32x32x16_bf16 v[112:127], a[224:227], v[16:19], 0
  v_exp_f32 v128, v128
  v_exp_f32 v129, v129
  v_exp_f32 v130, v130
  v_exp_f32 v131, v131
  v_cvt_pk_bf16_f32 v144, v128, v129
  v_cvt_pk_bf16_f32 v145, v130, v131
  v_mfma_f32_32x32x16_bf16 v[48:63], a[220:223], v[148:151], v[48:63]
  buffer_store_dwordx4 v[252:255], v2, s[40:43], s51 offen offset:0 sc1
  v_exp_f32 v132, v132
  v_exp_f32 v133, v133
  v_exp_f32 v134, v134
  v_exp_f32 v135, v135
  v_cvt_pk_bf16_f32 v146, v132, v133
  v_cvt_pk_bf16_f32 v147, v134, v135
  v_mfma_f32_32x32x16_bf16 v[112:127], a[228:231], v[20:23], v[112:127]
  v_exp_f32 v136, v136
  v_exp_f32 v137, v137
  v_exp_f32 v138, v138
  v_exp_f32 v139, v139
  v_cvt_pk_bf16_f32 v148, v136, v137
  v_cvt_pk_bf16_f32 v149, v138, v139
  v_mfma_f32_32x32x16_bf16 v[64:79], a[216:219], v[144:147], v[64:79]
  v_exp_f32 v140, v140
  v_exp_f32 v141, v141
  v_exp_f32 v142, v142
  v_exp_f32 v143, v143
  v_cvt_pk_bf16_f32 v150, v140, v141
  v_cvt_pk_bf16_f32 v151, v142, v143
  v_mfma_f32_32x32x16_bf16 v[128:143], a[224:227], v[24:27], 0
  v_exp_f32 v112, v112
  v_exp_f32 v113, v113
  v_exp_f32 v114, v114
  v_exp_f32 v115, v115
  v_cvt_pk_bf16_f32 v144, v112, v113
  v_cvt_pk_bf16_f32 v145, v114, v115
  v_mfma_f32_32x32x16_bf16 v[64:79], a[220:223], v[148:151], v[64:79]
  v_exp_f32 v116, v116
  v_exp_f32 v117, v117
  v_exp_f32 v118, v118
  v_exp_f32 v119, v119
  v_cvt_pk_bf16_f32 v146, v116, v117
  v_cvt_pk_bf16_f32 v147, v118, v119
  v_mfma_f32_32x32x16_bf16 v[128:143], a[228:231], v[28:31], v[128:143]
  v_exp_f32 v120, v120
  v_exp_f32 v121, v121
  v_exp_f32 v122, v122
  v_exp_f32 v123, v123
  v_cvt_pk_bf16_f32 v148, v120, v121
  v_cvt_pk_bf16_f32 v149, v122, v123
  s_waitcnt vmcnt(12)
  v_mfma_f32_32x32x16_bf16 v[48:63], a[232:235], v[144:147], v[48:63]
  v_exp_f32 v124, v124
  v_exp_f32 v125, v125
  v_exp_f32 v126, v126
  v_exp_f32 v127, v127
  v_cvt_pk_bf16_f32 v150, v124, v125
  v_cvt_pk_bf16_f32 v151, v126, v127
  s_waitcnt vmcnt(10)
  v_mfma_f32_32x32x16_bf16 v[112:127], a[240:243], v[16:19], 0
  v_exp_f32 v128, v128
  v_exp_f32 v129, v129
  v_exp_f32 v130, v130
  v_exp_f32 v131, v131
  v_cvt_pk_bf16_f32 v144, v128, v129
  v_cvt_pk_bf16_f32 v145, v130, v131
  v_mfma_f32_32x32x16_bf16 v[48:63], a[236:239], v[148:151], v[48:63]
  buffer_store_dwordx4 v[252:255], v2, s[40:43], s51 offen offset:1024 sc1
  v_exp_f32 v132, v132
  v_exp_f32 v133, v133
  v_exp_f32 v134, v134
  v_exp_f32 v135, v135
  v_cvt_pk_bf16_f32 v146, v132, v133
  v_cvt_pk_bf16_f32 v147, v134, v135
  v_mfma_f32_32x32x16_bf16 v[112:127], a[244:247], v[20:23], v[112:127]
  v_exp_f32 v136, v136
  v_exp_f32 v137, v137
  v_exp_f32 v138, v138
  v_exp_f32 v139, v139
  v_cvt_pk_bf16_f32 v148, v136, v137
  v_cvt_pk_bf16_f32 v149, v138, v139
  v_mfma_f32_32x32x16_bf16 v[64:79], a[232:235], v[144:147], v[64:79]
  v_exp_f32 v140, v140
  v_exp_f32 v141, v141
  v_exp_f32 v142, v142
  v_exp_f32 v143, v143
  v_cvt_pk_bf16_f32 v150, v140, v141
  v_cvt_pk_bf16_f32 v151, v142, v143
  v_mfma_f32_32x32x16_bf16 v[128:143], a[240:243], v[24:27], 0
  v_exp_f32 v112, v112
  v_exp_f32 v113, v113
  v_exp_f32 v114, v114
  v_exp_f32 v115, v115
  v_cvt_pk_bf16_f32 v144, v112, v113
  v_cvt_pk_bf16_f32 v145, v114, v115
  v_mfma_f32_32x32x16_bf16 v[64:79], a[236:239], v[148:151], v[64:79]
  buffer_load_dwordx4 v[184:187], v179, s[40:43], 0 offen sc1
  buffer_load_dword v188, v181, s[40:43], 0 offen sc1
  v_exp_f32 v116, v116
  v_exp_f32 v117, v117
  v_exp_f32 v118, v118
  v_exp_f32 v119, v119
  v_cvt_pk_bf16_f32 v146, v116, v117
  v_cvt_pk_bf16_f32 v147, v118, v119
  v_mfma_f32_32x32x16_bf16 v[128:143], a[244:247], v[28:31], v[128:143]
  v_exp_f32 v120, v120
  v_exp_f32 v121, v121
  v_exp_f32 v122, v122
  v_exp_f32 v123, v123
  v_cvt_pk_bf16_f32 v148, v120, v121
  v_cvt_pk_bf16_f32 v149, v122, v123
  s_waitcnt vmcnt(9)
  v_mfma_f32_32x32x16_bf16 v[48:63], a[248:251], v[144:147], v[48:63]
  v_exp_f32 v124, v124
  v_exp_f32 v125, v125
  v_exp_f32 v126, v126
  v_exp_f32 v127, v127
  v_cvt_pk_bf16_f32 v150, v124, v125
  v_cvt_pk_bf16_f32 v151, v126, v127
  v_mfma_f32_32x32x16_bf16 v[112:127], a[0:3], v[32:35], 0
  v_exp_f32 v128, v128
  v_exp_f32 v129, v129
  v_exp_f32 v130, v130
  v_exp_f32 v131, v131
  v_cvt_pk_bf16_f32 v144, v128, v129
  v_cvt_pk_bf16_f32 v145, v130, v131
  v_mfma_f32_32x32x16_bf16 v[48:63], a[252:255], v[148:151], v[48:63]
  v_exp_f32 v132, v132
  v_exp_f32 v133, v133
  v_exp_f32 v134, v134
  v_exp_f32 v135, v135
  v_cvt_pk_bf16_f32 v146, v132, v133
  v_cvt_pk_bf16_f32 v147, v134, v135
  v_mfma_f32_32x32x16_bf16 v[112:127], a[4:7], v[36:39], v[112:127]
  v_exp_f32 v136, v136
  v_exp_f32 v137, v137
  v_exp_f32 v138, v138
  v_exp_f32 v139, v139
  v_cvt_pk_bf16_f32 v148, v136, v137
  v_cvt_pk_bf16_f32 v149, v138, v139
  v_mfma_f32_32x32x16_bf16 v[64:79], a[248:251], v[144:147], v[64:79]
  v_exp_f32 v140, v140
  v_exp_f32 v141, v141
  v_exp_f32 v142, v142
  v_exp_f32 v143, v143
  v_cvt_pk_bf16_f32 v150, v140, v141
  v_cvt_pk_bf16_f32 v151, v142, v143
  v_mfma_f32_32x32x16_bf16 v[128:143], a[0:3], v[40:43], 0
  v_exp_f32 v112, v112
  v_exp_f32 v113, v113
  v_exp_f32 v114, v114
  v_exp_f32 v115, v115
  v_cvt_pk_bf16_f32 v144, v112, v113
  v_cvt_pk_bf16_f32 v145, v114, v115
  v_mfma_f32_32x32x16_bf16 v[64:79], a[252:255], v[148:151], v[64:79]
  v_exp_f32 v116, v116
  v_exp_f32 v117, v117
  v_exp_f32 v118, v118
  v_exp_f32 v119, v119
  v_cvt_pk_bf16_f32 v146, v116, v117
  v_cvt_pk_bf16_f32 v147, v118, v119
  v_mfma_f32_32x32x16_bf16 v[128:143], a[4:7], v[44:47], v[128:143]
  v_exp_f32 v120, v120
  v_exp_f32 v121, v121
  v_exp_f32 v122, v122
  v_exp_f32 v123, v123
  v_cvt_pk_bf16_f32 v148, v120, v121
  v_cvt_pk_bf16_f32 v149, v122, v123
  v_mfma_f32_32x32x16_bf16 v[80:95], a[8:11], v[144:147], 0
  v_exp_f32 v124, v124
  v_exp_f32 v125, v125
  v_exp_f32 v126, v126
  v_exp_f32 v127, v127
  v_cvt_pk_bf16_f32 v150, v124, v125
  v_cvt_pk_bf16_f32 v151, v126, v127
  v_mfma_f32_32x32x16_bf16 v[112:127], a[16:19], v[32:35], 0
  v_exp_f32 v128, v128
  v_exp_f32 v129, v129
  v_exp_f32 v130, v130
  v_exp_f32 v131, v131
  v_cvt_pk_bf16_f32 v144, v128, v129
  v_cvt_pk_bf16_f32 v145, v130, v131
  v_mfma_f32_32x32x16_bf16 v[80:95], a[12:15], v[148:151], v[80:95]
  s_waitcnt vmcnt(0)
  v_exp_f32 v132, v132
  v_exp_f32 v133, v133
  v_exp_f32 v134, v134
  v_exp_f32 v135, v135
  v_cvt_pk_bf16_f32 v146, v132, v133
  v_cvt_pk_bf16_f32 v147, v134, v135
  v_mfma_f32_32x32x16_bf16 v[112:127], a[20:23], v[36:39], v[112:127]
  v_min3_u32 v189, v184, v185, v186
  v_max3_u32 v190, v184, v185, v186
  v_min3_u32 v189, v189, v187, v188
  v_max3_u32 v190, v190, v187, v188
  v_xor_b32 v189, s73, v189
  v_xor_b32 v190, s73, v190
  v_or_b32 v189, v189, v190
  v_cmp_ne_u32 vcc, 0, v189
  v_exp_f32 v136, v136
  v_exp_f32 v137, v137
  v_exp_f32 v138, v138
  v_exp_f32 v139, v139
  v_cvt_pk_bf16_f32 v148, v136, v137
  v_cvt_pk_bf16_f32 v149, v138, v139
  v_mfma_f32_32x32x16_bf16 v[96:111], a[8:11], v[144:147], 0
  s_cbranch_vccnz KF_FL
KF_FL_B:
  v_exp_f32 v140, v140
  v_exp_f32 v141, v141
  v_exp_f32 v142, v142
  v_exp_f32 v143, v143
  v_cvt_pk_bf16_f32 v150, v140, v141
  v_cvt_pk_bf16_f32 v151, v142, v143
  v_mfma_f32_32x32x16_bf16 v[128:143], a[16:19], v[40:43], 0
  v_exp_f32 v112, v112
  v_exp_f32 v113, v113
  v_exp_f32 v114, v114
  v_exp_f32 v115, v115
  v_cvt_pk_bf16_f32 v144, v112, v113
  v_cvt_pk_bf16_f32 v145, v114, v115
  v_mfma_f32_32x32x16_bf16 v[96:111], a[12:15], v[148:151], v[96:111]
  v_exp_f32 v116, v116
  v_exp_f32 v117, v117
  v_exp_f32 v118, v118
  v_exp_f32 v119, v119
  v_cvt_pk_bf16_f32 v146, v116, v117
  v_cvt_pk_bf16_f32 v147, v118, v119
  v_mfma_f32_32x32x16_bf16 v[128:143], a[20:23], v[44:47], v[128:143]
  v_add_f32 v156, v60, v76
  v_mov_b32 v157, 0x53800000
  v_cmp_nlt_f32 vcc, v156, v157
  ds_write_b128 v11, v[48:51] offset:0
  v_exp_f32 v120, v120
  v_exp_f32 v121, v121
  v_exp_f32 v122, v122
  v_exp_f32 v123, v123
  v_cvt_pk_bf16_f32 v148, v120, v121
  v_cvt_pk_bf16_f32 v149, v122, v123
  v_mfma_f32_32x32x16_bf16 v[80:95], a[24:27], v[144:147], v[80:95]
  ds_write_b128 v11, v[52:55] offset:4096
  ds_write_b128 v11, v[56:59] offset:8192
  ds_write_b128 v11, v[60:63] offset:12288
  ds_write_b32 v15, v152 offset:0
  v_exp_f32 v124, v124
  v_exp_f32 v125, v125
  v_exp_f32 v126, v126
  v_exp_f32 v127, v127
  v_cvt_pk_bf16_f32 v150, v124, v125
  v_cvt_pk_bf16_f32 v151, v126, v127
  v_mfma_f32_32x32x16_bf16 v[112:127], a[32:35], v[32:35], 0
  ds_write_b128 v11, v[64:67] offset:16384
  ds_write_b128 v11, v[68:71] offset:20480
  ds_write_b128 v11, v[72:75] offset:24576
  ds_write_b128 v11, v[76:79] offset:28672
  v_exp_f32 v128, v128
  v_exp_f32 v129, v129
  v_exp_f32 v130, v130
  v_exp_f32 v131, v131
  v_cvt_pk_bf16_f32 v144, v128, v129
  v_cvt_pk_bf16_f32 v145, v130, v131
  v_mfma_f32_32x32x16_bf16 v[80:95], a[28:31], v[148:151], v[80:95]
  ds_write_b32 v15, v153 offset:1024
  s_and_b64 vcc, vcc, s[52:53]
  s_cselect_b32 s70, 1, 0
  v_mov_b32 v156, s70
  buffer_load_dwordx4 a[0:3], v3, s[40:43], s44 offen offset:0 sc1
  v_exp_f32 v132, v132
  v_exp_f32 v133, v133
  v_exp_f32 v134, v134
  v_exp_f32 v135, v135
  v_cvt_pk_bf16_f32 v146, v132, v133
  v_cvt_pk_bf16_f32 v147, v134, v135
  v_mfma_f32_32x32x16_bf16 v[112:127], a[36:39], v[36:39], v[112:127]
  ds_write_b32 v249, v156 offset:0
  s_waitcnt lgkmcnt(0)
  s_barrier
  v_exp_f32 v136, v136
  v_exp_f32 v137, v137
  v_exp_f32 v138, v138
  v_exp_f32 v139, v139
  v_cvt_pk_bf16_f32 v148, v136, v137
  v_cvt_pk_bf16_f32 v149, v138, v139
  v_mfma_f32_32x32x16_bf16 v[96:111], a[24:27], v[144:147], v[96:111]
  buffer_load_dwordx4 a[4:7], v3, s[40:43], s44 offen offset:1024 sc1
  v_exp_f32 v140, v140
  v_exp_f32 v141, v141
  v_exp_f32 v142, v142
  v_exp_f32 v143, v143
  v_cvt_pk_bf16_f32 v150, v140, v141
  v_cvt_pk_bf16_f32 v151, v142, v143
  v_mfma_f32_32x32x16_bf16 v[128:143], a[32:35], v[40:43], 0
  ds_read_b128 v[160:163], v250 offset:0
  ds_read_b32 v244, v248 offset:0
  ds_read_b32 v245, v248 offset:256
  ds_read_b32 v246, v248 offset:512
  ds_read_b32 v247, v248 offset:768
  ds_read_b32 v240, v14 offset:0
  v_exp_f32 v112, v112
  v_exp_f32 v113, v113
  v_exp_f32 v114, v114
  v_exp_f32 v115, v115
  v_cvt_pk_bf16_f32 v144, v112, v113
  v_cvt_pk_bf16_f32 v145, v114, v115
  v_mfma_f32_32x32x16_bf16 v[96:111], a[28:31], v[148:151], v[96:111]
  ds_read_b32 v241, v14 offset:1024
  ds_read_b32 v242, v14 offset:2048
  ds_read_b32 v243, v14 offset:3072
  s_waitcnt lgkmcnt(0)
  ds_read_b128 v[208:211], v12 offset:0
  ds_read_b128 v[212:215], v12 offset:4096
  buffer_load_dwordx4 a[8:11], v3, s[40:43], s44 offen offset:2048 sc1
  v_exp_f32 v116, v116
  v_exp_f32 v117, v117
  v_exp_f32 v118, v118
  v_exp_f32 v119, v119
  v_cvt_pk_bf16_f32 v146, v116, v117
  v_cvt_pk_bf16_f32 v147, v118, v119
  v_mfma_f32_32x32x16_bf16 v[128:143], a[36:39], v[44:47], v[128:143]
  ds_read_b128 v[216:219], v12 offset:1024
  ds_read_b128 v[220:223], v12 offset:5120
  ds_read_b128 v[224:227], v12 offset:2048
  ds_read_b128 v[228:231], v12 offset:6144
  ds_read_b128 v[232:235], v12 offset:3072
  ds_read_b128 v[236:239], v12 offset:7168
  v_exp_f32 v120, v120
  v_exp_f32 v121, v121
  v_exp_f32 v122, v122
  v_exp_f32 v123, v123
  v_cvt_pk_bf16_f32 v148, v120, v121
  v_cvt_pk_bf16_f32 v149, v122, v123
  v_mfma_f32_32x32x16_bf16 v[80:95], a[40:43], v[144:147], v[80:95]
  v_or_b32 v160, v160, v161
  v_or3_b32 v160, v160, v162, v163
  s_nop 0
  v_readfirstlane_b32 s70, v160
  v_min3_f32 v160, v244, v245, v246
  v_min_f32 v160, v160, v247
  s_or_b32 s69, s69, s70
  buffer_load_dwordx4 a[12:15], v3, s[40:43], s44 offen offset:3072 sc1
  v_exp_f32 v124, v124
  v_exp_f32 v125, v125
  v_exp_f32 v126, v126
  v_exp_f32 v127, v127
  v_cvt_pk_bf16_f32 v150, v124, v125
  v_cvt_pk_bf16_f32 v151, v126, v127
  v_mfma_f32_32x32x16_bf16 v[112:127], a[48:51], v[32:35], 0
  v_sub_f32 v156, v160, v244
  v_sub_f32 v157, v160, v245
  v_sub_f32 v158, v160, v246
  v_sub_f32 v159, v160, v247
  v_exp_f32 v156, v156
  v_exp_f32 v157, v157
  v_exp_f32 v128, v128
  v_exp_f32 v129, v129
  v_exp_f32 v130, v130
  v_exp_f32 v131, v131
  v_cvt_pk_bf16_f32 v144, v128, v129
  v_cvt_pk_bf16_f32 v145, v130, v131
  v_mfma_f32_32x32x16_bf16 v[80:95], a[44:47], v[148:151], v[80:95]
  v_exp_f32 v158, v158
  v_exp_f32 v159, v159
  v_mul_f32 v160, v156, v240
  v_fmac_f32 v160, v157, v241
  v_fmac_f32 v160, v158, v242
  v_fmac_f32 v160, v159, v243
  buffer_load_dwordx4 a[16:19], v4, s[40:43], s44 offen offset:0 sc1
  v_exp_f32 v132, v132
  v_exp_f32 v133, v133
  v_exp_f32 v134, v134
  v_exp_f32 v135, v135
  v_cvt_pk_bf16_f32 v146, v132, v133
  v_cvt_pk_bf16_f32 v147, v134, v135
  v_mfma_f32_32x32x16_bf16 v[112:127], a[52:55], v[36:39], v[112:127]
  v_rcp_f32 v160, v160
  s_nop 0
  v_mul_f32 v156, v156, v160
  v_mul_f32 v157, v157, v160
  v_mul_f32 v158, v158, v160
  v_mul_f32 v159, v159, v160
  s_waitcnt lgkmcnt(0)
  v_exp_f32 v136, v136
  v_exp_f32 v137, v137
  v_exp_f32 v138, v138
  v_exp_f32 v139, v139
  v_cvt_pk_bf16_f32 v148, v136, v137
  v_cvt_pk_bf16_f32 v149, v138, v139
  v_mfma_f32_32x32x16_bf16 v[96:111], a[40:43], v[144:147], v[96:111]
  v_mul_f32 v208, v208, v156
  v_mul_f32 v209, v209, v156
  v_mul_f32 v210, v210, v156
  v_mul_f32 v211, v211, v156
  v_mul_f32 v212, v212, v156
  v_mul_f32 v213, v213, v156
  buffer_load_dwordx4 a[20:23], v4, s[40:43], s44 offen offset:1024 sc1
  v_exp_f32 v140, v140
  v_exp_f32 v141, v141
  v_exp_f32 v142, v142
  v_exp_f32 v143, v143
  v_cvt_pk_bf16_f32 v150, v140, v141
  v_cvt_pk_bf16_f32 v151, v142, v143
  v_mfma_f32_32x32x16_bf16 v[128:143], a[48:51], v[40:43], 0
  v_mul_f32 v214, v214, v156
  v_mul_f32 v215, v215, v156
  v_fmac_f32 v208, v157, v216
  v_fmac_f32 v209, v157, v217
  v_fmac_f32 v210, v157, v218
  v_fmac_f32 v211, v157, v219
  v_exp_f32 v112, v112
  v_exp_f32 v113, v113
  v_exp_f32 v114, v114
  v_exp_f32 v115, v115
  v_cvt_pk_bf16_f32 v144, v112, v113
  v_cvt_pk_bf16_f32 v145, v114, v115
  v_mfma_f32_32x32x16_bf16 v[96:111], a[44:47], v[148:151], v[96:111]
  v_fmac_f32 v212, v157, v220
  v_fmac_f32 v213, v157, v221
  v_fmac_f32 v214, v157, v222
  v_fmac_f32 v215, v157, v223
  v_fmac_f32 v208, v158, v224
  v_fmac_f32 v209, v158, v225
  buffer_load_dwordx4 a[24:27], v4, s[40:43], s44 offen offset:2048 sc1
  v_exp_f32 v116, v116
  v_exp_f32 v117, v117
  v_exp_f32 v118, v118
  v_exp_f32 v119, v119
  v_cvt_pk_bf16_f32 v146, v116, v117
  v_cvt_pk_bf16_f32 v147, v118, v119
  v_mfma_f32_32x32x16_bf16 v[128:143], a[52:55], v[44:47], v[128:143]
  v_fmac_f32 v210, v158, v226
  v_fmac_f32 v211, v158, v227
  v_fmac_f32 v212, v158, v228
  v_fmac_f32 v213, v158, v229
  v_fmac_f32 v214, v158, v230
  v_fmac_f32 v215, v158, v231
  v_exp_f32 v120, v120
  v_exp_f32 v121, v121
  v_exp_f32 v122, v122
  v_exp_f32 v123, v123
  v_cvt_pk_bf16_f32 v148, v120, v121
  v_cvt_pk_bf16_f32 v149, v122, v123
  v_mfma_f32_32x32x16_bf16 v[80:95], a[56:59], v[144:147], v[80:95]
  v_fmac_f32 v208, v159, v232
  v_fmac_f32 v209, v159, v233
  v_fmac_f32 v210, v159, v234
  v_fmac_f32 v211, v159, v235
  v_fmac_f32 v212, v159, v236
  v_fmac_f32 v213, v159, v237
  buffer_load_dwordx4 a[28:31], v4, s[40:43], s44 offen offset:3072 sc1
  v_exp_f32 v124, v124
  v_exp_f32 v125, v125
  v_exp_f32 v126, v126
  v_exp_f32 v127, v127
  v_cvt_pk_bf16_f32 v150, v124, v125
  v_cvt_pk_bf16_f32 v151, v126, v127
  v_mfma_f32_32x32x16_bf16 v[112:127], a[64:67], v[32:35], 0
  v_fmac_f32 v214, v159, v238
  v_fmac_f32 v215, v159, v239
  v_cvt_pk_bf16_f32 v240, v208, v209
  v_cvt_pk_bf16_f32 v241, v210, v211
  v_cvt_pk_bf16_f32 v242, v212, v213
  v_cvt_pk_bf16_f32 v243, v214, v215
  v_exp_f32 v128, v128
  v_exp_f32 v129, v129
  v_exp_f32 v130, v130
  v_exp_f32 v131, v131
  v_cvt_pk_bf16_f32 v144, v128, v129
  v_cvt_pk_bf16_f32 v145, v130, v131
  v_mfma_f32_32x32x16_bf16 v[80:95], a[60:63], v[148:151], v[80:95]
  v_cndmask_b32 v242, v242, 0, s[14:15]
  v_min_u32 v241, -2, v241
  v_min_u32 v243, -2, v243
  buffer_load_dwordx4 a[32:35], v5, s[40:43], s44 offen offset:0 sc1
  v_exp_f32 v132, v132
  v_exp_f32 v133, v133
  v_exp_f32 v134, v134
  v_exp_f32 v135, v135
  v_cvt_pk_bf16_f32 v146, v132, v133
  v_cvt_pk_bf16_f32 v147, v134, v135
  v_mfma_f32_32x32x16_bf16 v[112:127], a[68:71], v[36:39], v[112:127]
  v_exp_f32 v136, v136
  v_exp_f32 v137, v137
  v_exp_f32 v138, v138
  v_exp_f32 v139, v139
  v_cvt_pk_bf16_f32 v148, v136, v137
  v_cvt_pk_bf16_f32 v149, v138, v139
  v_mfma_f32_32x32x16_bf16 v[96:111], a[56:59], v[144:147], v[96:111]
  buffer_load_dwordx4 a[36:39], v5, s[40:43], s44 offen offset:1024 sc1
  v_exp_f32 v140, v140
  v_exp_f32 v141, v141
  v_exp_f32 v142, v142
  v_exp_f32 v143, v143
  v_cvt_pk_bf16_f32 v150, v140, v141
  v_cvt_pk_bf16_f32 v151, v142, v143
  v_mfma_f32_32x32x16_bf16 v[128:143], a[64:67], v[40:43], 0
  s_cmp_lg_u32 s69, 0
  s_cbranch_scc1 KF_SLOW0
KF_SLOW0_B:
  buffer_store_dwordx4 v[240:243], v2, s[40:43], s23 offen sc1
  v_exp_f32 v112, v112
  v_exp_f32 v113, v113
  v_exp_f32 v114, v114
  v_exp_f32 v115, v115
  v_cvt_pk_bf16_f32 v144, v112, v113
  v_cvt_pk_bf16_f32 v145, v114, v115
  v_mfma_f32_32x32x16_bf16 v[96:111], a[60:63], v[148:151], v[96:111]
  buffer_load_dwordx4 a[40:43], v5, s[40:43], s44 offen offset:2048 sc1
  v_exp_f32 v116, v116
  v_exp_f32 v117, v117
  v_exp_f32 v118, v118
  v_exp_f32 v119, v119
  v_cvt_pk_bf16_f32 v146, v116, v117
  v_cvt_pk_bf16_f32 v147, v118, v119
  v_mfma_f32_32x32x16_bf16 v[128:143], a[68:71], v[44:47], v[128:143]
  v_exp_f32 v120, v120
  v_exp_f32 v121, v121
  v_exp_f32 v122, v122
  v_exp_f32 v123, v123
  v_cvt_pk_bf16_f32 v148, v120, v121
  v_cvt_pk_bf16_f32 v149, v122, v123
  v_mfma_f32_32x32x16_bf16 v[80:95], a[72:75], v[144:147], v[80:95]
  buffer_load_dwordx4 a[44:47], v5, s[40:43], s44 offen offset:3072 sc1
  v_exp_f32 v124, v124
  v_exp_f32 v125, v125
  v_exp_f32 v126, v126
  v_exp_f32 v127, v127
  v_cvt_pk_bf16_f32 v150, v124, v125
  v_cvt_pk_bf16_f32 v151, v126, v127
  v_mfma_f32_32x32x16_bf16 v[112:127], a[80:83], v[32:35], 0
  v_exp_f32 v128, v128
  v_exp_f32 v129, v129
  v_exp_f32 v130, v130
  v_exp_f32 v131, v131
  v_cvt_pk_bf16_f32 v144, v128, v129
  v_cvt_pk_bf16_f32 v145, v130, v131
  v_mfma_f32_32x32x16_bf16 v[80:95], a[76:79], v[148:151], v[80:95]
  buffer_load_dwordx4 a[48:51], v6, s[40:43], s44 offen offset:0 sc1
  v_exp_f32 v132, v132
  v_exp_f32 v133, v133
  v_exp_f32 v134, v134
  v_exp_f32 v135, v135
  v_cvt_pk_bf16_f32 v146, v132, v133
  v_cvt_pk_bf16_f32 v147, v134, v135
  v_mfma_f32_32x32x16_bf16 v[112:127], a[84:87], v[36:39], v[112:127]
  v_exp_f32 v136, v136
  v_exp_f32 v137, v137
  v_exp_f32 v138, v138
  v_exp_f32 v139, v139
  v_cvt_pk_bf16_f32 v148, v136, v137
  v_cvt_pk_bf16_f32 v149, v138, v139
  v_mfma_f32_32x32x16_bf16 v[96:111], a[72:75], v[144:147], v[96:111]
  buffer_load_dwordx4 a[52:55], v6, s[40:43], s44 offen offset:1024 sc1
  v_exp_f32 v140, v140
  v_exp_f32 v141, v141
  v_exp_f32 v142, v142
  v_exp_f32 v143, v143
  v_cvt_pk_bf16_f32 v150, v140, v141
  v_cvt_pk_bf16_f32 v151, v142, v143
  v_mfma_f32_32x32x16_bf16 v[128:143], a[80:83], v[40:43], 0
  v_exp_f32 v112, v112
  v_exp_f32 v113, v113
  v_exp_f32 v114, v114
  v_exp_f32 v115, v115
  v_cvt_pk_bf16_f32 v144, v112, v113
  v_cvt_pk_bf16_f32 v145, v114, v115
  v_mfma_f32_32x32x16_bf16 v[96:111], a[76:79], v[148:151], v[96:111]
  buffer_load_dwordx4 a[56:59], v6, s[40:43], s44 offen offset:2048 sc1
  v_exp_f32 v116, v116
  v_exp_f32 v117, v117
  v_exp_f32 v118, v118
  v_exp_f32 v119, v119
  v_cvt_pk_bf16_f32 v146, v116, v117
  v_cvt_pk_bf16_f32 v147, v118, v119
  v_mfma_f32_32x32x16_bf16 v[128:143], a[84:87], v[44:47], v[128:143]
  v_exp_f32 v120, v120
  v_exp_f32 v121, v121
  v_exp_f32 v122, v122
  v_exp_f32 v123, v123
  v_cvt_pk_bf16_f32 v148, v120, v121
  v_cvt_pk_bf16_f32 v149, v122, v123
  v_mfma_f32_32x32x16_bf16 v[80:95], a[88:91], v[144:147], v[80:95]
  buffer_load_dwordx4 a[60:63], v6, s[40:43], s44 offen offset:3072 sc1
  v_exp_f32 v124, v124
  v_exp_f32 v125, v125
  v_exp_f32 v126, v126
  v_exp_f32 v127, v127
  v_cvt_pk_bf16_f32 v150, v124, v125
  v_cvt_pk_bf16_f32 v151, v126, v127
  v_mfma_f32_32x32x16_bf16 v[112:127], a[96:99], v[32:35], 0
  v_exp_f32 v128, v128
  v_exp_f32 v129, v129
  v_exp_f32 v130, v130
  v_exp_f32 v131, v131
  v_cvt_pk_bf16_f32 v144, v128, v129
  v_cvt_pk_bf16_f32 v145, v130, v131
  v_mfma_f32_32x32x16_bf16 v[80:95], a[92:95], v[148:151], v[80:95]
  buffer_load_dwordx4 a[64:67], v7, s[40:43], s44 offen offset:0 sc1
  v_exp_f32 v132, v132
  v_exp_f32 v133, v133
  v_exp_f32 v134, v134
  v_exp_f32 v135, v135
  v_cvt_pk_bf16_f32 v146, v132, v133
  v_cvt_pk_bf16_f32 v147, v134, v135
  v_mfma_f32_32x32x16_bf16 v[112:127], a[100:103], v[36:39], v[112:127]
  v_exp_f32 v136, v136
  v_exp_f32 v137, v137
  v_exp_f32 v138, v138
  v_exp_f32 v139, v139
  v_cvt_pk_bf16_f32 v148, v136, v137
  v_cvt_pk_bf16_f32 v149, v138, v139
  v_mfma_f32_32x32x16_bf16 v[96:111], a[88:91], v[144:147], v[96:111]
  buffer_load_dwordx4 a[68:71], v7, s[40:43], s44 offen offset:1024 sc1
  v_exp_f32 v140, v140
  v_exp_f32 v141, v141
  v_exp_f32 v142, v142
  v_exp_f32 v143, v143
  v_cvt_pk_bf16_f32 v150, v140, v141
  v_cvt_pk_bf16_f32 v151, v142, v143
  v_mfma_f32_32x32x16_bf16 v[128:143], a[96:99], v[40:43], 0
  buffer_load_dwordx4 v[164:167], v251, s[32:35], s60 offen
  v_exp_f32 v112, v112
  v_exp_f32 v113, v113
  v_exp_f32 v114, v114
  v_exp_f32 v115, v115
  v_cvt_pk_bf16_f32 v144, v112, v113
  v_cvt_pk_bf16_f32 v145, v114, v115
  v_mfma_f32_32x32x16_bf16 v[96:111], a[92:95], v[148:151], v[96:111]
  buffer_load_dwordx4 a[72:75], v7, s[40:43], s44 offen offset:2048 sc1
  v_exp_f32 v116, v116
  v_exp_f32 v117, v117
  v_exp_f32 v118, v118
  v_exp_f32 v119, v119
  v_cvt_pk_bf16_f32 v146, v116, v117
  v_cvt_pk_bf16_f32 v147, v118, v119
  v_mfma_f32_32x32x16_bf16 v[128:143], a[100:103], v[44:47], v[128:143]
  v_exp_f32 v120, v120
  v_exp_f32 v121, v121
  v_exp_f32 v122, v122
  v_exp_f32 v123, v123
  v_cvt_pk_bf16_f32 v148, v120, v121
  v_cvt_pk_bf16_f32 v149, v122, v123
  v_mfma_f32_32x32x16_bf16 v[80:95], a[104:107], v[144:147], v[80:95]
  buffer_load_dwordx4 a[76:79], v7, s[40:43], s44 offen offset:3072 sc1
  v_exp_f32 v124, v124
  v_exp_f32 v125, v125
  v_exp_f32 v126, v126
  v_exp_f32 v127, v127
  v_cvt_pk_bf16_f32 v150, v124, v125
  v_cvt_pk_bf16_f32 v151, v126, v127
  v_mfma_f32_32x32x16_bf16 v[112:127], a[112:115], v[32:35], 0
  buffer_load_dwordx4 v[168:171], v251, s[32:35], s61 offen
  v_exp_f32 v128, v128
  v_exp_f32 v129, v129
  v_exp_f32 v130, v130
  v_exp_f32 v131, v131
  v_cvt_pk_bf16_f32 v144, v128, v129
  v_cvt_pk_bf16_f32 v145, v130, v131
  v_mfma_f32_32x32x16_bf16 v[80:95], a[108:111], v[148:151], v[80:95]
  buffer_load_dwordx4 a[80:83], v8, s[40:43], s44 offen offset:0 sc1
  v_exp_f32 v132, v132
  v_exp_f32 v133, v133
  v_exp_f32 v134, v134
  v_exp_f32 v135, v135
  v_cvt_pk_bf16_f32 v146, v132, v133
  v_cvt_pk_bf16_f32 v147, v134, v135
  v_mfma_f32_32x32x16_bf16 v[112:127], a[116:119], v[36:39], v[112:127]
  v_exp_f32 v136, v136
  v_exp_f32 v137, v137
  v_exp_f32 v138, v138
  v_exp_f32 v139, v139
  v_cvt_pk_bf16_f32 v148, v136, v137
  v_cvt_pk_bf16_f32 v149, v138, v139
  v_mfma_f32_32x32x16_bf16 v[96:111], a[104:107], v[144:147], v[96:111]
  buffer_load_dwordx4 a[84:87], v8, s[40:43], s44 offen offset:1024 sc1
  v_exp_f32 v140, v140
  v_exp_f32 v141, v141
  v_exp_f32 v142, v142
  v_exp_f32 v143, v143
  v_cvt_pk_bf16_f32 v150, v140, v141
  v_cvt_pk_bf16_f32 v151, v142, v143
  v_mfma_f32_32x32x16_bf16 v[128:143], a[112:115], v[40:43], 0
  buffer_load_dwordx4 v[48:51], v2, s[40:43], s54 offen offset:0 sc1
  buffer_load_dwordx4 v[52:55], v2, s[40:43], s54 offen offset:1024 sc1
  v_exp_f32 v112, v112
  v_exp_f32 v113, v113
  v_exp_f32 v114, v114
  v_exp_f32 v115, v115
  v_cvt_pk_bf16_f32 v144, v112, v113
  v_cvt_pk_bf16_f32 v145, v114, v115
  v_mfma_f32_32x32x16_bf16 v[96:111], a[108:111], v[148:151], v[96:111]
  buffer_load_dwordx4 a[88:91], v8, s[40:43], s44 offen offset:2048 sc1
  v_exp_f32 v116, v116
  v_exp_f32 v117, v117
  v_exp_f32 v118, v118
  v_exp_f32 v119, v119
  v_cvt_pk_bf16_f32 v146, v116, v117
  v_cvt_pk_bf16_f32 v147, v118, v119
  v_mfma_f32_32x32x16_bf16 v[128:143], a[116:119], v[44:47], v[128:143]
  buffer_load_dwordx4 v[56:59], v2, s[40:43], s54 offen offset:2048 sc1
  buffer_load_dwordx4 v[60:63], v2, s[40:43], s54 offen offset:3072 sc1
  v_exp_f32 v120, v120
  v_exp_f32 v121, v121
  v_exp_f32 v122, v122
  v_exp_f32 v123, v123
  v_cvt_pk_bf16_f32 v148, v120, v121
  v_cvt_pk_bf16_f32 v149, v122, v123
  v_mfma_f32_32x32x16_bf16 v[80:95], a[120:123], v[144:147], v[80:95]
  buffer_load_dwordx4 a[92:95], v8, s[40:43], s44 offen offset:3072 sc1
  v_exp_f32 v124, v124
  v_exp_f32 v125, v125
  v_exp_f32 v126, v126
  v_exp_f32 v127, v127
  v_cvt_pk_bf16_f32 v150, v124, v125
  v_cvt_pk_bf16_f32 v151, v126, v127
  v_mfma_f32_32x32x16_bf16 v[112:127], a[128:131], v[32:35], 0
  buffer_load_dwordx4 v[64:67], v10, s[40:43], s54 offen offset:0 sc1
  buffer_load_dwordx4 v[68:71], v10, s[40:43], s54 offen offset:1024 sc1
  v_exp_f32 v128, v128
  v_exp_f32 v129, v129
  v_exp_f32 v130, v130
  v_exp_f32 v131, v131
  v_cvt_pk_bf16_f32 v144, v128, v129
  v_cvt_pk_bf16_f32 v145, v130, v131
  v_mfma_f32_32x32x16_bf16 v[80:95], a[124:127], v[148:151], v[80:95]
  buffer_load_dwordx4 a[96:99], v9, s[40:43], s44 offen offset:0 sc1
  v_exp_f32 v132, v132
  v_exp_f32 v133, v133
  v_exp_f32 v134, v134
  v_exp_f32 v135, v135
  v_cvt_pk_bf16_f32 v146, v132, v133
  v_cvt_pk_bf16_f32 v147, v134, v135
  v_mfma_f32_32x32x16_bf16 v[112:127], a[132:135], v[36:39], v[112:127]
  buffer_load_dwordx4 v[72:75], v10, s[40:43], s54 offen offset:2048 sc1
  buffer_load_dwordx4 v[76:79], v10, s[40:43], s54 offen offset:3072 sc1
  v_exp_f32 v136, v136
  v_exp_f32 v137, v137
  v_exp_f32 v138, v138
  v_exp_f32 v139, v139
  v_cvt_pk_bf16_f32 v148, v136, v137
  v_cvt_pk_bf16_f32 v149, v138, v139
  v_mfma_f32_32x32x16_bf16 v[96:111], a[120:123], v[144:147], v[96:111]
  buffer_load_dwordx4 a[100:103], v9, s[40:43], s44 offen offset:1024 sc1
  v_exp_f32 v140, v140
  v_exp_f32 v141, v141
  v_exp_f32 v142, v142
  v_exp_f32 v143, v143
  v_cvt_pk_bf16_f32 v150, v140, v141
  v_cvt_pk_bf16_f32 v151, v142, v143
  v_mfma_f32_32x32x16_bf16 v[128:143], a[128:131], v[40:43], 0
  v_exp_f32 v112, v112
  v_exp_f32 v113, v113
  v_exp_f32 v114, v114
  v_exp_f32 v115, v115
  v_cvt_pk_bf16_f32 v144, v112, v113
  v_cvt_pk_bf16_f32 v145, v114, v115
  v_mfma_f32_32x32x16_bf16 v[96:111], a[124:127], v[148:151], v[96:111]
  buffer_load_dwordx4 a[104:107], v9, s[40:43], s44 offen offset:2048 sc1
  v_exp_f32 v116, v116
  v_exp_f32 v117, v117
  v_exp_f32 v118, v118
  v_exp_f32 v119, v119
  v_cvt_pk_bf16_f32 v146, v116, v117
  v_cvt_pk_bf16_f32 v147, v118, v119
  v_mfma_f32_32x32x16_bf16 v[128:143], a[132:135], v[44:47], v[128:143]
  s_barrier
  v_exp_f32 v120, v120
  v_exp_f32 v121, v121
  v_exp_f32 v122, v122
  v_exp_f32 v123, v123
  v_cvt_pk_bf16_f32 v148, v120, v121
  v_cvt_pk_bf16_f32 v149, v122, v123
  v_mfma_f32_32x32x16_bf16 v[80:95], a[136:139], v[144:147], v[80:95]
  buffer_load_dwordx4 a[108:111], v9, s[40:43], s44 offen offset:3072 sc1
  v_exp_f32 v124, v124
  v_exp_f32 v125, v125
  v_exp_f32 v126, v126
  v_exp_f32 v127, v127
  v_cvt_pk_bf16_f32 v150, v124, v125
  v_cvt_pk_bf16_f32 v151, v126, v127
  v_mfma_f32_32x32x16_bf16 v[112:127], a[144:147], v[32:35], 0
  ds_read_b64_tr_b16 v[184:185], v172 offset:0
  ds_read_b64_tr_b16 v[186:187], v172 offset:1024
  ds_read_b64_tr_b16 v[188:189], v173 offset:0
  ds_read_b64_tr_b16 v[190:191], v173 offset:1024
  v_exp_f32 v128, v128
  v_exp_f32 v129, v129
  v_exp_f32 v130, v130
  v_exp_f32 v131, v131
  v_cvt_pk_bf16_f32 v144, v128, v129
  v_cvt_pk_bf16_f32 v145, v130, v131
  v_mfma_f32_32x32x16_bf16 v[80:95], a[140:143], v[148:151], v[80:95]
  buffer_load_dwordx4 a[112:115], v3, s[40:43], s45 offen offset:0 sc1
  ds_read_b64_tr_b16 v[192:193], v172 offset:2048
  ds_read_b64_tr_b16 v[194:195], v172 offset:3072
  ds_read_b64_tr_b16 v[196:197], v173 offset:2048
  ds_read_b64_tr_b16 v[198:199], v173 offset:3072
  v_exp_f32 v132, v132
  v_exp_f32 v133, v133
  v_exp_f32 v134, v134
  v_exp_f32 v135, v135
  v_cvt_pk_bf16_f32 v146, v132, v133
  v_cvt_pk_bf16_f32 v147, v134, v135
  v_mfma_f32_32x32x16_bf16 v[112:127], a[148:151], v[36:39], v[112:127]
  ds_read_b64_tr_b16 v[200:201], v172 offset:3584
  ds_read_b64_tr_b16 v[202:203], v172 offset:4608
  ds_read_b64_tr_b16 v[204:205], v173 offset:3584
  ds_read_b64_tr_b16 v[206:207], v173 offset:4608
  v_exp_f32 v136, v136
  v_exp_f32 v137, v137
  v_exp_f32 v138, v138
  v_exp_f32 v139, v139
  v_cvt_pk_bf16_f32 v148, v136, v137
  v_cvt_pk_bf16_f32 v149, v138, v139
  v_mfma_f32_32x32x16_bf16 v[96:111], a[136:139], v[144:147], v[96:111]
  buffer_load_dwordx4 a[116:119], v3, s[40:43], s45 offen offset:1024 sc1
  s_waitcnt vmcnt(5)
  v_max3_u32 v163, v49, v51, v53
  v_max3_u32 v163, v163, v55, v57
  v_max3_u32 v163, v163, v59, v61
  v_max3_u32 v163, v163, v63, v65
  v_max3_u32 v163, v163, v67, v69
  v_max3_u32 v163, v163, v71, v73
  v_max3_u32 v163, v163, v75, v77
  v_max_u32 v163, v163, v79
  v_cmp_eq_u32 vcc, -1, v163
  v_exp_f32 v140, v140
  v_exp_f32 v141, v141
  v_exp_f32 v142, v142
  v_exp_f32 v143, v143
  v_cvt_pk_bf16_f32 v150, v140, v141
  v_cvt_pk_bf16_f32 v151, v142, v143
  v_mfma_f32_32x32x16_bf16 v[128:143], a[144:147], v[40:43], 0
  s_cbranch_vccnz KF_WR0
KF_WR0_B:
  v_exp_f32 v112, v112
  v_exp_f32 v113, v113
  v_exp_f32 v114, v114
  v_exp_f32 v115, v115
  v_cvt_pk_bf16_f32 v144, v112, v113
  v_cvt_pk_bf16_f32 v145, v114, v115
  v_mfma_f32_32x32x16_bf16 v[96:111], a[140:143], v[148:151], v[96:111]
  buffer_load_dwordx4 a[120:123], v3, s[40:43], s45 offen offset:2048 sc1
  v_exp_f32 v116, v116
  v_exp_f32 v117, v117
  s_waitcnt lgkmcnt(8)
  v_mfma_f32_32x32x16_bf16 v[208:223], v[184:187], v[48:51], 0
  v_exp_f32 v118, v118
  v_exp_f32 v119, v119
  v_cvt_pk_bf16_f32 v146, v116, v117
  v_cvt_pk_bf16_f32 v147, v118, v119
  v_mfma_f32_32x32x16_bf16 v[128:143], a[148:151], v[44:47], v[128:143]
  v_exp_f32 v120, v120
  v_exp_f32 v121, v121
  v_mfma_f32_32x32x16_bf16 v[224:239], v[188:191], v[48:51], 0
  ds_read_b64_tr_b16 v[184:185], v172 offset:5632
  ds_read_b64_tr_b16 v[186:187], v172 offset:6656
  ds_read_b64_tr_b16 v[188:189], v173 offset:5632
  ds_read_b64_tr_b16 v[190:191], v173 offset:6656
  v_exp_f32 v122, v122
  v_exp_f32 v123, v123
  v_cvt_pk_bf16_f32 v148, v120, v121
  v_cvt_pk_bf16_f32 v149, v122, v123
  v_mfma_f32_32x32x16_bf16 v[80:95], a[152:155], v[144:147], v[80:95]
  buffer_load_dwordx4 a[124:127], v3, s[40:43], s45 offen offset:3072 sc1
  v_exp_f32 v124, v124
  v_exp_f32 v125, v125
  s_waitcnt lgkmcnt(8)
  v_mfma_f32_32x32x16_bf16 v[208:223], v[192:195], v[52:55], v[208:223]
  v_exp_f32 v126, v126
  v_exp_f32 v127, v127
  v_cvt_pk_bf16_f32 v150, v124, v125
  v_cvt_pk_bf16_f32 v151, v126, v127
  v_mfma_f32_32x32x16_bf16 v[112:127], a[160:163], v[32:35], 0
  v_exp_f32 v128, v128
  v_exp_f32 v129, v129
  v_mfma_f32_32x32x16_bf16 v[224:239], v[196:199], v[52:55], v[224:239]
  ds_read_b64_tr_b16 v[192:193], v172 offset:7168
  ds_read_b64_tr_b16 v[194:195], v172 offset:8192
  ds_read_b64_tr_b16 v[196:197], v173 offset:7168
  ds_read_b64_tr_b16 v[198:199], v173 offset:8192
  v_exp_f32 v130, v130
  v_exp_f32 v131, v131
  v_cvt_pk_bf16_f32 v144, v128, v129
  v_cvt_pk_bf16_f32 v145, v130, v131
  v_mfma_f32_32x32x16_bf16 v[80:95], a[156:159], v[148:151], v[80:95]
  buffer_load_dwordx4 a[128:131], v4, s[40:43], s45 offen offset:0 sc1
  v_exp_f32 v132, v132
  v_exp_f32 v133, v133
  s_waitcnt lgkmcnt(8)
  v_mfma_f32_32x32x16_bf16 v[208:223], v[200:203], v[56:59], v[208:223]
  v_exp_f32 v134, v134
  v_exp_f32 v135, v135
  v_cvt_pk_bf16_f32 v146, v132, v133
  v_cvt_pk_bf16_f32 v147, v134, v135
  v_mfma_f32_32x32x16_bf16 v[112:127], a[164:167], v[36:39], v[112:127]
  v_exp_f32 v136, v136
  v_exp_f32 v137, v137
  v_mfma_f32_32x32x16_bf16 v[224:239], v[204:207], v[56:59], v[224:239]
  ds_read_b64_tr_b16 v[200:201], v172 offset:9216
  ds_read_b64_tr_b16 v[202:203], v172 offset:10240
  ds_read_b64_tr_b16 v[204:205], v173 offset:9216
  ds_read_b64_tr_b16 v[206:207], v173 offset:10240
  v_exp_f32 v138, v138
  v_exp_f32 v139, v139
  v_cvt_pk_bf16_f32 v148, v136, v137
  v_cvt_pk_bf16_f32 v149, v138, v139
  v_mfma_f32_32x32x16_bf16 v[96:111], a[152:155], v[144:147], v[96:111]
  buffer_load_dwordx4 a[132:135], v4, s[40:43], s45 offen offset:1024 sc1
  v_exp_f32 v140, v140
  v_exp_f32 v141, v141
  s_waitcnt lgkmcnt(8)
  v_mfma_f32_32x32x16_bf16 v[208:223], v[184:187], v[60:63], v[208:223]
  v_exp_f32 v142, v142
  v_exp_f32 v143, v143
  v_cvt_pk_bf16_f32 v150, v140, v141
  v_cvt_pk_bf16_f32 v151, v142, v143
  v_mfma_f32_32x32x16_bf16 v[128:143], a[160:163], v[40:43], 0
  v_exp_f32 v112, v112
  v_exp_f32 v113, v113
  v_mfma_f32_32x32x16_bf16 v[224:239], v[188:191], v[60:63], v[224:239]
  ds_read_b64_tr_b16 v[184:185], v172 offset:10752
  ds_read_b64_tr_b16 v[186:187], v172 offset:11776
  ds_read_b64_tr_b16 v[188:189], v173 offset:10752
  ds_read_b64_tr_b16 v[190:191], v173 offset:11776
  v_exp_f32 v114, v114
  v_exp_f32 v115, v115
  v_cvt_pk_bf16_f32 v144, v112, v113
  v_cvt_pk_bf16_f32 v145, v114, v115
  v_mfma_f32_32x32x16_bf16 v[96:111], a[156:159], v[148:151], v[96:111]
  buffer_load_dwordx4 a[136:139], v4, s[40:43], s45 offen offset:2048 sc1
  v_exp_f32 v116, v116
  v_exp_f32 v117, v117
  s_waitcnt lgkmcnt(8)
  v_mfma_f32_32x32x16_bf16 v[208:223], v[192:195], v[64:67], v[208:223]
  v_exp_f32 v118, v118
  v_exp_f32 v119, v119
  v_cvt_pk_bf16_f32 v146, v116, v117
  v_cvt_pk_bf16_f32 v147, v118, v119
  v_mfma_f32_32x32x16_bf16 v[128:143], a[164:167], v[44:47], v[128:143]
  v_exp_f32 v120, v120
  v_exp_f32 v121, v121
  v_mfma_f32_32x32x16_bf16 v[224:239], v[196:199], v[64:67], v[224:239]
  ds_read_b64_tr_b16 v[192:193], v172 offset:12800
  ds_read_b64_tr_b16 v[194:195], v172 offset:13824
  ds_read_b64_tr_b16 v[196:197], v173 offset:12800
  ds_read_b64_tr_b16 v[198:199], v173 offset:13824
  v_exp_f32 v122, v122
  v_exp_f32 v123, v123
  v_cvt_pk_bf16_f32 v148, v120, v121
  v_cvt_pk_bf16_f32 v149, v122, v123
  v_mfma_f32_32x32x16_bf16 v[80:95], a[168:171], v[144:147], v[80:95]
  buffer_load_dwordx4 a[140:143], v4, s[40:43], s45 offen offset:3072 sc1
  v_exp_f32 v124, v124
  v_exp_f32 v125, v125
  s_waitcnt lgkmcnt(8)
  v_mfma_f32_32x32x16_bf16 v[208:223], v[200:203], v[68:71], v[208:223]
  v_exp_f32 v126, v126
  v_exp_f32 v127, v127
  v_cvt_pk_bf16_f32 v150, v124, v125
  v_cvt_pk_bf16_f32 v151, v126, v127
  v_mfma_f32_32x32x16_bf16 v[112:127], a[176:179], v[32:35], 0
  v_exp_f32 v128, v128
  v_exp_f32 v129, v129
  v_mfma_f32_32x32x16_bf16 v[224:239], v[204:207], v[68:71], v[224:239]
  v_exp_f32 v130, v130
  v_exp_f32 v131, v131
  v_cvt_pk_bf16_f32 v144, v128, v129
  v_cvt_pk_bf16_f32 v145, v130, v131
  v_mfma_f32_32x32x16_bf16 v[80:95], a[172:175], v[148:151], v[80:95]
  buffer_load_dwordx4 a[144:147], v5, s[40:43], s45 offen offset:0 sc1
  v_exp_f32 v132, v132
  v_exp_f32 v133, v133
  s_waitcnt lgkmcnt(4)
  v_mfma_f32_32x32x16_bf16 v[208:223], v[184:187], v[72:75], v[208:223]
  v_exp_f32 v134, v134
  v_exp_f32 v135, v135
  v_cvt_pk_bf16_f32 v146, v132, v133
  v_cvt_pk_bf16_f32 v147, v134, v135
  v_mfma_f32_32x32x16_bf16 v[112:127], a[180:183], v[36:39], v[112:127]
  v_exp_f32 v136, v136
  v_exp_f32 v137, v137
  v_mfma_f32_32x32x16_bf16 v[224:239], v[188:191], v[72:75], v[224:239]
  v_exp_f32 v138, v138
  v_exp_f32 v139, v139
  v_cvt_pk_bf16_f32 v148, v136, v137
  v_cvt_pk_bf16_f32 v149, v138, v139
  v_mfma_f32_32x32x16_bf16 v[96:111], a[168:171], v[144:147], v[96:111]
  buffer_load_dwordx4 a[148:151], v5, s[40:43], s45 offen offset:1024 sc1
  v_exp_f32 v140, v140
  v_exp_f32 v141, v141
  s_waitcnt lgkmcnt(0)
  v_mfma_f32_32x32x16_bf16 v[208:223], v[192:195], v[76:79], v[208:223]
  v_exp_f32 v142, v142
  v_exp_f32 v143, v143
  v_cvt_pk_bf16_f32 v150, v140, v141
  v_cvt_pk_bf16_f32 v151, v142, v143
  v_mfma_f32_32x32x16_bf16 v[128:143], a[176:179], v[40:43], 0
  v_exp_f32 v112, v112
  v_exp_f32 v113, v113
  v_mfma_f32_32x32x16_bf16 v[224:239], v[196:199], v[76:79], v[224:239]
  v_exp_f32 v114, v114
  v_exp_f32 v115, v115
  v_cvt_pk_bf16_f32 v144, v112, v113
  v_cvt_pk_bf16_f32 v145, v114, v115
  v_mfma_f32_32x32x16_bf16 v[96:111], a[172:175], v[148:151], v[96:111]
  buffer_load_dwordx4 a[152:155], v5, s[40:43], s45 offen offset:2048 sc1
  v_exp_f32 v116, v116
  v_exp_f32 v117, v117
  v_exp_f32 v118, v118
  v_exp_f32 v119, v119
  v_cvt_pk_bf16_f32 v146, v116, v117
  v_cvt_pk_bf16_f32 v147, v118, v119
  v_mfma_f32_32x32x16_bf16 v[128:143], a[180:183], v[44:47], v[128:143]
  v_exp_f32 v120, v120
  v_exp_f32 v121, v121
  v_exp_f32 v122, v122
  v_exp_f32 v123, v123
  v_cvt_pk_bf16_f32 v148, v120, v121
  v_cvt_pk_bf16_f32 v149, v122, v123
  v_mfma_f32_32x32x16_bf16 v[80:95], a[184:187], v[144:147], v[80:95]
  buffer_load_dwordx4 a[156:159], v5, s[40:43], s45 offen offset:3072 sc1
  v_exp_f32 v124, v124
  v_exp_f32 v125, v125
  v_exp_f32 v126, v126
  v_exp_f32 v127, v127
  v_cvt_pk_bf16_f32 v150, v124, v125
  v_cvt_pk_bf16_f32 v151, v126, v127
  v_mfma_f32_32x32x16_bf16 v[112:127], a[192:195], v[32:35], 0
  ds_write_b128 v11, v[208:211] offset:0
  ds_write_b128 v11, v[212:215] offset:4096
  ds_write_b128 v11, v[216:219] offset:8192
  v_exp_f32 v128, v128
  v_exp_f32 v129, v129
  v_exp_f32 v130, v130
  v_exp_f32 v131, v131
  v_cvt_pk_bf16_f32 v144, v128, v129
  v_cvt_pk_bf16_f32 v145, v130, v131
  v_mfma_f32_32x32x16_bf16 v[80:95], a[188:191], v[148:151], v[80:95]
  buffer_load_dwordx4 a[160:163], v6, s[40:43], s45 offen offset:0 sc1
  ds_write_b128 v11, v[220:223] offset:12288
  ds_write_b128 v11, v[224:227] offset:16384
  ds_write_b128 v11, v[228:231] offset:20480
  v_exp_f32 v132, v132
  v_exp_f32 v133, v133
  v_exp_f32 v134, v134
  v_exp_f32 v135, v135
  v_cvt_pk_bf16_f32 v146, v132, v133
  v_cvt_pk_bf16_f32 v147, v134, v135
  v_mfma_f32_32x32x16_bf16 v[112:127], a[196:199], v[36:39], v[112:127]
  ds_write_b128 v11, v[232:235] offset:24576
  ds_write_b128 v11, v[236:239] offset:28672
  s_waitcnt lgkmcnt(0)
  v_exp_f32 v136, v136
  v_exp_f32 v137, v137
  v_exp_f32 v138, v138
  v_exp_f32 v139, v139
  v_cvt_pk_bf16_f32 v148, v136, v137
  v_cvt_pk_bf16_f32 v149, v138, v139
  v_mfma_f32_32x32x16_bf16 v[96:111], a[184:187], v[144:147], v[96:111]
  buffer_load_dwordx4 a[164:167], v6, s[40:43], s45 offen offset:1024 sc1
  s_barrier
  v_exp_f32 v140, v140
  v_exp_f32 v141, v141
  v_exp_f32 v142, v142
  v_exp_f32 v143, v143
  v_cvt_pk_bf16_f32 v150, v140, v141
  v_cvt_pk_bf16_f32 v151, v142, v143
  v_mfma_f32_32x32x16_bf16 v[128:143], a[192:195], v[40:43], 0
  ds_read_b128 v[48:51], v13 offset:0
  ds_read_b128 v[52:55], v13 offset:4096
  ds_read_b128 v[56:59], v13 offset:1024
  ds_read_b128 v[60:63], v13 offset:5120
  ds_read_b128 v[64:67], v13 offset:2048
  v_exp_f32 v112, v112
  v_exp_f32 v113, v113
  v_exp_f32 v114, v114
  v_exp_f32 v115, v115
  v_cvt_pk_bf16_f32 v144, v112, v113
  v_cvt_pk_bf16_f32 v145, v114, v115
  v_mfma_f32_32x32x16_bf16 v[96:111], a[188:191], v[148:151], v[96:111]
  buffer_load_dwordx4 a[168:171], v6, s[40:43], s45 offen offset:2048 sc1
  ds_read_b128 v[68:71], v13 offset:6144
  ds_read_b128 v[72:75], v13 offset:3072
  ds_read_b128 v[76:79], v13 offset:7168
  v_permlane32_swap_b32 v164, v166
  v_permlane32_swap_b32 v165, v167
  v_lshlrev_b32 v16, 16, v164
  v_exp_f32 v116, v116
  v_exp_f32 v117, v117
  v_exp_f32 v118, v118
  v_exp_f32 v119, v119
  v_cvt_pk_bf16_f32 v146, v116, v117
  v_cvt_pk_bf16_f32 v147, v118, v119
  v_mfma_f32_32x32x16_bf16 v[128:143], a[196:199], v[44:47], v[128:143]
  v_and_b32 v17, 0xffff0000, v164
  v_lshlrev_b32 v18, 16, v165
  v_and_b32 v19, 0xffff0000, v165
  v_lshlrev_b32 v20, 16, v166
  v_and_b32 v21, 0xffff0000, v166
  v_lshlrev_b32 v22, 16, v167
  v_exp_f32 v120, v120
  v_exp_f32 v121, v121
  v_exp_f32 v122, v122
  v_exp_f32 v123, v123
  v_cvt_pk_bf16_f32 v148, v120, v121
  v_cvt_pk_bf16_f32 v149, v122, v123
  v_mfma_f32_32x32x16_bf16 v[80:95], a[200:203], v[144:147], v[80:95]
  buffer_load_dwordx4 a[172:175], v6, s[40:43], s45 offen offset:3072 sc1
  v_and_b32 v23, 0xffff0000, v167
  s_waitcnt lgkmcnt(0)
  v_add_f32 v16, v16, v48
  v_add_f32 v17, v17, v49
  v_add_f32 v18, v18, v50
  v_add_f32 v19, v19, v51
  v_exp_f32 v124, v124
  v_exp_f32 v125, v125
  v_exp_f32 v126, v126
  v_exp_f32 v127, v127
  v_cvt_pk_bf16_f32 v150, v124, v125
  v_cvt_pk_bf16_f32 v151, v126, v127
  v_mfma_f32_32x32x16_bf16 v[112:127], a[208:211], v[32:35], 0
  v_add_f32 v20, v20, v52
  v_add_f32 v21, v21, v53
  v_add_f32 v22, v22, v54
  v_add_f32 v23, v23, v55
  v_add_f32 v16, v16, v56
  v_add_f32 v17, v17, v57
  v_exp_f32 v128, v128
  v_exp_f32 v129, v129
  v_exp_f32 v130, v130
  v_exp_f32 v131, v131
  v_cvt_pk_bf16_f32 v144, v128, v129
  v_cvt_pk_bf16_f32 v145, v130, v131
  v_mfma_f32_32x32x16_bf16 v[80:95], a[204:207], v[148:151], v[80:95]
  buffer_load_dwordx4 a[176:179], v7, s[40:43], s45 offen offset:0 sc1
  v_add_f32 v18, v18, v58
  v_add_f32 v19, v19, v59
  v_add_f32 v20, v20, v60
  v_add_f32 v21, v21, v61
  v_add_f32 v22, v22, v62
  v_add_f32 v23, v23, v63
  v_exp_f32 v132, v132
  v_exp_f32 v133, v133
  v_exp_f32 v134, v134
  v_exp_f32 v135, v135
  v_cvt_pk_bf16_f32 v146, v132, v133
  v_cvt_pk_bf16_f32 v147, v134, v135
  v_mfma_f32_32x32x16_bf16 v[112:127], a[212:215], v[36:39], v[112:127]
  v_add_f32 v16, v16, v64
  v_add_f32 v17, v17, v65
  v_add_f32 v18, v18, v66
  v_add_f32 v19, v19, v67
  v_add_f32 v20, v20, v68
  v_add_f32 v21, v21, v69
  v_exp_f32 v136, v136
  v_exp_f32 v137, v137
  v_exp_f32 v138, v138
  v_exp_f32 v139, v139
  v_cvt_pk_bf16_f32 v148, v136, v137
  v_cvt_pk_bf16_f32 v149, v138, v139
  v_mfma_f32_32x32x16_bf16 v[96:111], a[200:203], v[144:147], v[96:111]
  buffer_load_dwordx4 a[180:183], v7, s[40:43], s45 offen offset:1024 sc1
  v_add_f32 v22, v22, v70
  v_add_f32 v23, v23, v71
  v_add_f32 v16, v16, v72
  v_add_f32 v17, v17, v73
  v_add_f32 v18, v18, v74
  v_add_f32 v19, v19, v75
  v_exp_f32 v140, v140
  v_exp_f32 v141, v141
  v_exp_f32 v142, v142
  v_exp_f32 v143, v143
  v_cvt_pk_bf16_f32 v150, v140, v141
  v_cvt_pk_bf16_f32 v151, v142, v143
  v_mfma_f32_32x32x16_bf16 v[128:143], a[208:211], v[40:43], 0
  v_add_f32 v20, v20, v76
  v_add_f32 v21, v21, v77
  v_add_f32 v22, v22, v78
  v_add_f32 v23, v23, v79
  v_cvt_pk_bf16_f32 v164, v16, v17
  v_cvt_pk_bf16_f32 v165, v18, v19
  v_exp_f32 v112, v112
  v_exp_f32 v113, v113
  v_exp_f32 v114, v114
  v_exp_f32 v115, v115
  v_cvt_pk_bf16_f32 v144, v112, v113
  v_cvt_pk_bf16_f32 v145, v114, v115
  v_mfma_f32_32x32x16_bf16 v[96:111], a[204:207], v[148:151], v[96:111]
  buffer_load_dwordx4 a[184:187], v7, s[40:43], s45 offen offset:2048 sc1
  v_cvt_pk_bf16_f32 v166, v20, v21
  v_cvt_pk_bf16_f32 v167, v22, v23
  v_min_u32 v165, -2, v165
  v_min_u32 v167, -2, v167
  buffer_store_dwordx4 v[164:167], v2, s[40:43], s26 offen sc1
  buffer_store_dwordx2 v[164:165], v2, s[40:43], s27 offen sc1
  v_exp_f32 v116, v116
  v_exp_f32 v117, v117
  v_exp_f32 v118, v118
  v_exp_f32 v119, v119
  v_cvt_pk_bf16_f32 v146, v116, v117
  v_cvt_pk_bf16_f32 v147, v118, v119
  v_mfma_f32_32x32x16_bf16 v[128:143], a[212:215], v[44:47], v[128:143]
  v_lshlrev_b32 v16, 16, v164
  v_and_b32 v17, 0xffff0000, v164
  v_lshlrev_b32 v18, 16, v165
  v_and_b32 v19, 0xffff0000, v165
  v_lshlrev_b32 v20, 16, v166
  v_and_b32 v21, 0xffff0000, v166
  v_exp_f32 v120, v120
  v_exp_f32 v121, v121
  v_exp_f32 v122, v122
  v_exp_f32 v123, v123
  v_cvt_pk_bf16_f32 v148, v120, v121
  v_cvt_pk_bf16_f32 v149, v122, v123
  v_mfma_f32_32x32x16_bf16 v[80:95], a[216:219], v[144:147], v[80:95]
  buffer_load_dwordx4 a[188:191], v7, s[40:43], s45 offen offset:3072 sc1
  v_lshlrev_b32 v22, 16, v167
  v_and_b32 v23, 0xffff0000, v167
  v_add_f32 v24, v16, v17
  v_add_f32 v26, v20, v21
  v_mul_f32 v25, v16, v16
  v_mul_f32 v27, v20, v20
  v_exp_f32 v124, v124
  v_exp_f32 v125, v125
  v_exp_f32 v126, v126
  v_exp_f32 v127, v127
  v_cvt_pk_bf16_f32 v150, v124, v125
  v_cvt_pk_bf16_f32 v151, v126, v127
  v_mfma_f32_32x32x16_bf16 v[112:127], a[224:227], v[32:35], 0
  v_add_f32 v24, v24, v18
  v_add_f32 v26, v26, v22
  v_add_f32 v24, v24, v19
  v_add_f32 v26, v26, v23
  v_fmac_f32 v25, v17, v17
  v_fmac_f32 v27, v21, v21
  v_exp_f32 v128, v128
  v_exp_f32 v129, v129
  v_exp_f32 v130, v130
  v_exp_f32 v131, v131
  v_cvt_pk_bf16_f32 v144, v128, v129
  v_cvt_pk_bf16_f32 v145, v130, v131
  v_mfma_f32_32x32x16_bf16 v[80:95], a[220:223], v[148:151], v[80:95]
  buffer_load_dwordx4 a[192:195], v8, s[40:43], s45 offen offset:0 sc1
  v_fmac_f32 v25, v18, v18
  v_fmac_f32 v27, v22, v22
  v_fmac_f32 v25, v19, v19
  v_fmac_f32 v27, v23, v23
  v_cndmask_b32 v26, v26, 0, s[74:75]
  v_cndmask_b32 v27, v27, 0, s[74:75]
  v_exp_f32 v132, v132
  v_exp_f32 v133, v133
  v_exp_f32 v134, v134
  v_exp_f32 v135, v135
  v_cvt_pk_bf16_f32 v146, v132, v133
  v_cvt_pk_bf16_f32 v147, v134, v135
  v_mfma_f32_32x32x16_bf16 v[112:127], a[228:231], v[36:39], v[112:127]
  v_add_f32 v24, v24, v26
  v_add_f32 v25, v25, v27
  v_mov_b32 v26, v24
  v_mov_b32 v27, v25
  s_nop 0
  v_permlane32_swap_b32 v24, v26
  v_permlane32_swap_b32 v25, v27
  v_exp_f32 v136, v136
  v_exp_f32 v137, v137
  v_exp_f32 v138, v138
  v_exp_f32 v139, v139
  v_cvt_pk_bf16_f32 v148, v136, v137
  v_cvt_pk_bf16_f32 v149, v138, v139
  v_mfma_f32_32x32x16_bf16 v[96:111], a[216:219], v[144:147], v[96:111]
  buffer_load_dwordx4 a[196:199], v8, s[40:43], s45 offen offset:1024 sc1
  v_add_f32 v24, v24, v26
  v_add_f32 v25, v25, v27
  v_min_u32 v25, -2, v25
  buffer_store_dwordx2 v[24:25], v182, s[40:43], s30 offen sc1
  v_exp_f32 v140, v140
  v_exp_f32 v141, v141
  v_exp_f32 v142, v142
  v_exp_f32 v143, v143
  v_cvt_pk_bf16_f32 v150, v140, v141
  v_cvt_pk_bf16_f32 v151, v142, v143
  v_mfma_f32_32x32x16_bf16 v[128:143], a[224:227], v[40:43], 0
  v_exp_f32 v112, v112
  v_exp_f32 v113, v113
  v_exp_f32 v114, v114
  v_exp_f32 v115, v115
  v_cvt_pk_bf16_f32 v144, v112, v113
  v_cvt_pk_bf16_f32 v145, v114, v115
  v_mfma_f32_32x32x16_bf16 v[96:111], a[220:223], v[148:151], v[96:111]
  buffer_load_dwordx4 a[200:203], v8, s[40:43], s45 offen offset:2048 sc1
  v_exp_f32 v116, v116
  v_exp_f32 v117, v117
  v_exp_f32 v118, v118
  v_exp_f32 v119, v119
  v_cvt_pk_bf16_f32 v146, v116, v117
  v_cvt_pk_bf16_f32 v147, v118, v119
  v_mfma_f32_32x32x16_bf16 v[128:143], a[228:231], v[44:47], v[128:143]
  v_exp_f32 v120, v120
  v_exp_f32 v121, v121
  v_exp_f32 v122, v122
  v_exp_f32 v123, v123
  v_cvt_pk_bf16_f32 v148, v120, v121
  v_cvt_pk_bf16_f32 v149, v122, v123
  v_mfma_f32_32x32x16_bf16 v[80:95], a[232:235], v[144:147], v[80:95]
  buffer_load_dwordx4 a[204:207], v8, s[40:43], s45 offen offset:3072 sc1
  v_exp_f32 v124, v124
  v_exp_f32 v125, v125
  v_exp_f32 v126, v126
  v_exp_f32 v127, v127
  v_cvt_pk_bf16_f32 v150, v124, v125
  v_cvt_pk_bf16_f32 v151, v126, v127
  v_mfma_f32_32x32x16_bf16 v[112:127], a[240:243], v[32:35], 0
  v_exp_f32 v128, v128
  v_exp_f32 v129, v129
  v_exp_f32 v130, v130
  v_exp_f32 v131, v131
  v_cvt_pk_bf16_f32 v144, v128, v129
  v_cvt_pk_bf16_f32 v145, v130, v131
  v_mfma_f32_32x32x16_bf16 v[80:95], a[236:239], v[148:151], v[80:95]
  buffer_load_dwordx4 a[208:211], v9, s[40:43], s45 offen offset:0 sc1
  v_exp_f32 v132, v132
  v_exp_f32 v133, v133
  v_exp_f32 v134, v134
  v_exp_f32 v135, v135
  v_cvt_pk_bf16_f32 v146, v132, v133
  v_cvt_pk_bf16_f32 v147, v134, v135
  v_mfma_f32_32x32x16_bf16 v[112:127], a[244:247], v[36:39], v[112:127]
  v_exp_f32 v136, v136
  v_exp_f32 v137, v137
  v_exp_f32 v138, v138
  v_exp_f32 v139, v139
  v_cvt_pk_bf16_f32 v148, v136, v137
  v_cvt_pk_bf16_f32 v149, v138, v139
  v_mfma_f32_32x32x16_bf16 v[96:111], a[232:235], v[144:147], v[96:111]
  buffer_load_dwordx4 a[212:215], v9, s[40:43], s45 offen offset:1024 sc1
  v_exp_f32 v140, v140
  v_exp_f32 v141, v141
  v_exp_f32 v142, v142
  v_exp_f32 v143, v143
  v_cvt_pk_bf16_f32 v150, v140, v141
  v_cvt_pk_bf16_f32 v151, v142, v143
  v_mfma_f32_32x32x16_bf16 v[128:143], a[240:243], v[40:43], 0
  v_exp_f32 v112, v112
  v_exp_f32 v113, v113
  v_exp_f32 v114, v114
  v_exp_f32 v115, v115
  v_cvt_pk_bf16_f32 v144, v112, v113
  v_cvt_pk_bf16_f32 v145, v114, v115
  v_mfma_f32_32x32x16_bf16 v[96:111], a[236:239], v[148:151], v[96:111]
  buffer_load_dwordx4 a[216:219], v9, s[40:43], s45 offen offset:2048 sc1
  v_exp_f32 v116, v116
  v_exp_f32 v117, v117
  v_exp_f32 v118, v118
  v_exp_f32 v119, v119
  v_cvt_pk_bf16_f32 v146, v116, v117
  v_cvt_pk_bf16_f32 v147, v118, v119
  v_mfma_f32_32x32x16_bf16 v[128:143], a[244:247], v[44:47], v[128:143]
  v_exp_f32 v120, v120
  v_exp_f32 v121, v121
  v_exp_f32 v122, v122
  v_exp_f32 v123, v123
  v_cvt_pk_bf16_f32 v148, v120, v121
  v_cvt_pk_bf16_f32 v149, v122, v123
  v_mfma_f32_32x32x16_bf16 v[80:95], a[248:251], v[144:147], v[80:95]
  buffer_load_dwordx4 a[220:223], v9, s[40:43], s45 offen offset:3072 sc1
  v_exp_f32 v124, v124
  v_exp_f32 v125, v125
  v_exp_f32 v126, v126
  v_exp_f32 v127, v127
  v_cvt_pk_bf16_f32 v150, v124, v125
  v_cvt_pk_bf16_f32 v151, v126, v127
  v_exp_f32 v128, v128
  v_exp_f32 v129, v129
  v_exp_f32 v130, v130
  v_exp_f32 v131, v131
  v_cvt_pk_bf16_f32 v144, v128, v129
  v_cvt_pk_bf16_f32 v145, v130, v131
  v_mfma_f32_32x32x16_bf16 v[80:95], a[252:255], v[148:151], v[80:95]
  v_exp_f32 v132, v132
  v_exp_f32 v133, v133
  v_exp_f32 v134, v134
  v_exp_f32 v135, v135
  v_cvt_pk_bf16_f32 v146, v132, v133
  v_cvt_pk_bf16_f32 v147, v134, v135
  v_exp_f32 v136, v136
  v_exp_f32 v137, v137
  v_exp_f32 v138, v138
  v_exp_f32 v139, v139
  v_cvt_pk_bf16_f32 v148, v136, v137
  v_cvt_pk_bf16_f32 v149, v138, v139
  v_mfma_f32_32x32x16_bf16 v[96:111], a[248:251], v[144:147], v[96:111]
  v_exp_f32 v140, v140
  v_exp_f32 v141, v141
  v_exp_f32 v142, v142
  v_exp_f32 v143, v143
  v_cvt_pk_bf16_f32 v150, v140, v141
  v_cvt_pk_bf16_f32 v151, v142, v143
  s_nop 1
  v_mfma_f32_32x32x16_bf16 v[96:111], a[252:255], v[148:151], v[96:111]
  v_lshlrev_b32 v176, 3, v1
  v_and_b32 v177, 31, v1
  v_lshlrev_b32 v179, 6, v177
  v_add_u32 v179, 151616, v179
  v_lshlrev_b32 v177, 5, v177
  v_lshrrev_b32 v178, 5, v1
  v_lshl_add_u32 v177, v178, 4, v177
  buffer_load_dwordx4 v[48:51], v2, s[40:43], s56 offen offset:0 sc1
  buffer_load_dwordx4 v[52:55], v2, s[40:43], s56 offen offset:1024 sc1
  buffer_load_dwordx4 v[56:59], v2, s[40:43], s56 offen offset:2048 sc1
  buffer_load_dwordx4 v[60:63], v2, s[40:43], s56 offen offset:3072 sc1
  buffer_load_dwordx4 v[64:67], v10, s[40:43], s56 offen offset:0 sc1
  buffer_load_dwordx4 v[68:71], v10, s[40:43], s56 offen offset:1024 sc1
  buffer_load_dwordx4 v[72:75], v10, s[40:43], s56 offen offset:2048 sc1
  buffer_load_dwordx2 v[136:137], v176, s[40:43], s58 offen offset:0 sc1
  buffer_load_dwordx2 v[138:139], v176, s[40:43], s58 offen offset:512 sc1
  buffer_load_dwordx2 v[140:141], v176, s[40:43], s58 offen offset:1024 sc1
  buffer_load_dwordx2 v[142:143], v176, s[40:43], s58 offen offset:1536 sc1
  buffer_load_dwordx4 v[112:115], v177, s[40:43], s63 offen sc1
  buffer_load_dwordx4 v[116:119], v177, s[40:43], s64 offen sc1
  v_add_f32 v156, v92, v108
  v_mov_b32 v157, 0x53800000
  v_cmp_nlt_f32 vcc, v156, v157
  ds_write_b128 v11, v[80:83] offset:32768
  ds_write_b128 v11, v[84:87] offset:36864
  ds_write_b128 v11, v[88:91] offset:40960
  ds_write_b128 v11, v[92:95] offset:45056
  ds_write_b32 v15, v154 offset:2048
  ds_write_b128 v11, v[96:99] offset:49152
  ds_write_b128 v11, v[100:103] offset:53248
  ds_write_b128 v11, v[104:107] offset:57344
  ds_write_b128 v11, v[108:111] offset:61440
  ds_write_b32 v15, v155 offset:3072
  s_and_b64 vcc, vcc, s[52:53]
  s_cselect_b32 s70, 1, 0
  v_mov_b32 v156, s70
  ds_write_b32 v249, v156 offset:16
  s_waitcnt lgkmcnt(0)
  s_barrier
  ds_read_b128 v[160:163], v250 offset:16
  ds_read_b32 v244, v248 offset:2048
  ds_read_b32 v245, v248 offset:2304
  ds_read_b32 v246, v248 offset:2560
  ds_read_b32 v247, v248 offset:2816
  ds_read_b32 v240, v14 offset:32768
  ds_read_b32 v241, v14 offset:33792
  ds_read_b32 v242, v14 offset:34816
  ds_read_b32 v243, v14 offset:35840
  s_waitcnt lgkmcnt(0)
  ds_read_b128 v[208:211], v12 offset:32768
  ds_read_b128 v[212:215], v12 offset:36864
  ds_read_b128 v[216:219], v12 offset:33792
  ds_read_b128 v[220:223], v12 offset:37888
  ds_read_b128 v[224:227], v12 offset:34816
  ds_read_b128 v[228:231], v12 offset:38912
  ds_read_b128 v[232:235], v12 offset:35840
  ds_read_b128 v[236:239], v12 offset:39936
  v_or_b32 v160, v160, v161
  v_or3_b32 v160, v160, v162, v163
  s_nop 0
  v_readfirstlane_b32 s70, v160
  v_min3_f32 v160, v244, v245, v246
  v_min_f32 v160, v160, v247
  s_or_b32 s69, s69, s70
  v_sub_f32 v156, v160, v244
  v_sub_f32 v157, v160, v245
  v_sub_f32 v158, v160, v246
  v_sub_f32 v159, v160, v247
  v_exp_f32 v156, v156
  v_exp_f32 v157, v157
  v_exp_f32 v158, v158
  v_exp_f32 v159, v159
  v_mul_f32 v160, v156, v240
  v_fmac_f32 v160, v157, v241
  v_fmac_f32 v160, v158, v242
  v_fmac_f32 v160, v159, v243
  v_rcp_f32 v160, v160
  s_nop 0
  v_mul_f32 v156, v156, v160
  v_mul_f32 v157, v157, v160
  v_mul_f32 v158, v158, v160
  v_mul_f32 v159, v159, v160
  s_waitcnt lgkmcnt(0)
  v_pk_mul_f32 v[208:209], v[208:209], v[156:157] op_sel_hi:[1,0]
  v_pk_mul_f32 v[210:211], v[210:211], v[156:157] op_sel_hi:[1,0]
  v_pk_mul_f32 v[212:213], v[212:213], v[156:157] op_sel_hi:[1,0]
  v_pk_mul_f32 v[214:215], v[214:215], v[156:157] op_sel_hi:[1,0]
  v_pk_fma_f32 v[208:209], v[216:217], v[156:157], v[208:209] op_sel:[0,1,0] op_sel_hi:[1,1,1]
  v_pk_fma_f32 v[210:211], v[218:219], v[156:157], v[210:211] op_sel:[0,1,0] op_sel_hi:[1,1,1]
  v_pk_fma_f32 v[212:213], v[220:221], v[156:157], v[212:213] op_sel:[0,1,0] op_sel_hi:[1,1,1]
  v_pk_fma_f32 v[214:215], v[222:223], v[156:157], v[214:215] op_sel:[0,1,0] op_sel_hi:[1,1,1]
  v_pk_fma_f32 v[208:209], v[224:225], v[158:159], v[208:209] op_sel:[0,0,0] op_sel_hi:[1,0,1]
  v_pk_fma_f32 v[210:211], v[226:227], v[158:159], v[210:211] op_sel:[0,0,0] op_sel_hi:[1,0,1]
  v_pk_fma_f32 v[212:213], v[228:229], v[158:159], v[212:213] op_sel:[0,0,0] op_sel_hi:[1,0,1]
  v_pk_fma_f32 v[214:215], v[230:231], v[158:159], v[214:215] op_sel:[0,0,0] op_sel_hi:[1,0,1]
  v_pk_fma_f32 v[208:209], v[232:233], v[158:159], v[208:209] op_sel:[0,1,0] op_sel_hi:[1,1,1]
  v_pk_fma_f32 v[210:211], v[234:235], v[158:159], v[210:211] op_sel:[0,1,0] op_sel_hi:[1,1,1]
  v_pk_fma_f32 v[212:213], v[236:237], v[158:159], v[212:213] op_sel:[0,1,0] op_sel_hi:[1,1,1]
  v_pk_fma_f32 v[214:215], v[238:239], v[158:159], v[214:215] op_sel:[0,1,0] op_sel_hi:[1,1,1]
  v_cvt_pk_bf16_f32 v240, v208, v209
  v_cvt_pk_bf16_f32 v241, v210, v211
  v_cvt_pk_bf16_f32 v242, v212, v213
  v_cvt_pk_bf16_f32 v243, v214, v215
  v_cndmask_b32 v242, v242, 0, s[14:15]
  v_min_u32 v241, -2, v241
  v_min_u32 v243, -2, v243
  s_cmp_lg_u32 s69, 0
  s_cbranch_scc1 KF_SLOW1
KF_SLOW1_B:
  s_add_u32 s24, s23, 65536
  buffer_store_dwordx4 v[240:243], v2, s[40:43], s24 offen sc1
  buffer_load_dwordx4 a[224:227], v3, s[40:43], s67 offen offset:0 sc1
  buffer_load_dwordx4 a[228:231], v3, s[40:43], s68 offen offset:0 sc1
  buffer_load_dwordx4 a[232:235], v3, s[40:43], s67 offen offset:1024 sc1
  buffer_load_dwordx4 a[236:239], v3, s[40:43], s68 offen offset:1024 sc1
  v_mov_b32 v14, v176
  v_mov_b32 v15, v177
  v_mov_b32 v248, v178
  v_mov_b32 v249, v179
  v_lshl_add_u32 v248, v248, 3, v249
  s_lshl_b32 s70, s16, 4
  v_add_u32 v248, s70, v248
  s_mul_i32 s70, s16, 7168
  v_add_u32 v12, s70, v2
  v_mov_b32 v162, v182
  s_waitcnt vmcnt(15)
  v_max3_u32 v160, v49, v51, v53
  v_max_u32 v160, v160, v55
  v_cmp_eq_u32 vcc, -1, v160
  s_nop 3
  s_nop 0
  s_cbranch_vccnz KF_HR00
KF_HR00_B:
  s_waitcnt vmcnt(13)
  v_max3_u32 v160, v57, v59, v61
  v_max_u32 v160, v160, v63
  v_cmp_eq_u32 vcc, -1, v160
  ds_write_b128 v12, v[48:51] offset:0
  ds_write_b128 v12, v[52:55] offset:1024
  s_nop 2
  s_cbranch_vccnz KF_HR01
KF_HR01_B:
  s_waitcnt vmcnt(11)
  v_max3_u32 v160, v65, v67, v69
  v_max_u32 v160, v160, v71
  v_cmp_eq_u32 vcc, -1, v160
  ds_write_b128 v12, v[56:59] offset:2048
  ds_write_b128 v12, v[60:63] offset:3072
  s_nop 2
  s_cbranch_vccnz KF_HR02
KF_HR02_B:
  s_waitcnt vmcnt(6)
  v_max3_u32 v160, v73, v75, v137
  v_max3_u32 v160, v160, v139, v141
  v_max_u32 v160, v160, v143
  v_cmp_eq_u32 vcc, -1, v160
  ds_write_b128 v12, v[64:67] offset:4096
  ds_write_b128 v12, v[68:71] offset:5120
  s_nop 2
  s_cbranch_vccnz KF_HR03
KF_HR03_B:
  ds_write_b128 v12, v[72:75] offset:6144
  v_add_f32 v136, v136, v138
  v_add_f32 v137, v137, v139
  v_add_f32 v140, v140, v142
  v_add_f32 v141, v141, v143
  v_add_f32 v136, v136, v140
  v_add_f32 v137, v137, v141
  ds_write_b64 v248, v[136:137] offset:0
  s_waitcnt lgkmcnt(0)
  s_barrier
  ds_read_b128 v[96:99], v249 offset:0
  ds_read_b128 v[100:103], v249 offset:16
  ds_read_b128 v[104:107], v249 offset:32
  ds_read_b128 v[108:111], v249 offset:48
  ds_read_b128 v[80:83], v3 offset:0
  ds_read_b128 v[84:87], v3 offset:1024
  ds_read_b128 v[88:91], v3 offset:2048
  s_waitcnt lgkmcnt(2)
  v_mfma_f32_32x32x16_bf16 v[16:31], a[0:3], v[80:83], 0
  ds_read_b128 v[92:95], v3 offset:3072
  s_waitcnt lgkmcnt(2)
  v_mfma_f32_32x32x16_bf16 v[16:31], a[4:7], v[84:87], v[16:31]
  ds_read_b128 v[80:83], v4 offset:0
  buffer_load_dwordx4 a[240:243], v3, s[40:43], s67 offen offset:2048 sc1
  s_waitcnt lgkmcnt(2)
  v_mfma_f32_32x32x16_bf16 v[16:31], a[8:11], v[88:91], v[16:31]
  ds_read_b128 v[84:87], v4 offset:1024
  v_add_f32 v96, v96, v98
  v_add_f32 v97, v97, v99
  v_add_f32 v100, v100, v102
  v_add_f32 v101, v101, v103
  s_waitcnt lgkmcnt(2)
  v_mfma_f32_32x32x16_bf16 v[16:31], a[12:15], v[92:95], v[16:31]
  ds_read_b128 v[88:91], v4 offset:2048
  buffer_load_dwordx4 a[244:247], v3, s[40:43], s68 offen offset:2048 sc1
  v_add_f32 v96, v96, v100
  v_add_f32 v97, v97, v101
  v_add_f32 v104, v104, v106
  s_waitcnt lgkmcnt(2)
  v_mfma_f32_32x32x16_bf16 v[16:31], a[16:19], v[80:83], v[16:31]
  ds_read_b128 v[92:95], v4 offset:3072
  v_add_f32 v105, v105, v107
  v_add_f32 v108, v108, v110
  v_add_f32 v109, v109, v111
  v_add_f32 v104, v104, v108
  s_waitcnt lgkmcnt(2)
  v_mfma_f32_32x32x16_bf16 v[16:31], a[20:23], v[84:87], v[16:31]
  ds_read_b128 v[80:83], v5 offset:0
  buffer_load_dwordx4 a[248:251], v3, s[40:43], s67 offen offset:3072 sc1
  v_add_f32 v105, v105, v109
  v_add_f32 v96, v96, v104
  v_add_f32 v97, v97, v105
  s_waitcnt lgkmcnt(2)
  v_mfma_f32_32x32x16_bf16 v[16:31], a[24:27], v[88:91], v[16:31]
  ds_read_b128 v[84:87], v5 offset:1024
  v_mul_f32 v96, 0x3b124925, v96
  v_mul_f32 v97, 0x3b124925, v97
  v_fma_f32 v97, -v96, v96, v97
  v_max_f32 v97, 0, v97
  s_waitcnt lgkmcnt(2)
  v_mfma_f32_32x32x16_bf16 v[16:31], a[28:31], v[92:95], v[16:31]
  ds_read_b128 v[88:91], v5 offset:2048
  buffer_load_dwordx4 a[252:255], v3, s[40:43], s68 offen offset:3072 sc1
  v_cvt_pk_bf16_f32 v128, -v96, -v96
  v_cvt_pk_bf16_f32 v98, v97, v97
  v_and_b32 v98, 0xffff0000, v98
  s_waitcnt lgkmcnt(2)
  v_mfma_f32_32x32x16_bf16 v[16:31], a[32:35], v[80:83], v[16:31]
  ds_read_b128 v[92:95], v5 offset:3072
  v_add_f32 v98, 0x3727c5ac, v98
  v_cvt_pk_bf16_f32 v98, v98, v98
  v_and_b32 v98, 0xffff0000, v98
  v_sqrt_f32 v98, v98
  s_waitcnt lgkmcnt(2)
  v_mfma_f32_32x32x16_bf16 v[16:31], a[36:39], v[84:87], v[16:31]
  ds_read_b128 v[80:83], v6 offset:0
  v_cvt_pk_bf16_f32 v98, v98, v98
  v_and_b32 v98, 0xffff0000, v98
  v_rcp_f32 v252, v98
  s_waitcnt lgkmcnt(2)
  v_mfma_f32_32x32x16_bf16 v[16:31], a[40:43], v[88:91], v[16:31]
  ds_read_b128 v[84:87], v6 offset:1024
  v_mul_f32 v254, 0xbfb8aa3b, v252
  v_mov_b32 v129, 0
  v_mov_b32 v130, 0
  v_mov_b32 v131, 0
  s_waitcnt lgkmcnt(2)
  v_mfma_f32_32x32x16_bf16 v[16:31], a[44:47], v[92:95], v[16:31]
  ds_read_b128 v[88:91], v6 offset:2048
  s_waitcnt vmcnt(8)
  v_add_f32 v112, v112, v113
  v_add_f32 v114, v114, v115
  s_waitcnt lgkmcnt(2)
  v_mfma_f32_32x32x16_bf16 v[16:31], a[48:51], v[80:83], v[16:31]
  ds_read_b128 v[92:95], v6 offset:3072
  v_add_f32 v112, v112, v114
  v_mov_b32 v113, v112
  s_nop 1
  v_permlane32_swap_b32 v112, v113
  v_add_f32 v112, v112, v113
  s_waitcnt lgkmcnt(2)
  v_mfma_f32_32x32x16_bf16 v[16:31], a[52:55], v[84:87], v[16:31]
  ds_read_b128 v[80:83], v7 offset:0
  v_cvt_pk_bf16_f32 v113, v112, v112
  v_and_b32 v113, 0xffff0000, v113
  v_sub_f32 v113, v112, v113
  s_waitcnt lgkmcnt(2)
  v_mfma_f32_32x32x16_bf16 v[16:31], a[56:59], v[88:91], v[16:31]
  ds_read_b128 v[84:87], v7 offset:1024
  v_cvt_pk_bf16_f32 v120, v112, v113
  v_cndmask_b32 v120, v120, 0, s[52:53]
  v_mov_b32 v121, 0
  v_mov_b32 v122, 0
  s_waitcnt lgkmcnt(2)
  v_mfma_f32_32x32x16_bf16 v[16:31], a[60:63], v[92:95], v[16:31]
  ds_read_b128 v[88:91], v7 offset:2048
  v_mov_b32 v123, 0
  v_add_f32 v116, v116, v117
  v_add_f32 v118, v118, v119
  s_waitcnt lgkmcnt(2)
  v_mfma_f32_32x32x16_bf16 v[16:31], a[64:67], v[80:83], v[16:31]
  ds_read_b128 v[92:95], v7 offset:3072
  v_add_f32 v116, v116, v118
  v_mov_b32 v117, v116
  s_nop 1
  v_permlane32_swap_b32 v116, v117
  v_add_f32 v116, v116, v117
  s_waitcnt lgkmcnt(2)
  v_mfma_f32_32x32x16_bf16 v[16:31], a[68:71], v[84:87], v[16:31]
  ds_read_b128 v[80:83], v8 offset:0
  buffer_load_dwordx4 v[48:51], v2, s[40:43], s55 offen offset:0 sc1
  buffer_load_dwordx4 v[52:55], v2, s[40:43], s55 offen offset:1024 sc1
  v_cvt_pk_bf16_f32 v117, v116, v116
  v_and_b32 v117, 0xffff0000, v117
  v_sub_f32 v117, v116, v117
  s_waitcnt lgkmcnt(2)
  v_mfma_f32_32x32x16_bf16 v[16:31], a[72:75], v[88:91], v[16:31]
  ds_read_b128 v[84:87], v8 offset:1024
  v_cvt_pk_bf16_f32 v124, v116, v117
  v_cndmask_b32 v124, v124, 0, s[52:53]
  v_mov_b32 v125, 0
  v_mov_b32 v126, 0
  s_waitcnt lgkmcnt(2)
  v_mfma_f32_32x32x16_bf16 v[16:31], a[76:79], v[92:95], v[16:31]
  ds_read_b128 v[88:91], v8 offset:2048
  buffer_load_dwordx4 v[56:59], v2, s[40:43], s55 offen offset:2048 sc1
  buffer_load_dwordx4 v[60:63], v2, s[40:43], s55 offen offset:3072 sc1
  v_mov_b32 v127, 0
  s_waitcnt lgkmcnt(2)
  v_mfma_f32_32x32x16_bf16 v[16:31], a[80:83], v[80:83], v[16:31]
  ds_read_b128 v[92:95], v8 offset:3072
  s_waitcnt lgkmcnt(2)
  v_mfma_f32_32x32x16_bf16 v[16:31], a[84:87], v[84:87], v[16:31]
  ds_read_b128 v[80:83], v9 offset:0
  buffer_load_dwordx4 v[64:67], v10, s[40:43], s55 offen offset:0 sc1
  buffer_load_dwordx4 v[68:71], v10, s[40:43], s55 offen offset:1024 sc1
  s_waitcnt lgkmcnt(2)
  v_mfma_f32_32x32x16_bf16 v[16:31], a[88:91], v[88:91], v[16:31]
  ds_read_b128 v[84:87], v9 offset:1024
  s_waitcnt lgkmcnt(2)
  v_mfma_f32_32x32x16_bf16 v[16:31], a[92:95], v[92:95], v[16:31]
  ds_read_b128 v[88:91], v9 offset:2048
  buffer_load_dwordx4 v[72:75], v10, s[40:43], s55 offen offset:2048 sc1
  buffer_load_dwordx4 v[76:79], v10, s[40:43], s55 offen offset:3072 sc1
  s_waitcnt lgkmcnt(2)
  v_mfma_f32_32x32x16_bf16 v[16:31], a[96:99], v[80:83], v[16:31]
  ds_read_b128 v[92:95], v9 offset:3072
  s_waitcnt lgkmcnt(2)
  v_mfma_f32_32x32x16_bf16 v[16:31], a[100:103], v[84:87], v[16:31]
  s_waitcnt lgkmcnt(1)
  v_mfma_f32_32x32x16_bf16 v[16:31], a[104:107], v[88:91], v[16:31]
  s_waitcnt lgkmcnt(0)
  v_mfma_f32_32x32x16_bf16 v[16:31], a[108:111], v[92:95], v[16:31]
  v_mfma_f32_32x32x16_bf16 v[16:31], v[120:123], v[128:131], v[16:31]
  ds_read_b64_tr_b16 v[176:177], v172 offset:0
  ds_read_b64_tr_b16 v[178:179], v172 offset:1024
  ds_read_b64_tr_b16 v[180:181], v173 offset:0
  ds_read_b64_tr_b16 v[182:183], v173 offset:1024
  ds_read_b64_tr_b16 v[184:185], v172 offset:2048
  ds_read_b64_tr_b16 v[186:187], v172 offset:3072
  ds_read_b64_tr_b16 v[188:189], v173 offset:2048
  ds_read_b64_tr_b16 v[190:191], v173 offset:3072
  ds_read_b64_tr_b16 v[192:193], v172 offset:3584
  ds_read_b64_tr_b16 v[194:195], v172 offset:4608
  ds_read_b64_tr_b16 v[196:197], v173 offset:3584
  ds_read_b64_tr_b16 v[198:199], v173 offset:4608
  s_waitcnt vmcnt(6)
  v_max3_u32 v160, v49, v51, v53
  v_max_u32 v160, v160, v55
  v_cmp_eq_u32 vcc, -1, v160
  v_mul_f32 v240, v16, v254
  v_mul_f32 v241, v17, v254
  v_mul_f32 v242, v18, v254
  v_mul_f32 v243, v19, v254
  s_nop 0
  s_cbranch_vccnz KF_WR10
KF_WR10_B:
  s_waitcnt lgkmcnt(8)
  v_mfma_f32_32x32x16_bf16 v[208:223], v[176:179], v[48:51], 0
  ds_read_b64_tr_b16 v[200:201], v172 offset:5632
  ds_read_b64_tr_b16 v[202:203], v172 offset:6656
  ds_read_b64_tr_b16 v[204:205], v173 offset:5632
  ds_read_b64_tr_b16 v[206:207], v173 offset:6656
  v_mfma_f32_32x32x16_bf16 v[224:239], v[180:183], v[48:51], 0
  s_waitcnt vmcnt(4)
  v_max3_u32 v160, v57, v59, v61
  v_max_u32 v160, v160, v63
  v_cmp_eq_u32 vcc, -1, v160
  s_waitcnt lgkmcnt(8)
  v_mfma_f32_32x32x16_bf16 v[208:223], v[184:187], v[52:55], v[208:223]
  ds_read_b64_tr_b16 v[176:177], v172 offset:7168
  ds_read_b64_tr_b16 v[178:179], v172 offset:8192
  ds_read_b64_tr_b16 v[180:181], v173 offset:7168
  ds_read_b64_tr_b16 v[182:183], v173 offset:8192
  v_mfma_f32_32x32x16_bf16 v[224:239], v[188:191], v[52:55], v[224:239]
  v_exp_f32 v240, v240
  v_exp_f32 v241, v241
  v_exp_f32 v242, v242
  s_cbranch_vccnz KF_WR11
KF_WR11_B:
  s_waitcnt lgkmcnt(8)
  v_mfma_f32_32x32x16_bf16 v[208:223], v[192:195], v[56:59], v[208:223]
  ds_read_b64_tr_b16 v[184:185], v172 offset:9216
  ds_read_b64_tr_b16 v[186:187], v172 offset:10240
  ds_read_b64_tr_b16 v[188:189], v173 offset:9216
  ds_read_b64_tr_b16 v[190:191], v173 offset:10240
  v_mfma_f32_32x32x16_bf16 v[224:239], v[196:199], v[56:59], v[224:239]
  s_waitcnt vmcnt(2)
  v_max3_u32 v160, v65, v67, v69
  v_max_u32 v160, v160, v71
  v_cmp_eq_u32 vcc, -1, v160
  s_waitcnt lgkmcnt(8)
  v_mfma_f32_32x32x16_bf16 v[208:223], v[200:203], v[60:63], v[208:223]
  ds_read_b64_tr_b16 v[192:193], v172 offset:10752
  ds_read_b64_tr_b16 v[194:195], v172 offset:11776
  ds_read_b64_tr_b16 v[196:197], v173 offset:10752
  ds_read_b64_tr_b16 v[198:199], v173 offset:11776
  v_mfma_f32_32x32x16_bf16 v[224:239], v[204:207], v[60:63], v[224:239]
  v_exp_f32 v243, v243
  v_add_f32 v240, 1.0, v240
  v_add_f32 v241, 1.0, v241
  v_add_f32 v242, 1.0, v242
  s_cbranch_vccnz KF_WR12
KF_WR12_B:
  s_waitcnt lgkmcnt(8)
  v_mfma_f32_32x32x16_bf16 v[208:223], v[176:179], v[64:67], v[208:223]
  ds_read_b64_tr_b16 v[200:201], v172 offset:12800
  ds_read_b64_tr_b16 v[202:203], v172 offset:13824
  ds_read_b64_tr_b16 v[204:205], v173 offset:12800
  ds_read_b64_tr_b16 v[206:207], v173 offset:13824
  v_mfma_f32_32x32x16_bf16 v[224:239], v[180:183], v[64:67], v[224:239]
  s_waitcnt vmcnt(0)
  v_max3_u32 v160, v73, v75, v77
  v_max_u32 v160, v160, v79
  v_cmp_eq_u32 vcc, -1, v160
  s_waitcnt lgkmcnt(8)
  v_mfma_f32_32x32x16_bf16 v[208:223], v[184:187], v[68:71], v[208:223]
  v_add_f32 v243, 1.0, v243
  v_rcp_f32 v240, v240
  v_rcp_f32 v241, v241
  v_mfma_f32_32x32x16_bf16 v[224:239], v[188:191], v[68:71], v[224:239]
  v_rcp_f32 v242, v242
  v_rcp_f32 v243, v243
  v_mul_f32 v16, v16, v240
  s_cbranch_vccnz KF_WR13
KF_WR13_B:
  s_waitcnt lgkmcnt(4)
  v_mfma_f32_32x32x16_bf16 v[208:223], v[192:195], v[72:75], v[208:223]
  v_mul_f32 v17, v17, v241
  v_mul_f32 v18, v18, v242
  v_mul_f32 v19, v19, v243
  v_cvt_pk_bf16_f32 v144, v16, v17
  v_cvt_pk_bf16_f32 v145, v18, v19
  v_mfma_f32_32x32x16_bf16 v[224:239], v[196:199], v[72:75], v[224:239]
  v_min_u32 v145, -2, v145
  v_mul_f32 v240, v20, v254
  v_mul_f32 v241, v21, v254
  v_mul_f32 v242, v22, v254
  v_mul_f32 v243, v23, v254
  s_waitcnt lgkmcnt(0)
  v_mfma_f32_32x32x16_bf16 v[208:223], v[200:203], v[76:79], v[208:223]
  v_exp_f32 v240, v240
  v_exp_f32 v241, v241
  v_exp_f32 v242, v242
  v_mfma_f32_32x32x16_bf16 v[224:239], v[204:207], v[76:79], v[224:239]
  v_exp_f32 v243, v243
  v_add_f32 v240, 1.0, v240
  v_add_f32 v241, 1.0, v241
  v_add_f32 v242, 1.0, v242
  v_add_f32 v243, 1.0, v243
  v_rcp_f32 v240, v240
  v_rcp_f32 v241, v241
  v_rcp_f32 v242, v242
  v_rcp_f32 v243, v243
  v_mul_f32 v20, v20, v240
  v_mul_f32 v21, v21, v241
  v_mul_f32 v22, v22, v242
  ds_write_b128 v11, v[208:211] offset:32768
  ds_write_b128 v11, v[212:215] offset:36864
  ds_write_b128 v11, v[216:219] offset:40960
  ds_write_b128 v11, v[220:223] offset:45056
  ds_write_b128 v11, v[224:227] offset:49152
  ds_write_b128 v11, v[228:231] offset:53248
  ds_write_b128 v11, v[232:235] offset:57344
  ds_write_b128 v11, v[236:239] offset:61440
  v_mul_f32 v23, v23, v243
  v_cvt_pk_bf16_f32 v146, v20, v21
  v_cvt_pk_bf16_f32 v147, v22, v23
  v_min_u32 v147, -2, v147
  buffer_store_dwordx4 v[144:147], v2, s[40:43], s48 offen offset:0 sc1
  v_mul_f32 v240, v24, v254
  v_mul_f32 v241, v25, v254
  v_mul_f32 v242, v26, v254
  s_waitcnt lgkmcnt(0)
  s_barrier
  ds_read_b128 v[48:51], v13 offset:32768
  ds_read_b128 v[52:55], v13 offset:36864
  ds_read_b128 v[56:59], v13 offset:33792
  ds_read_b128 v[60:63], v13 offset:37888
  ds_read_b128 v[64:67], v13 offset:34816
  ds_read_b128 v[68:71], v13 offset:38912
  ds_read_b128 v[72:75], v13 offset:35840
  ds_read_b128 v[76:79], v13 offset:39936
  v_permlane32_swap_b32 v168, v170
  v_permlane32_swap_b32 v169, v171
  v_lshlrev_b32 v176, 16, v168
  v_and_b32 v177, 0xffff0000, v168
  v_lshlrev_b32 v178, 16, v169
  v_and_b32 v179, 0xffff0000, v169
  v_lshlrev_b32 v180, 16, v170
  v_and_b32 v181, 0xffff0000, v170
  v_lshlrev_b32 v182, 16, v171
  v_and_b32 v183, 0xffff0000, v171
  s_waitcnt lgkmcnt(0)
  v_pk_add_f32 v[176:177], v[176:177], v[48:49]
  v_pk_add_f32 v[178:179], v[178:179], v[50:51]
  v_pk_add_f32 v[180:181], v[180:181], v[52:53]
  v_pk_add_f32 v[182:183], v[182:183], v[54:55]
  v_pk_add_f32 v[176:177], v[176:177], v[56:57]
  v_pk_add_f32 v[178:179], v[178:179], v[58:59]
  v_pk_add_f32 v[180:181], v[180:181], v[60:61]
  v_pk_add_f32 v[182:183], v[182:183], v[62:63]
  v_pk_add_f32 v[176:177], v[176:177], v[64:65]
  v_pk_add_f32 v[178:179], v[178:179], v[66:67]
  v_pk_add_f32 v[180:181], v[180:181], v[68:69]
  v_pk_add_f32 v[182:183], v[182:183], v[70:71]
  v_pk_add_f32 v[176:177], v[176:177], v[72:73]
  v_pk_add_f32 v[178:179], v[178:179], v[74:75]
  v_pk_add_f32 v[180:181], v[180:181], v[76:77]
  v_pk_add_f32 v[182:183], v[182:183], v[78:79]
  v_cvt_pk_bf16_f32 v168, v176, v177
  v_cvt_pk_bf16_f32 v169, v178, v179
  v_cvt_pk_bf16_f32 v170, v180, v181
  v_cvt_pk_bf16_f32 v171, v182, v183
  v_min_u32 v169, -2, v169
  v_min_u32 v171, -2, v171
  buffer_store_dwordx4 v[168:171], v2, s[40:43], s28 offen sc1
  buffer_store_dwordx2 v[168:169], v2, s[40:43], s29 offen sc1
  v_lshlrev_b32 v176, 16, v168
  v_and_b32 v177, 0xffff0000, v168
  v_lshlrev_b32 v178, 16, v169
  v_and_b32 v179, 0xffff0000, v169
  v_lshlrev_b32 v180, 16, v170
  v_and_b32 v181, 0xffff0000, v170
  v_lshlrev_b32 v182, 16, v171
  v_and_b32 v183, 0xffff0000, v171
  v_add_f32 v156, v176, v177
  v_add_f32 v158, v180, v181
  v_mul_f32 v157, v176, v176
  v_mul_f32 v159, v180, v180
  v_add_f32 v156, v156, v178
  v_add_f32 v158, v158, v182
  v_add_f32 v156, v156, v179
  v_add_f32 v158, v158, v183
  v_fmac_f32 v157, v177, v177
  v_fmac_f32 v159, v181, v181
  v_fmac_f32 v157, v178, v178
  v_fmac_f32 v159, v182, v182
  v_fmac_f32 v157, v179, v179
  v_fmac_f32 v159, v183, v183
  v_cndmask_b32 v158, v158, 0, s[74:75]
  v_cndmask_b32 v159, v159, 0, s[74:75]
  v_add_f32 v156, v156, v158
  v_add_f32 v157, v157, v159
  v_mov_b32 v158, v156
  v_mov_b32 v159, v157
  s_nop 0
  v_permlane32_swap_b32 v156, v158
  v_permlane32_swap_b32 v157, v159
  v_add_f32 v156, v156, v158
  v_add_f32 v157, v157, v159
  v_min_u32 v157, -2, v157
  buffer_store_dwordx2 v[156:157], v162, s[40:43], s31 offen sc1
  ds_read_b128 v[80:83], v3 offset:0
  ds_read_b128 v[84:87], v3 offset:1024
  ds_read_b128 v[88:91], v3 offset:2048
  s_barrier
  s_waitcnt lgkmcnt(2)
  v_mfma_f32_32x32x16_bf16 v[32:47], a[112:115], v[80:83], 0
  ds_read_b128 v[92:95], v3 offset:3072
  buffer_load_dwordx4 v[176:179], v4, s[40:43], s67 offen offset:0 sc1
  s_waitcnt lgkmcnt(2)
  v_mfma_f32_32x32x16_bf16 v[32:47], a[116:119], v[84:87], v[32:47]
  ds_read_b128 v[80:83], v4 offset:0
  buffer_load_dwordx4 v[180:183], v4, s[40:43], s68 offen offset:0 sc1
  s_waitcnt lgkmcnt(2)
  v_mfma_f32_32x32x16_bf16 v[32:47], a[120:123], v[88:91], v[32:47]
  ds_read_b128 v[84:87], v4 offset:1024
  buffer_load_dwordx4 v[184:187], v4, s[40:43], s67 offen offset:1024 sc1
  v_mul_f32 v243, v27, v254
  v_exp_f32 v240, v240
  s_waitcnt lgkmcnt(2)
  v_mfma_f32_32x32x16_bf16 v[32:47], a[124:127], v[92:95], v[32:47]
  ds_read_b128 v[88:91], v4 offset:2048
  buffer_load_dwordx4 v[188:191], v4, s[40:43], s68 offen offset:1024 sc1
  v_exp_f32 v241, v241
  v_exp_f32 v242, v242
  s_waitcnt lgkmcnt(2)
  v_mfma_f32_32x32x16_bf16 v[32:47], a[128:131], v[80:83], v[32:47]
  ds_read_b128 v[92:95], v4 offset:3072
  buffer_load_dwordx4 v[192:195], v4, s[40:43], s67 offen offset:2048 sc1
  v_exp_f32 v243, v243
  v_add_f32 v240, 1.0, v240
  s_waitcnt lgkmcnt(2)
  v_mfma_f32_32x32x16_bf16 v[32:47], a[132:135], v[84:87], v[32:47]
  ds_read_b128 v[80:83], v5 offset:0
  buffer_load_dwordx4 v[196:199], v4, s[40:43], s68 offen offset:2048 sc1
  v_add_f32 v241, 1.0, v241
  v_add_f32 v242, 1.0, v242
  v_add_f32 v243, 1.0, v243
  s_waitcnt lgkmcnt(2)
  v_mfma_f32_32x32x16_bf16 v[32:47], a[136:139], v[88:91], v[32:47]
  ds_read_b128 v[84:87], v5 offset:1024
  buffer_load_dwordx4 v[200:203], v4, s[40:43], s67 offen offset:3072 sc1
  v_rcp_f32 v240, v240
  v_rcp_f32 v241, v241
  s_waitcnt lgkmcnt(2)
  v_mfma_f32_32x32x16_bf16 v[32:47], a[140:143], v[92:95], v[32:47]
  ds_read_b128 v[88:91], v5 offset:2048
  buffer_load_dwordx4 v[204:207], v4, s[40:43], s68 offen offset:3072 sc1
  v_rcp_f32 v242, v242
  v_rcp_f32 v243, v243
  s_waitcnt lgkmcnt(2)
  v_mfma_f32_32x32x16_bf16 v[32:47], a[144:147], v[80:83], v[32:47]
  ds_read_b128 v[92:95], v5 offset:3072
  buffer_load_dwordx4 v[208:211], v5, s[40:43], s67 offen offset:0 sc1
  v_mul_f32 v24, v24, v240
  v_mul_f32 v25, v25, v241
  v_mul_f32 v26, v26, v242
  s_waitcnt lgkmcnt(2)
  v_mfma_f32_32x32x16_bf16 v[32:47], a[148:151], v[84:87], v[32:47]
  ds_read_b128 v[80:83], v6 offset:0
  buffer_load_dwordx4 v[212:215], v5, s[40:43], s68 offen offset:0 sc1
  v_mul_f32 v27, v27, v243
  v_cvt_pk_bf16_f32 v148, v24, v25
  v_cvt_pk_bf16_f32 v149, v26, v27
  s_waitcnt lgkmcnt(2)
  v_mfma_f32_32x32x16_bf16 v[32:47], a[152:155], v[88:91], v[32:47]
  ds_read_b128 v[84:87], v6 offset:1024
  buffer_load_dwordx4 v[216:219], v5, s[40:43], s67 offen offset:1024 sc1
  v_min_u32 v149, -2, v149
  v_mul_f32 v240, v28, v254
  v_mul_f32 v241, v29, v254
  s_waitcnt lgkmcnt(2)
  v_mfma_f32_32x32x16_bf16 v[32:47], a[156:159], v[92:95], v[32:47]
  ds_read_b128 v[88:91], v6 offset:2048
  buffer_load_dwordx4 v[220:223], v5, s[40:43], s68 offen offset:1024 sc1
  v_mul_f32 v242, v30, v254
  v_mul_f32 v243, v31, v254
  v_exp_f32 v240, v240
  s_waitcnt lgkmcnt(2)
  v_mfma_f32_32x32x16_bf16 v[32:47], a[160:163], v[80:83], v[32:47]
  ds_read_b128 v[92:95], v6 offset:3072
  buffer_load_dwordx4 v[224:227], v5, s[40:43], s67 offen offset:2048 sc1
  v_exp_f32 v241, v241
  v_exp_f32 v242, v242
  s_waitcnt lgkmcnt(2)
  v_mfma_f32_32x32x16_bf16 v[32:47], a[164:167], v[84:87], v[32:47]
  ds_read_b128 v[80:83], v7 offset:0
  buffer_load_dwordx4 v[228:231], v5, s[40:43], s68 offen offset:2048 sc1
  v_exp_f32 v243, v243
  v_add_f32 v240, 1.0, v240
  s_waitcnt lgkmcnt(2)
  v_mfma_f32_32x32x16_bf16 v[32:47], a[168:171], v[88:91], v[32:47]
  ds_read_b128 v[84:87], v7 offset:1024
  buffer_load_dwordx4 v[232:235], v5, s[40:43], s67 offen offset:3072 sc1
  v_add_f32 v241, 1.0, v241
  v_add_f32 v242, 1.0, v242
  v_add_f32 v243, 1.0, v243
  s_waitcnt lgkmcnt(2)
  v_mfma_f32_32x32x16_bf16 v[32:47], a[172:175], v[92:95], v[32:47]
  ds_read_b128 v[88:91], v7 offset:2048
  buffer_load_dwordx4 v[236:239], v5, s[40:43], s68 offen offset:3072 sc1
  v_rcp_f32 v240, v240
  v_rcp_f32 v241, v241
  s_waitcnt lgkmcnt(2)
  v_mfma_f32_32x32x16_bf16 v[32:47], a[176:179], v[80:83], v[32:47]
  ds_read_b128 v[92:95], v7 offset:3072
  buffer_load_dwordx4 v[48:51], v2, s[40:43], s57 offen offset:0 sc1
  buffer_load_dwordx4 v[52:55], v2, s[40:43], s57 offen offset:1024 sc1
  v_rcp_f32 v242, v242
  v_rcp_f32 v243, v243
  s_waitcnt lgkmcnt(2)
  v_mfma_f32_32x32x16_bf16 v[32:47], a[180:183], v[84:87], v[32:47]
  ds_read_b128 v[80:83], v8 offset:0
  buffer_load_dwordx4 v[56:59], v2, s[40:43], s57 offen offset:2048 sc1
  buffer_load_dwordx4 v[60:63], v2, s[40:43], s57 offen offset:3072 sc1
  v_mul_f32 v28, v28, v240
  v_mul_f32 v29, v29, v241
  v_mul_f32 v30, v30, v242
  s_waitcnt lgkmcnt(2)
  v_mfma_f32_32x32x16_bf16 v[32:47], a[184:187], v[88:91], v[32:47]
  ds_read_b128 v[84:87], v8 offset:1024
  buffer_load_dwordx4 v[64:67], v10, s[40:43], s57 offen offset:0 sc1
  buffer_load_dwordx4 v[68:71], v10, s[40:43], s57 offen offset:1024 sc1
  v_mul_f32 v31, v31, v243
  v_cvt_pk_bf16_f32 v150, v28, v29
  v_cvt_pk_bf16_f32 v151, v30, v31
  s_waitcnt lgkmcnt(2)
  v_mfma_f32_32x32x16_bf16 v[32:47], a[188:191], v[92:95], v[32:47]
  ds_read_b128 v[88:91], v8 offset:2048
  buffer_load_dwordx4 v[72:75], v10, s[40:43], s57 offen offset:2048 sc1
  buffer_load_dwordx2 v[136:137], v14, s[40:43], s59 offen offset:0 sc1
  buffer_load_dwordx2 v[138:139], v14, s[40:43], s59 offen offset:512 sc1
  buffer_load_dwordx2 v[140:141], v14, s[40:43], s59 offen offset:1024 sc1
  buffer_load_dwordx2 v[142:143], v14, s[40:43], s59 offen offset:1536 sc1
  v_min_u32 v151, -2, v151
  buffer_store_dwordx4 v[148:151], v2, s[40:43], s48 offen offset:1024 sc1
  s_waitcnt lgkmcnt(2)
  v_mfma_f32_32x32x16_bf16 v[32:47], a[192:195], v[80:83], v[32:47]
  ds_read_b128 v[92:95], v8 offset:3072
  s_waitcnt lgkmcnt(2)
  v_mfma_f32_32x32x16_bf16 v[32:47], a[196:199], v[84:87], v[32:47]
  ds_read_b128 v[80:83], v9 offset:0
  s_waitcnt lgkmcnt(2)
  v_mfma_f32_32x32x16_bf16 v[32:47], a[200:203], v[88:91], v[32:47]
  ds_read_b128 v[84:87], v9 offset:1024
  s_waitcnt lgkmcnt(2)
  v_mfma_f32_32x32x16_bf16 v[32:47], a[204:207], v[92:95], v[32:47]
  ds_read_b128 v[88:91], v9 offset:2048
  s_waitcnt lgkmcnt(2)
  v_mfma_f32_32x32x16_bf16 v[32:47], a[208:211], v[80:83], v[32:47]
  ds_read_b128 v[92:95], v9 offset:3072
  s_waitcnt lgkmcnt(2)
  v_mfma_f32_32x32x16_bf16 v[32:47], a[212:215], v[84:87], v[32:47]
  s_waitcnt lgkmcnt(1)
  v_mfma_f32_32x32x16_bf16 v[32:47], a[216:219], v[88:91], v[32:47]
  s_waitcnt lgkmcnt(0)
  v_mfma_f32_32x32x16_bf16 v[32:47], a[220:223], v[92:95], v[32:47]
  v_mfma_f32_32x32x16_bf16 v[32:47], v[124:127], v[128:131], v[32:47]
  s_nop 11
  v_pk_mul_f32 v[240:241], v[32:33], v[254:255] op_sel:[0,0] op_sel_hi:[1,0]
  v_pk_mul_f32 v[242:243], v[34:35], v[254:255] op_sel:[0,0] op_sel_hi:[1,0]
  v_exp_f32 v240, v240
  v_exp_f32 v241, v241
  v_exp_f32 v242, v242
  v_exp_f32 v243, v243
  v_add_f32 v240, 1.0, v240
  v_add_f32 v241, 1.0, v241
  v_add_f32 v242, 1.0, v242
  v_add_f32 v243, 1.0, v243
  v_rcp_f32 v240, v240
  v_rcp_f32 v241, v241
  v_rcp_f32 v242, v242
  v_rcp_f32 v243, v243
  v_pk_mul_f32 v[32:33], v[32:33], v[240:241]
  v_pk_mul_f32 v[34:35], v[34:35], v[242:243]
  v_cvt_pk_bf16_f32 v152, v32, v33
  v_cvt_pk_bf16_f32 v153, v34, v35
  v_min_u32 v153, -2, v153
  v_pk_mul_f32 v[240:241], v[36:37], v[254:255] op_sel:[0,0] op_sel_hi:[1,0]
  v_pk_mul_f32 v[242:243], v[38:39], v[254:255] op_sel:[0,0] op_sel_hi:[1,0]
  v_exp_f32 v240, v240
  v_exp_f32 v241, v241
  v_exp_f32 v242, v242
  v_exp_f32 v243, v243
  v_add_f32 v240, 1.0, v240
  v_add_f32 v241, 1.0, v241
  v_add_f32 v242, 1.0, v242
  v_add_f32 v243, 1.0, v243
  v_rcp_f32 v240, v240
  v_rcp_f32 v241, v241
  v_rcp_f32 v242, v242
  v_rcp_f32 v243, v243
  v_pk_mul_f32 v[36:37], v[36:37], v[240:241]
  v_pk_mul_f32 v[38:39], v[38:39], v[242:243]
  v_cvt_pk_bf16_f32 v154, v36, v37
  v_cvt_pk_bf16_f32 v155, v38, v39
  v_min_u32 v155, -2, v155
  buffer_store_dwordx4 v[152:155], v2, s[40:43], s49 offen offset:0 sc1
  v_pk_mul_f32 v[240:241], v[40:41], v[254:255] op_sel:[0,0] op_sel_hi:[1,0]
  v_pk_mul_f32 v[242:243], v[42:43], v[254:255] op_sel:[0,0] op_sel_hi:[1,0]
  v_exp_f32 v240, v240
  v_exp_f32 v241, v241
  v_exp_f32 v242, v242
  v_exp_f32 v243, v243
  v_add_f32 v240, 1.0, v240
  v_add_f32 v241, 1.0, v241
  v_add_f32 v242, 1.0, v242
  v_add_f32 v243, 1.0, v243
  v_rcp_f32 v240, v240
  v_rcp_f32 v241, v241
  v_rcp_f32 v242, v242
  v_rcp_f32 v243, v243
  v_pk_mul_f32 v[40:41], v[40:41], v[240:241]
  v_pk_mul_f32 v[42:43], v[42:43], v[242:243]
  v_cvt_pk_bf16_f32 v156, v40, v41
  v_cvt_pk_bf16_f32 v157, v42, v43
  v_min_u32 v157, -2, v157
  v_pk_mul_f32 v[240:241], v[44:45], v[254:255] op_sel:[0,0] op_sel_hi:[1,0]
  v_pk_mul_f32 v[242:243], v[46:47], v[254:255] op_sel:[0,0] op_sel_hi:[1,0]
  v_exp_f32 v240, v240
  v_exp_f32 v241, v241
  v_exp_f32 v242, v242
  v_exp_f32 v243, v243
  v_add_f32 v240, 1.0, v240
  v_add_f32 v241, 1.0, v241
  v_add_f32 v242, 1.0, v242
  v_add_f32 v243, 1.0, v243
  v_rcp_f32 v240, v240
  v_rcp_f32 v241, v241
  v_rcp_f32 v242, v242
  v_rcp_f32 v243, v243
  v_pk_mul_f32 v[44:45], v[44:45], v[240:241]
  v_pk_mul_f32 v[46:47], v[46:47], v[242:243]
  v_cvt_pk_bf16_f32 v158, v44, v45
  v_cvt_pk_bf16_f32 v159, v46, v47
  v_min_u32 v159, -2, v159
  buffer_store_dwordx4 v[156:159], v2, s[40:43], s49 offen offset:1024 sc1
  s_waitcnt vmcnt(9)
  v_max3_u32 v160, v49, v51, v53
  v_max_u32 v160, v160, v55
  v_cmp_eq_u32 vcc, -1, v160
  s_nop 3
  s_nop 0
  s_cbranch_vccnz KF_HR10
KF_HR10_B:
  s_waitcnt vmcnt(7)
  v_max3_u32 v160, v57, v59, v61
  v_max_u32 v160, v160, v63
  v_cmp_eq_u32 vcc, -1, v160
  ds_write_b128 v12, v[48:51] offset:28672
  ds_write_b128 v12, v[52:55] offset:29696
  s_nop 2
  s_cbranch_vccnz KF_HR11
KF_HR11_B:
  s_waitcnt vmcnt(5)
  v_max3_u32 v160, v65, v67, v69
  v_max_u32 v160, v160, v71
  v_cmp_eq_u32 vcc, -1, v160
  ds_write_b128 v12, v[56:59] offset:30720
  ds_write_b128 v12, v[60:63] offset:31744
  s_nop 2
  s_cbranch_vccnz KF_HR12
KF_HR12_B:
  s_waitcnt vmcnt(0)
  v_max3_u32 v160, v73, v75, v137
  v_max3_u32 v160, v160, v139, v141
  v_max_u32 v160, v160, v143
  v_cmp_eq_u32 vcc, -1, v160
  ds_write_b128 v12, v[64:67] offset:32768
  ds_write_b128 v12, v[68:71] offset:33792
  s_nop 2
  s_cbranch_vccnz KF_HR13
KF_HR13_B:
  ds_write_b128 v12, v[72:75] offset:34816
  v_add_f32 v136, v136, v138
  v_add_f32 v137, v137, v139
  v_add_f32 v140, v140, v142
  v_add_f32 v141, v141, v143
  v_add_f32 v136, v136, v140
  v_add_f32 v137, v137, v141
  ds_write_b64 v248, v[136:137] offset:2048
  s_waitcnt lgkmcnt(0)
  s_barrier
  ds_read_b128 v[96:99], v249 offset:2048
  ds_read_b128 v[100:103], v249 offset:2064
  ds_read_b128 v[104:107], v249 offset:2080
  ds_read_b128 v[108:111], v249 offset:2096
  ds_read_b128 v[80:83], v3 offset:28672
  ds_read_b128 v[84:87], v3 offset:29696
  ds_read_b128 v[88:91], v3 offset:30720
  s_waitcnt lgkmcnt(2)
  v_mfma_f32_32x32x16_bf16 v[48:63], a[0:3], v[80:83], 0
  ds_read_b128 v[92:95], v3 offset:31744
  s_waitcnt lgkmcnt(2)
  v_mfma_f32_32x32x16_bf16 v[48:63], a[4:7], v[84:87], v[48:63]
  ds_read_b128 v[80:83], v4 offset:28672
  buffer_load_dwordx4 a[0:3], v6, s[40:43], s67 offen offset:0 sc1
  s_waitcnt lgkmcnt(2)
  v_mfma_f32_32x32x16_bf16 v[48:63], a[8:11], v[88:91], v[48:63]
  ds_read_b128 v[84:87], v4 offset:29696
  buffer_load_dwordx4 a[4:7], v6, s[40:43], s68 offen offset:0 sc1
  v_add_f32 v96, v96, v98
  v_add_f32 v97, v97, v99
  v_add_f32 v100, v100, v102
  s_waitcnt lgkmcnt(2)
  v_mfma_f32_32x32x16_bf16 v[48:63], a[12:15], v[92:95], v[48:63]
  ds_read_b128 v[88:91], v4 offset:30720
  buffer_load_dwordx4 a[8:11], v6, s[40:43], s67 offen offset:1024 sc1
  v_add_f32 v101, v101, v103
  v_add_f32 v96, v96, v100
  v_add_f32 v97, v97, v101
  s_waitcnt lgkmcnt(2)
  v_mfma_f32_32x32x16_bf16 v[48:63], a[16:19], v[80:83], v[48:63]
  ds_read_b128 v[92:95], v4 offset:31744
  buffer_load_dwordx4 a[12:15], v6, s[40:43], s68 offen offset:1024 sc1
  v_add_f32 v104, v104, v106
  v_add_f32 v105, v105, v107
  v_add_f32 v108, v108, v110
  s_waitcnt lgkmcnt(2)
  v_mfma_f32_32x32x16_bf16 v[48:63], a[20:23], v[84:87], v[48:63]
  ds_read_b128 v[80:83], v5 offset:28672
  buffer_load_dwordx4 a[16:19], v6, s[40:43], s67 offen offset:2048 sc1
  v_add_f32 v109, v109, v111
  v_add_f32 v104, v104, v108
  v_add_f32 v105, v105, v109
  s_waitcnt lgkmcnt(2)
  v_mfma_f32_32x32x16_bf16 v[48:63], a[24:27], v[88:91], v[48:63]
  ds_read_b128 v[84:87], v5 offset:29696
  buffer_load_dwordx4 a[20:23], v6, s[40:43], s68 offen offset:2048 sc1
  v_add_f32 v96, v96, v104
  v_add_f32 v97, v97, v105
  v_mul_f32 v96, 0x3b124925, v96
  s_waitcnt lgkmcnt(2)
  v_mfma_f32_32x32x16_bf16 v[48:63], a[28:31], v[92:95], v[48:63]
  ds_read_b128 v[88:91], v5 offset:30720
  buffer_load_dwordx4 a[24:27], v6, s[40:43], s67 offen offset:3072 sc1
  v_mul_f32 v97, 0x3b124925, v97
  v_fma_f32 v97, -v96, v96, v97
  v_max_f32 v97, 0, v97
  s_waitcnt lgkmcnt(2)
  v_mfma_f32_32x32x16_bf16 v[48:63], a[32:35], v[80:83], v[48:63]
  ds_read_b128 v[92:95], v5 offset:31744
  buffer_load_dwordx4 a[28:31], v6, s[40:43], s68 offen offset:3072 sc1
  v_cvt_pk_bf16_f32 v132, -v96, -v96
  v_cvt_pk_bf16_f32 v98, v97, v97
  v_and_b32 v98, 0xffff0000, v98
  s_waitcnt lgkmcnt(2)
  v_mfma_f32_32x32x16_bf16 v[48:63], a[36:39], v[84:87], v[48:63]
  ds_read_b128 v[80:83], v6 offset:28672
  buffer_load_dwordx4 a[32:35], v7, s[40:43], s67 offen offset:0 sc1
  v_add_f32 v98, 0x3727c5ac, v98
  v_cvt_pk_bf16_f32 v98, v98, v98
  v_and_b32 v98, 0xffff0000, v98
  s_waitcnt lgkmcnt(2)
  v_mfma_f32_32x32x16_bf16 v[48:63], a[40:43], v[88:91], v[48:63]
  ds_read_b128 v[84:87], v6 offset:29696
  buffer_load_dwordx4 a[36:39], v7, s[40:43], s68 offen offset:0 sc1
  v_sqrt_f32 v98, v98
  s_nop 0
  v_cvt_pk_bf16_f32 v98, v98, v98
  s_waitcnt lgkmcnt(2)
  v_mfma_f32_32x32x16_bf16 v[48:63], a[44:47], v[92:95], v[48:63]
  ds_read_b128 v[88:91], v6 offset:30720
  buffer_load_dwordx4 a[40:43], v7, s[40:43], s67 offen offset:1024 sc1
  v_and_b32 v98, 0xffff0000, v98
  v_rcp_f32 v253, v98
  s_waitcnt lgkmcnt(2)
  v_mfma_f32_32x32x16_bf16 v[48:63], a[48:51], v[80:83], v[48:63]
  ds_read_b128 v[92:95], v6 offset:31744
  buffer_load_dwordx4 a[44:47], v7, s[40:43], s68 offen offset:1024 sc1
  v_mul_f32 v255, 0xbfb8aa3b, v253
  v_mov_b32 v133, 0
  v_mov_b32 v134, 0
  s_waitcnt lgkmcnt(2)
  v_mfma_f32_32x32x16_bf16 v[48:63], a[52:55], v[84:87], v[48:63]
  ds_read_b128 v[80:83], v7 offset:28672
  buffer_load_dwordx4 a[48:51], v7, s[40:43], s67 offen offset:2048 sc1
  v_mov_b32 v135, 0
  s_waitcnt lgkmcnt(2)
  v_mfma_f32_32x32x16_bf16 v[48:63], a[56:59], v[88:91], v[48:63]
  ds_read_b128 v[84:87], v7 offset:29696
  buffer_load_dwordx4 a[52:55], v7, s[40:43], s68 offen offset:2048 sc1
  s_waitcnt lgkmcnt(2)
  v_mfma_f32_32x32x16_bf16 v[48:63], a[60:63], v[92:95], v[48:63]
  ds_read_b128 v[88:91], v7 offset:30720
  buffer_load_dwordx4 a[56:59], v7, s[40:43], s67 offen offset:3072 sc1
  s_waitcnt lgkmcnt(2)
  v_mfma_f32_32x32x16_bf16 v[48:63], a[64:67], v[80:83], v[48:63]
  ds_read_b128 v[92:95], v7 offset:31744
  buffer_load_dwordx4 a[60:63], v7, s[40:43], s68 offen offset:3072 sc1
  s_waitcnt lgkmcnt(2)
  v_mfma_f32_32x32x16_bf16 v[48:63], a[68:71], v[84:87], v[48:63]
  ds_read_b128 v[80:83], v8 offset:28672
  buffer_load_dwordx4 a[64:67], v8, s[40:43], s67 offen offset:0 sc1
  s_waitcnt lgkmcnt(2)
  v_mfma_f32_32x32x16_bf16 v[48:63], a[72:75], v[88:91], v[48:63]
  ds_read_b128 v[84:87], v8 offset:29696
  buffer_load_dwordx4 a[68:71], v8, s[40:43], s68 offen offset:0 sc1
  s_waitcnt lgkmcnt(2)
  v_mfma_f32_32x32x16_bf16 v[48:63], a[76:79], v[92:95], v[48:63]
  ds_read_b128 v[88:91], v8 offset:30720
  buffer_load_dwordx4 a[72:75], v8, s[40:43], s67 offen offset:1024 sc1
  s_waitcnt lgkmcnt(2)
  v_mfma_f32_32x32x16_bf16 v[48:63], a[80:83], v[80:83], v[48:63]
  ds_read_b128 v[92:95], v8 offset:31744
  buffer_load_dwordx4 a[76:79], v8, s[40:43], s68 offen offset:1024 sc1
  s_waitcnt lgkmcnt(2)
  v_mfma_f32_32x32x16_bf16 v[48:63], a[84:87], v[84:87], v[48:63]
  ds_read_b128 v[80:83], v9 offset:28672
  buffer_load_dwordx4 a[80:83], v8, s[40:43], s67 offen offset:2048 sc1
  s_waitcnt lgkmcnt(2)
  v_mfma_f32_32x32x16_bf16 v[48:63], a[88:91], v[88:91], v[48:63]
  ds_read_b128 v[84:87], v9 offset:29696
  buffer_load_dwordx4 a[84:87], v8, s[40:43], s68 offen offset:2048 sc1
  s_waitcnt lgkmcnt(2)
  v_mfma_f32_32x32x16_bf16 v[48:63], a[92:95], v[92:95], v[48:63]
  ds_read_b128 v[88:91], v9 offset:30720
  buffer_load_dwordx4 a[88:91], v8, s[40:43], s67 offen offset:3072 sc1
  s_waitcnt lgkmcnt(2)
  v_mfma_f32_32x32x16_bf16 v[48:63], a[96:99], v[80:83], v[48:63]
  ds_read_b128 v[92:95], v9 offset:31744
  buffer_load_dwordx4 a[92:95], v8, s[40:43], s68 offen offset:3072 sc1
  s_waitcnt lgkmcnt(2)
  v_mfma_f32_32x32x16_bf16 v[48:63], a[100:103], v[84:87], v[48:63]
  ds_read_b128 v[80:83], v3 offset:28672
  buffer_load_dwordx4 a[96:99], v9, s[40:43], s67 offen offset:0 sc1
  s_waitcnt lgkmcnt(2)
  v_mfma_f32_32x32x16_bf16 v[48:63], a[104:107], v[88:91], v[48:63]
  ds_read_b128 v[84:87], v3 offset:29696
  buffer_load_dwordx4 a[100:103], v9, s[40:43], s68 offen offset:0 sc1
  s_waitcnt lgkmcnt(2)
  v_mfma_f32_32x32x16_bf16 v[48:63], a[108:111], v[92:95], v[48:63]
  ds_read_b128 v[88:91], v3 offset:30720
  buffer_load_dwordx4 a[104:107], v9, s[40:43], s67 offen offset:1024 sc1
  v_mfma_f32_32x32x16_bf16 v[48:63], v[120:123], v[132:135], v[48:63]
  s_waitcnt lgkmcnt(2)
  v_mfma_f32_32x32x16_bf16 v[64:79], a[112:115], v[80:83], 0
  ds_read_b128 v[92:95], v3 offset:31744
  s_waitcnt lgkmcnt(2)
  v_mfma_f32_32x32x16_bf16 v[64:79], a[116:119], v[84:87], v[64:79]
  ds_read_b128 v[80:83], v4 offset:28672
  buffer_load_dwordx4 a[108:111], v9, s[40:43], s68 offen offset:1024 sc1
  s_waitcnt lgkmcnt(2)
  v_mfma_f32_32x32x16_bf16 v[64:79], a[120:123], v[88:91], v[64:79]
  ds_read_b128 v[84:87], v4 offset:29696
  buffer_load_dwordx4 a[112:115], v9, s[40:43], s67 offen offset:2048 sc1
  s_nop 0
  v_mul_f32 v240, v48, v255
  v_mul_f32 v241, v49, v255
  v_mul_f32 v242, v50, v255
  s_waitcnt lgkmcnt(2)
  v_mfma_f32_32x32x16_bf16 v[64:79], a[124:127], v[92:95], v[64:79]
  ds_read_b128 v[88:91], v4 offset:30720
  buffer_load_dwordx4 a[116:119], v9, s[40:43], s68 offen offset:2048 sc1
  v_mul_f32 v243, v51, v255
  v_exp_f32 v240, v240
  s_waitcnt lgkmcnt(2)
  v_mfma_f32_32x32x16_bf16 v[64:79], a[128:131], v[80:83], v[64:79]
  ds_read_b128 v[92:95], v4 offset:31744
  buffer_load_dwordx4 a[120:123], v9, s[40:43], s67 offen offset:3072 sc1
  v_exp_f32 v241, v241
  v_exp_f32 v242, v242
  s_waitcnt lgkmcnt(2)
  v_mfma_f32_32x32x16_bf16 v[64:79], a[132:135], v[84:87], v[64:79]
  ds_read_b128 v[80:83], v5 offset:28672
  buffer_load_dwordx4 a[124:127], v9, s[40:43], s68 offen offset:3072 sc1
  v_exp_f32 v243, v243
  v_add_f32 v240, 1.0, v240
  s_waitcnt lgkmcnt(2)
  v_mfma_f32_32x32x16_bf16 v[64:79], a[136:139], v[88:91], v[64:79]
  ds_read_b128 v[84:87], v5 offset:29696
  v_add_f32 v241, 1.0, v241
  v_add_f32 v242, 1.0, v242
  v_add_f32 v243, 1.0, v243
  v_rcp_f32 v240, v240
  s_waitcnt lgkmcnt(2)
  v_mfma_f32_32x32x16_bf16 v[64:79], a[140:143], v[92:95], v[64:79]
  ds_read_b128 v[88:91], v5 offset:30720
  v_rcp_f32 v241, v241
  v_rcp_f32 v242, v242
  s_waitcnt lgkmcnt(2)
  v_mfma_f32_32x32x16_bf16 v[64:79], a[144:147], v[80:83], v[64:79]
  ds_read_b128 v[92:95], v5 offset:31744
  v_rcp_f32 v243, v243
  v_mul_f32 v48, v48, v240
  v_mul_f32 v49, v49, v241
  s_waitcnt lgkmcnt(2)
  v_mfma_f32_32x32x16_bf16 v[64:79], a[148:151], v[84:87], v[64:79]
  ds_read_b128 v[80:83], v6 offset:28672
  v_mul_f32 v50, v50, v242
  v_mul_f32 v51, v51, v243
  v_cvt_pk_bf16_f32 v144, v48, v49
  v_cvt_pk_bf16_f32 v145, v50, v51
  s_waitcnt lgkmcnt(2)
  v_mfma_f32_32x32x16_bf16 v[64:79], a[152:155], v[88:91], v[64:79]
  ds_read_b128 v[84:87], v6 offset:29696
  v_min_u32 v145, -2, v145
  v_mul_f32 v240, v52, v255
  v_mul_f32 v241, v53, v255
  v_mul_f32 v242, v54, v255
  s_waitcnt lgkmcnt(2)
  v_mfma_f32_32x32x16_bf16 v[64:79], a[156:159], v[92:95], v[64:79]
  ds_read_b128 v[88:91], v6 offset:30720
  v_mul_f32 v243, v55, v255
  v_exp_f32 v240, v240
  v_exp_f32 v241, v241
  s_waitcnt lgkmcnt(2)
  v_mfma_f32_32x32x16_bf16 v[64:79], a[160:163], v[80:83], v[64:79]
  ds_read_b128 v[92:95], v6 offset:31744
  v_exp_f32 v242, v242
  v_exp_f32 v243, v243
  s_waitcnt lgkmcnt(2)
  v_mfma_f32_32x32x16_bf16 v[64:79], a[164:167], v[84:87], v[64:79]
  ds_read_b128 v[80:83], v7 offset:28672
  v_add_f32 v240, 1.0, v240
  v_add_f32 v241, 1.0, v241
  v_add_f32 v242, 1.0, v242
  v_add_f32 v243, 1.0, v243
  s_waitcnt lgkmcnt(2)
  v_mfma_f32_32x32x16_bf16 v[64:79], a[168:171], v[88:91], v[64:79]
  ds_read_b128 v[84:87], v7 offset:29696
  v_rcp_f32 v240, v240
  v_rcp_f32 v241, v241
  s_waitcnt lgkmcnt(2)
  v_mfma_f32_32x32x16_bf16 v[64:79], a[172:175], v[92:95], v[64:79]
  ds_read_b128 v[88:91], v7 offset:30720
  v_rcp_f32 v242, v242
  v_rcp_f32 v243, v243
  s_waitcnt lgkmcnt(2)
  v_mfma_f32_32x32x16_bf16 v[64:79], a[176:179], v[80:83], v[64:79]
  ds_read_b128 v[92:95], v7 offset:31744
  v_mul_f32 v52, v52, v240
  v_mul_f32 v53, v53, v241
  v_mul_f32 v54, v54, v242
  v_mul_f32 v55, v55, v243
  s_waitcnt lgkmcnt(2)
  v_mfma_f32_32x32x16_bf16 v[64:79], a[180:183], v[84:87], v[64:79]
  ds_read_b128 v[80:83], v8 offset:28672
  v_cvt_pk_bf16_f32 v146, v52, v53
  v_cvt_pk_bf16_f32 v147, v54, v55
  v_min_u32 v147, -2, v147
  buffer_store_dwordx4 v[144:147], v2, s[40:43], s50 offen offset:0 sc1
  s_waitcnt lgkmcnt(2)
  v_mfma_f32_32x32x16_bf16 v[64:79], a[184:187], v[88:91], v[64:79]
  ds_read_b128 v[84:87], v8 offset:29696
  v_mul_f32 v240, v56, v255
  v_mul_f32 v241, v57, v255
  v_mul_f32 v242, v58, v255
  v_mul_f32 v243, v59, v255
  s_waitcnt lgkmcnt(2)
  v_mfma_f32_32x32x16_bf16 v[64:79], a[188:191], v[92:95], v[64:79]
  ds_read_b128 v[88:91], v8 offset:30720
  v_exp_f32 v240, v240
  v_exp_f32 v241, v241
  s_waitcnt lgkmcnt(2)
  v_mfma_f32_32x32x16_bf16 v[64:79], a[192:195], v[80:83], v[64:79]
  ds_read_b128 v[92:95], v8 offset:31744
  v_exp_f32 v242, v242
  v_exp_f32 v243, v243
  s_waitcnt lgkmcnt(2)
  v_mfma_f32_32x32x16_bf16 v[64:79], a[196:199], v[84:87], v[64:79]
  ds_read_b128 v[80:83], v9 offset:28672
  v_add_f32 v240, 1.0, v240
  v_add_f32 v241, 1.0, v241
  v_add_f32 v242, 1.0, v242
  v_add_f32 v243, 1.0, v243
  s_waitcnt lgkmcnt(2)
  v_mfma_f32_32x32x16_bf16 v[64:79], a[200:203], v[88:91], v[64:79]
  ds_read_b128 v[84:87], v9 offset:29696
  v_rcp_f32 v240, v240
  v_rcp_f32 v241, v241
  s_waitcnt lgkmcnt(2)
  v_mfma_f32_32x32x16_bf16 v[64:79], a[204:207], v[92:95], v[64:79]
  ds_read_b128 v[88:91], v9 offset:30720
  v_rcp_f32 v242, v242
  v_rcp_f32 v243, v243
  s_waitcnt lgkmcnt(2)
  v_mfma_f32_32x32x16_bf16 v[64:79], a[208:211], v[80:83], v[64:79]
  ds_read_b128 v[92:95], v9 offset:31744
  v_mul_f32 v56, v56, v240
  v_mul_f32 v57, v57, v241
  v_mul_f32 v58, v58, v242
  v_mul_f32 v59, v59, v243
  s_waitcnt lgkmcnt(2)
  v_mfma_f32_32x32x16_bf16 v[64:79], a[212:215], v[84:87], v[64:79]
  v_cvt_pk_bf16_f32 v148, v56, v57
  v_cvt_pk_bf16_f32 v149, v58, v59
  v_min_u32 v149, -2, v149
  v_mul_f32 v240, v60, v255
  s_waitcnt lgkmcnt(1)
  v_mfma_f32_32x32x16_bf16 v[64:79], a[216:219], v[88:91], v[64:79]
  v_mul_f32 v241, v61, v255
  v_mul_f32 v242, v62, v255
  v_mul_f32 v243, v63, v255
  v_exp_f32 v240, v240
  s_waitcnt lgkmcnt(0)
  v_mfma_f32_32x32x16_bf16 v[64:79], a[220:223], v[92:95], v[64:79]
  v_exp_f32 v241, v241
  v_exp_f32 v242, v242
  v_exp_f32 v243, v243
  v_add_f32 v240, 1.0, v240
  v_add_f32 v241, 1.0, v241
  v_add_f32 v242, 1.0, v242
  v_add_f32 v243, 1.0, v243
  v_rcp_f32 v240, v240
  v_rcp_f32 v241, v241
  v_rcp_f32 v242, v242
  v_rcp_f32 v243, v243
  v_mul_f32 v60, v60, v240
  v_mul_f32 v61, v61, v241
  v_mul_f32 v62, v62, v242
  v_mul_f32 v63, v63, v243
  v_cvt_pk_bf16_f32 v150, v60, v61
  v_cvt_pk_bf16_f32 v151, v62, v63
  v_min_u32 v151, -2, v151
  buffer_store_dwordx4 v[148:151], v2, s[40:43], s50 offen offset:1024 sc1
  v_mfma_f32_32x32x16_bf16 v[64:79], v[124:127], v[132:135], v[64:79]
  buffer_load_dwordx4 v[96:99], v3, s[40:43], s65 offen offset:0 sc1
  buffer_load_dwordx4 v[100:103], v3, s[40:43], s65 offen offset:1024 sc1
  buffer_load_dwordx4 v[104:107], v3, s[40:43], s65 offen offset:2048 sc1
  buffer_load_dwordx4 v[108:111], v3, s[40:43], s65 offen offset:3072 sc1
  buffer_load_dwordx4 v[112:115], v4, s[40:43], s65 offen offset:0 sc1
  buffer_load_dwordx4 v[116:119], v4, s[40:43], s65 offen offset:1024 sc1
  buffer_load_dwordx4 v[136:139], v4, s[40:43], s65 offen offset:2048 sc1
  buffer_load_dwordx4 v[140:143], v4, s[40:43], s65 offen offset:3072 sc1
  s_nop 3
  v_pk_mul_f32 v[240:241], v[64:65], v[254:255] op_sel:[0,1] op_sel_hi:[1,1]
  v_pk_mul_f32 v[242:243], v[66:67], v[254:255] op_sel:[0,1] op_sel_hi:[1,1]
  v_exp_f32 v240, v240
  v_exp_f32 v241, v241
  v_exp_f32 v242, v242
  v_exp_f32 v243, v243
  v_add_f32 v240, 1.0, v240
  v_add_f32 v241, 1.0, v241
  v_add_f32 v242, 1.0, v242
  v_add_f32 v243, 1.0, v243
  v_rcp_f32 v240, v240
  v_rcp_f32 v241, v241
  v_rcp_f32 v242, v242
  v_rcp_f32 v243, v243
  v_pk_mul_f32 v[64:65], v[64:65], v[240:241]
  v_pk_mul_f32 v[66:67], v[66:67], v[242:243]
  v_cvt_pk_bf16_f32 v152, v64, v65
  v_cvt_pk_bf16_f32 v153, v66, v67
  v_min_u32 v153, -2, v153
  v_pk_mul_f32 v[240:241], v[68:69], v[254:255] op_sel:[0,1] op_sel_hi:[1,1]
  v_pk_mul_f32 v[242:243], v[70:71], v[254:255] op_sel:[0,1] op_sel_hi:[1,1]
  v_exp_f32 v240, v240
  v_exp_f32 v241, v241
  v_exp_f32 v242, v242
  v_exp_f32 v243, v243
  v_add_f32 v240, 1.0, v240
  v_add_f32 v241, 1.0, v241
  v_add_f32 v242, 1.0, v242
  v_add_f32 v243, 1.0, v243
  v_rcp_f32 v240, v240
  v_rcp_f32 v241, v241
  v_rcp_f32 v242, v242
  v_rcp_f32 v243, v243
  v_pk_mul_f32 v[68:69], v[68:69], v[240:241]
  v_pk_mul_f32 v[70:71], v[70:71], v[242:243]
  v_cvt_pk_bf16_f32 v154, v68, v69
  v_cvt_pk_bf16_f32 v155, v70, v71
  v_min_u32 v155, -2, v155
  buffer_store_dwordx4 v[152:155], v2, s[40:43], s51 offen offset:0 sc1
  v_pk_mul_f32 v[240:241], v[72:73], v[254:255] op_sel:[0,1] op_sel_hi:[1,1]
  v_pk_mul_f32 v[242:243], v[74:75], v[254:255] op_sel:[0,1] op_sel_hi:[1,1]
  v_exp_f32 v240, v240
  v_exp_f32 v241, v241
  v_exp_f32 v242, v242
  v_exp_f32 v243, v243
  v_add_f32 v240, 1.0, v240
  v_add_f32 v241, 1.0, v241
  v_add_f32 v242, 1.0, v242
  v_add_f32 v243, 1.0, v243
  v_rcp_f32 v240, v240
  v_rcp_f32 v241, v241
  v_rcp_f32 v242, v242
  v_rcp_f32 v243, v243
  v_pk_mul_f32 v[72:73], v[72:73], v[240:241]
  v_pk_mul_f32 v[74:75], v[74:75], v[242:243]
  v_cvt_pk_bf16_f32 v156, v72, v73
  v_cvt_pk_bf16_f32 v157, v74, v75
  v_min_u32 v157, -2, v157
  v_pk_mul_f32 v[240:241], v[76:77], v[254:255] op_sel:[0,1] op_sel_hi:[1,1]
  v_pk_mul_f32 v[242:243], v[78:79], v[254:255] op_sel:[0,1] op_sel_hi:[1,1]
  v_exp_f32 v240, v240
  v_exp_f32 v241, v241
  v_exp_f32 v242, v242
  v_exp_f32 v243, v243
  v_add_f32 v240, 1.0, v240
  v_add_f32 v241, 1.0, v241
  v_add_f32 v242, 1.0, v242
  v_add_f32 v243, 1.0, v243
  v_rcp_f32 v240, v240
  v_rcp_f32 v241, v241
  v_rcp_f32 v242, v242
  v_rcp_f32 v243, v243
  v_pk_mul_f32 v[76:77], v[76:77], v[240:241]
  v_pk_mul_f32 v[78:79], v[78:79], v[242:243]
  v_cvt_pk_bf16_f32 v158, v76, v77
  v_cvt_pk_bf16_f32 v159, v78, v79
  v_min_u32 v159, -2, v159
  buffer_store_dwordx4 v[156:159], v2, s[40:43], s51 offen offset:1024 sc1
  buffer_load_dwordx4 v[80:83], v5, s[40:43], s65 offen offset:0 sc1
  buffer_load_dwordx4 v[84:87], v5, s[40:43], s65 offen offset:1024 sc1
  buffer_load_dwordx4 v[88:91], v5, s[40:43], s65 offen offset:2048 sc1
  buffer_load_dwordx4 v[92:95], v5, s[40:43], s65 offen offset:3072 sc1
  buffer_load_dwordx4 v[120:123], v6, s[40:43], s65 offen offset:0 sc1
  buffer_load_dwordx4 v[124:127], v6, s[40:43], s65 offen offset:1024 sc1
  buffer_load_dwordx4 v[128:131], v6, s[40:43], s65 offen offset:2048 sc1
  v_add_u32 v11, 65536, v11
  v_add_u32 v13, 65536, v13
  s_and_b64 s[74:75], s[74:75], s[52:53]
  v_mov_b32 v162, 1073741824
  v_cndmask_b32 v251, v251, v162, s[74:75]
  s_waitcnt vmcnt(13)
  v_max3_u32 v160, v97, v99, v101
  v_max_u32 v160, v160, v103
  v_cmp_eq_u32 vcc, -1, v160
  s_nop 4
  s_cbranch_vccnz KF_R0
KF_R0_B:
  v_mfma_f32_32x32x16_bf16 v[16:31], a[224:227], v[96:99], 0
  v_mfma_f32_32x32x16_bf16 v[32:47], a[228:231], v[96:99], 0
  buffer_load_dwordx4 v[132:135], v6, s[40:43], s65 offen offset:3072 sc1
  v_mfma_f32_32x32x16_bf16 v[16:31], a[232:235], v[100:103], v[16:31]
  s_waitcnt vmcnt(12)
  v_max3_u32 v160, v105, v107, v109
  v_max_u32 v160, v160, v111
  v_cmp_eq_u32 vcc, -1, v160
  v_mfma_f32_32x32x16_bf16 v[32:47], a[236:239], v[100:103], v[32:47]
  buffer_load_dwordx4 v[96:99], v7, s[40:43], s65 offen offset:0 sc1
  s_nop 2
  s_cbranch_vccnz KF_R1
KF_R1_B:
  v_mfma_f32_32x32x16_bf16 v[16:31], a[240:243], v[104:107], v[16:31]
  v_mfma_f32_32x32x16_bf16 v[32:47], a[244:247], v[104:107], v[32:47]
  buffer_load_dwordx4 v[100:103], v7, s[40:43], s65 offen offset:1024 sc1
  v_mfma_f32_32x32x16_bf16 v[16:31], a[248:251], v[108:111], v[16:31]
  s_waitcnt vmcnt(12)
  v_max3_u32 v160, v113, v115, v117
  v_max_u32 v160, v160, v119
  v_cmp_eq_u32 vcc, -1, v160
  v_mfma_f32_32x32x16_bf16 v[32:47], a[252:255], v[108:111], v[32:47]
  buffer_load_dwordx4 v[104:107], v7, s[40:43], s65 offen offset:2048 sc1
  s_nop 2
  s_cbranch_vccnz KF_R2
KF_R2_B:
  v_mfma_f32_32x32x16_bf16 v[16:31], v[176:179], v[112:115], v[16:31]
  v_mfma_f32_32x32x16_bf16 v[32:47], v[180:183], v[112:115], v[32:47]
  buffer_load_dwordx4 v[108:111], v7, s[40:43], s65 offen offset:3072 sc1
  v_mfma_f32_32x32x16_bf16 v[16:31], v[184:187], v[116:119], v[16:31]
  s_waitcnt vmcnt(12)
  v_max3_u32 v160, v137, v139, v141
  v_max_u32 v160, v160, v143
  v_cmp_eq_u32 vcc, -1, v160
  v_mfma_f32_32x32x16_bf16 v[32:47], v[188:191], v[116:119], v[32:47]
  buffer_load_dwordx4 v[112:115], v8, s[40:43], s65 offen offset:0 sc1
  s_nop 2
  s_cbranch_vccnz KF_R3
KF_R3_B:
  v_mfma_f32_32x32x16_bf16 v[16:31], v[192:195], v[136:139], v[16:31]
  v_mfma_f32_32x32x16_bf16 v[32:47], v[196:199], v[136:139], v[32:47]
  buffer_load_dwordx4 v[116:119], v8, s[40:43], s65 offen offset:1024 sc1
  v_mfma_f32_32x32x16_bf16 v[16:31], v[200:203], v[140:143], v[16:31]
  s_waitcnt vmcnt(12)
  v_max3_u32 v160, v81, v83, v85
  v_max_u32 v160, v160, v87
  v_cmp_eq_u32 vcc, -1, v160
  v_mfma_f32_32x32x16_bf16 v[32:47], v[204:207], v[140:143], v[32:47]
  buffer_load_dwordx4 v[136:139], v8, s[40:43], s65 offen offset:2048 sc1
  s_nop 2
  s_cbranch_vccnz KF_R4
KF_R4_B:
  v_mfma_f32_32x32x16_bf16 v[16:31], v[208:211], v[80:83], v[16:31]
  v_mfma_f32_32x32x16_bf16 v[32:47], v[212:215], v[80:83], v[32:47]
  buffer_load_dwordx4 v[140:143], v8, s[40:43], s65 offen offset:3072 sc1
  v_mfma_f32_32x32x16_bf16 v[16:31], v[216:219], v[84:87], v[16:31]
  s_waitcnt vmcnt(12)
  v_max3_u32 v160, v89, v91, v93
  v_max_u32 v160, v160, v95
  v_cmp_eq_u32 vcc, -1, v160
  v_mfma_f32_32x32x16_bf16 v[32:47], v[220:223], v[84:87], v[32:47]
  buffer_load_dwordx4 v[80:83], v9, s[40:43], s65 offen offset:0 sc1
  s_nop 2
  s_cbranch_vccnz KF_R5
KF_R5_B:
  v_mfma_f32_32x32x16_bf16 v[16:31], v[224:227], v[88:91], v[16:31]
  v_mfma_f32_32x32x16_bf16 v[32:47], v[228:231], v[88:91], v[32:47]
  buffer_load_dwordx4 v[84:87], v9, s[40:43], s65 offen offset:1024 sc1
  v_mfma_f32_32x32x16_bf16 v[16:31], v[232:235], v[92:95], v[16:31]
  s_waitcnt vmcnt(12)
  v_max3_u32 v160, v121, v123, v125
  v_max_u32 v160, v160, v127
  v_cmp_eq_u32 vcc, -1, v160
  v_mfma_f32_32x32x16_bf16 v[32:47], v[236:239], v[92:95], v[32:47]
  buffer_load_dwordx4 v[88:91], v9, s[40:43], s65 offen offset:2048 sc1
  s_nop 2
  s_cbranch_vccnz KF_R6
KF_R6_B:
  v_mfma_f32_32x32x16_bf16 v[16:31], a[0:3], v[120:123], v[16:31]
  v_mfma_f32_32x32x16_bf16 v[32:47], a[4:7], v[120:123], v[32:47]
  buffer_load_dwordx4 v[92:95], v9, s[40:43], s65 offen offset:3072 sc1
  v_mfma_f32_32x32x16_bf16 v[16:31], a[8:11], v[124:127], v[16:31]
  s_waitcnt vmcnt(12)
  v_max3_u32 v160, v129, v131, v133
  v_max_u32 v160, v160, v135
  v_cmp_eq_u32 vcc, -1, v160
  v_mfma_f32_32x32x16_bf16 v[32:47], a[12:15], v[124:127], v[32:47]
  buffer_load_dwordx4 v[120:123], v3, s[40:43], s66 offen offset:0 sc1
  s_nop 2
  s_cbranch_vccnz KF_R7
KF_R7_B:
  v_mfma_f32_32x32x16_bf16 v[16:31], a[16:19], v[128:131], v[16:31]
  v_mfma_f32_32x32x16_bf16 v[32:47], a[20:23], v[128:131], v[32:47]
  buffer_load_dwordx4 v[124:127], v3, s[40:43], s66 offen offset:1024 sc1
  v_mfma_f32_32x32x16_bf16 v[16:31], a[24:27], v[132:135], v[16:31]
  s_waitcnt vmcnt(12)
  v_max3_u32 v160, v97, v99, v101
  v_max_u32 v160, v160, v103
  v_cmp_eq_u32 vcc, -1, v160
  v_mfma_f32_32x32x16_bf16 v[32:47], a[28:31], v[132:135], v[32:47]
  buffer_load_dwordx4 v[128:131], v3, s[40:43], s66 offen offset:2048 sc1
  s_nop 2
  s_cbranch_vccnz KF_R8
KF_R8_B:
  v_mfma_f32_32x32x16_bf16 v[16:31], a[32:35], v[96:99], v[16:31]
  v_mfma_f32_32x32x16_bf16 v[32:47], a[36:39], v[96:99], v[32:47]
  buffer_load_dwordx4 v[132:135], v3, s[40:43], s66 offen offset:3072 sc1
  v_mfma_f32_32x32x16_bf16 v[16:31], a[40:43], v[100:103], v[16:31]
  s_waitcnt vmcnt(12)
  v_max3_u32 v160, v105, v107, v109
  v_max_u32 v160, v160, v111
  v_cmp_eq_u32 vcc, -1, v160
  v_mfma_f32_32x32x16_bf16 v[32:47], a[44:47], v[100:103], v[32:47]
  buffer_load_dwordx4 v[96:99], v4, s[40:43], s66 offen offset:0 sc1
  s_nop 2
  s_cbranch_vccnz KF_R9
KF_R9_B:
  v_mfma_f32_32x32x16_bf16 v[16:31], a[48:51], v[104:107], v[16:31]
  v_mfma_f32_32x32x16_bf16 v[32:47], a[52:55], v[104:107], v[32:47]
  buffer_load_dwordx4 v[100:103], v4, s[40:43], s66 offen offset:1024 sc1
  v_mfma_f32_32x32x16_bf16 v[16:31], a[56:59], v[108:111], v[16:31]
  s_waitcnt vmcnt(12)
  v_max3_u32 v160, v113, v115, v117
  v_max_u32 v160, v160, v119
  v_cmp_eq_u32 vcc, -1, v160
  v_mfma_f32_32x32x16_bf16 v[32:47], a[60:63], v[108:111], v[32:47]
  buffer_load_dwordx4 v[104:107], v4, s[40:43], s66 offen offset:2048 sc1
  s_nop 2
  s_cbranch_vccnz KF_R10
KF_R10_B:
  v_mfma_f32_32x32x16_bf16 v[16:31], a[64:67], v[112:115], v[16:31]
  v_mfma_f32_32x32x16_bf16 v[32:47], a[68:71], v[112:115], v[32:47]
  buffer_load_dwordx4 v[108:111], v4, s[40:43], s66 offen offset:3072 sc1
  v_mfma_f32_32x32x16_bf16 v[16:31], a[72:75], v[116:119], v[16:31]
  s_waitcnt vmcnt(12)
  v_max3_u32 v160, v137, v139, v141
  v_max_u32 v160, v160, v143
  v_cmp_eq_u32 vcc, -1, v160
  v_mfma_f32_32x32x16_bf16 v[32:47], a[76:79], v[116:119], v[32:47]
  buffer_load_dwordx4 v[112:115], v5, s[40:43], s66 offen offset:0 sc1
  s_nop 2
  s_cbranch_vccnz KF_R11
KF_R11_B:
  v_mfma_f32_32x32x16_bf16 v[16:31], a[80:83], v[136:139], v[16:31]
  v_mfma_f32_32x32x16_bf16 v[32:47], a[84:87], v[136:139], v[32:47]
  buffer_load_dwordx4 v[116:119], v5, s[40:43], s66 offen offset:1024 sc1
  v_mfma_f32_32x32x16_bf16 v[16:31], a[88:91], v[140:143], v[16:31]
  s_waitcnt vmcnt(12)
  v_max3_u32 v160, v81, v83, v85
  v_max_u32 v160, v160, v87
  v_cmp_eq_u32 vcc, -1, v160
  v_mfma_f32_32x32x16_bf16 v[32:47], a[92:95], v[140:143], v[32:47]
  buffer_load_dwordx4 v[136:139], v5, s[40:43], s66 offen offset:2048 sc1
  s_nop 2
  s_cbranch_vccnz KF_R12
KF_R12_B:
  v_mfma_f32_32x32x16_bf16 v[16:31], a[96:99], v[80:83], v[16:31]
  v_mfma_f32_32x32x16_bf16 v[32:47], a[100:103], v[80:83], v[32:47]
  buffer_load_dwordx4 v[140:143], v5, s[40:43], s66 offen offset:3072 sc1
  v_mfma_f32_32x32x16_bf16 v[16:31], a[104:107], v[84:87], v[16:31]
  s_waitcnt vmcnt(12)
  v_max3_u32 v160, v89, v91, v93
  v_max_u32 v160, v160, v95
  v_cmp_eq_u32 vcc, -1, v160
  v_mfma_f32_32x32x16_bf16 v[32:47], a[108:111], v[84:87], v[32:47]
  buffer_load_dwordx4 v[80:83], v6, s[40:43], s66 offen offset:0 sc1
  s_nop 2
  s_cbranch_vccnz KF_R13
KF_R13_B:
  v_mfma_f32_32x32x16_bf16 v[16:31], a[112:115], v[88:91], v[16:31]
  v_mfma_f32_32x32x16_bf16 v[32:47], a[116:119], v[88:91], v[32:47]
  buffer_load_dwordx4 v[84:87], v6, s[40:43], s66 offen offset:1024 sc1
  v_mfma_f32_32x32x16_bf16 v[16:31], a[120:123], v[92:95], v[16:31]
  s_waitcnt vmcnt(12)
  v_max3_u32 v160, v121, v123, v125
  v_max_u32 v160, v160, v127
  v_cmp_eq_u32 vcc, -1, v160
  v_mfma_f32_32x32x16_bf16 v[32:47], a[124:127], v[92:95], v[32:47]
  buffer_load_dwordx4 v[88:91], v6, s[40:43], s66 offen offset:2048 sc1
  s_nop 2
  s_cbranch_vccnz KF_R14
KF_R14_B:
  v_mfma_f32_32x32x16_bf16 v[48:63], a[224:227], v[120:123], 0
  v_mfma_f32_32x32x16_bf16 v[64:79], a[228:231], v[120:123], 0
  buffer_load_dwordx4 v[92:95], v6, s[40:43], s66 offen offset:3072 sc1
  v_mfma_f32_32x32x16_bf16 v[48:63], a[232:235], v[124:127], v[48:63]
  s_waitcnt vmcnt(12)
  v_max3_u32 v160, v129, v131, v133
  v_max_u32 v160, v160, v135
  v_cmp_eq_u32 vcc, -1, v160
  v_mfma_f32_32x32x16_bf16 v[64:79], a[236:239], v[124:127], v[64:79]
  buffer_load_dwordx4 v[120:123], v7, s[40:43], s66 offen offset:0 sc1
  s_nop 2
  s_cbranch_vccnz KF_R15
KF_R15_B:
  v_mfma_f32_32x32x16_bf16 v[48:63], a[240:243], v[128:131], v[48:63]
  v_mfma_f32_32x32x16_bf16 v[64:79], a[244:247], v[128:131], v[64:79]
  buffer_load_dwordx4 v[124:127], v7, s[40:43], s66 offen offset:1024 sc1
  v_mfma_f32_32x32x16_bf16 v[48:63], a[248:251], v[132:135], v[48:63]
  s_waitcnt vmcnt(12)
  v_max3_u32 v160, v97, v99, v101
  v_max_u32 v160, v160, v103
  v_cmp_eq_u32 vcc, -1, v160
  v_mfma_f32_32x32x16_bf16 v[64:79], a[252:255], v[132:135], v[64:79]
  buffer_load_dwordx4 v[128:131], v7, s[40:43], s66 offen offset:2048 sc1
  ds_write_b128 v11, v[16:19] offset:0
  s_nop 1
  s_cbranch_vccnz KF_R16
KF_R16_B:
  v_mfma_f32_32x32x16_bf16 v[48:63], v[176:179], v[96:99], v[48:63]
  ds_write_b128 v11, v[20:23] offset:4096
  ds_write_b128 v11, v[24:27] offset:8192
  ds_write_b128 v11, v[28:31] offset:12288
  ds_write_b128 v11, v[32:35] offset:16384
  v_mfma_f32_32x32x16_bf16 v[64:79], v[180:183], v[96:99], v[64:79]
  buffer_load_dwordx4 v[132:135], v7, s[40:43], s66 offen offset:3072 sc1
  ds_write_b128 v11, v[36:39] offset:20480
  v_mfma_f32_32x32x16_bf16 v[48:63], v[184:187], v[100:103], v[48:63]
  s_waitcnt vmcnt(12)
  v_max3_u32 v160, v105, v107, v109
  v_max_u32 v160, v160, v111
  v_cmp_eq_u32 vcc, -1, v160
  v_mfma_f32_32x32x16_bf16 v[64:79], v[188:191], v[100:103], v[64:79]
  buffer_load_dwordx4 v[96:99], v8, s[40:43], s66 offen offset:0 sc1
  ds_write_b128 v11, v[40:43] offset:24576
  s_nop 1
  s_cbranch_vccnz KF_R17
KF_R17_B:
  v_mfma_f32_32x32x16_bf16 v[48:63], v[192:195], v[104:107], v[48:63]
  ds_write_b128 v11, v[44:47] offset:28672
  s_waitcnt lgkmcnt(0)
  s_barrier
  v_mfma_f32_32x32x16_bf16 v[64:79], v[196:199], v[104:107], v[64:79]
  buffer_load_dwordx4 v[100:103], v8, s[40:43], s66 offen offset:1024 sc1
  v_mfma_f32_32x32x16_bf16 v[48:63], v[200:203], v[108:111], v[48:63]
  s_waitcnt vmcnt(12)
  v_max3_u32 v160, v113, v115, v117
  v_max_u32 v160, v160, v119
  v_cmp_eq_u32 vcc, -1, v160
  v_mfma_f32_32x32x16_bf16 v[64:79], v[204:207], v[108:111], v[64:79]
  buffer_load_dwordx4 v[104:107], v8, s[40:43], s66 offen offset:2048 sc1
  s_nop 2
  s_cbranch_vccnz KF_R18
KF_R18_B:
  v_mfma_f32_32x32x16_bf16 v[48:63], v[208:211], v[112:115], v[48:63]
  v_mfma_f32_32x32x16_bf16 v[64:79], v[212:215], v[112:115], v[64:79]
  buffer_load_dwordx4 v[108:111], v8, s[40:43], s66 offen offset:3072 sc1
  v_mfma_f32_32x32x16_bf16 v[48:63], v[216:219], v[116:119], v[48:63]
  s_waitcnt vmcnt(12)
  v_max3_u32 v160, v137, v139, v141
  v_max_u32 v160, v160, v143
  v_cmp_eq_u32 vcc, -1, v160
  v_mfma_f32_32x32x16_bf16 v[64:79], v[220:223], v[116:119], v[64:79]
  buffer_load_dwordx4 v[112:115], v9, s[40:43], s66 offen offset:0 sc1
  ds_read_b128 v[16:19], v13 offset:0
  s_nop 1
  s_cbranch_vccnz KF_R19
KF_R19_B:
  v_mfma_f32_32x32x16_bf16 v[48:63], v[224:227], v[136:139], v[48:63]
  ds_read_b128 v[20:23], v13 offset:4096
  ds_read_b128 v[24:27], v13 offset:1024
  ds_read_b128 v[28:31], v13 offset:5120
  ds_read_b128 v[32:35], v13 offset:2048
  v_mfma_f32_32x32x16_bf16 v[64:79], v[228:231], v[136:139], v[64:79]
  buffer_load_dwordx4 v[116:119], v9, s[40:43], s66 offen offset:1024 sc1
  ds_read_b128 v[36:39], v13 offset:6144
  v_mfma_f32_32x32x16_bf16 v[48:63], v[232:235], v[140:143], v[48:63]
  s_waitcnt vmcnt(12)
  v_max3_u32 v160, v81, v83, v85
  v_max_u32 v160, v160, v87
  v_cmp_eq_u32 vcc, -1, v160
  v_mfma_f32_32x32x16_bf16 v[64:79], v[236:239], v[140:143], v[64:79]
  buffer_load_dwordx4 v[136:139], v9, s[40:43], s66 offen offset:2048 sc1
  ds_read_b128 v[40:43], v13 offset:3072
  s_nop 1
  s_cbranch_vccnz KF_R20
KF_R20_B:
  v_mfma_f32_32x32x16_bf16 v[48:63], a[0:3], v[80:83], v[48:63]
  ds_read_b128 v[44:47], v13 offset:7168
  v_lshlrev_b32 v240, 16, v164
  v_and_b32 v241, 0xffff0000, v164
  v_lshlrev_b32 v242, 16, v165
  v_mfma_f32_32x32x16_bf16 v[64:79], a[4:7], v[80:83], v[64:79]
  buffer_load_dwordx4 v[140:143], v9, s[40:43], s66 offen offset:3072 sc1
  v_and_b32 v243, 0xffff0000, v165
  v_mfma_f32_32x32x16_bf16 v[48:63], a[8:11], v[84:87], v[48:63]
  s_waitcnt vmcnt(12)
  v_max3_u32 v160, v89, v91, v93
  v_max_u32 v160, v160, v95
  v_cmp_eq_u32 vcc, -1, v160
  v_mfma_f32_32x32x16_bf16 v[64:79], a[12:15], v[84:87], v[64:79]
  v_lshlrev_b32 v244, 16, v166
  v_and_b32 v245, 0xffff0000, v166
  v_lshlrev_b32 v246, 16, v167
  v_and_b32 v247, 0xffff0000, v167
  s_cbranch_vccnz KF_R21
KF_R21_B:
  v_mfma_f32_32x32x16_bf16 v[48:63], a[16:19], v[88:91], v[48:63]
  s_waitcnt lgkmcnt(0)
  v_add_f32 v16, v16, v24
  v_add_f32 v17, v17, v25
  v_add_f32 v18, v18, v26
  v_mfma_f32_32x32x16_bf16 v[64:79], a[20:23], v[88:91], v[64:79]
  v_add_f32 v19, v19, v27
  v_add_f32 v20, v20, v28
  v_add_f32 v21, v21, v29
  v_add_f32 v22, v22, v30
  v_mfma_f32_32x32x16_bf16 v[48:63], a[24:27], v[92:95], v[48:63]
  s_waitcnt vmcnt(10)
  v_max3_u32 v160, v121, v123, v125
  v_max_u32 v160, v160, v127
  v_cmp_eq_u32 vcc, -1, v160
  v_mfma_f32_32x32x16_bf16 v[64:79], a[28:31], v[92:95], v[64:79]
  v_add_f32 v23, v23, v31
  v_add_f32 v32, v32, v40
  v_add_f32 v33, v33, v41
  v_add_f32 v34, v34, v42
  s_cbranch_vccnz KF_R22
KF_R22_B:
  v_mfma_f32_32x32x16_bf16 v[48:63], a[32:35], v[120:123], v[48:63]
  v_add_f32 v35, v35, v43
  v_add_f32 v36, v36, v44
  v_add_f32 v37, v37, v45
  v_add_f32 v38, v38, v46
  v_mfma_f32_32x32x16_bf16 v[64:79], a[36:39], v[120:123], v[64:79]
  v_add_f32 v39, v39, v47
  v_add_f32 v16, v16, v32
  v_add_f32 v17, v17, v33
  v_add_f32 v18, v18, v34
  v_mfma_f32_32x32x16_bf16 v[48:63], a[40:43], v[124:127], v[48:63]
  s_waitcnt vmcnt(8)
  v_max3_u32 v160, v129, v131, v133
  v_max_u32 v160, v160, v135
  v_cmp_eq_u32 vcc, -1, v160
  v_mfma_f32_32x32x16_bf16 v[64:79], a[44:47], v[124:127], v[64:79]
  v_add_f32 v19, v19, v35
  v_add_f32 v20, v20, v36
  v_add_f32 v21, v21, v37
  v_add_f32 v22, v22, v38
  s_cbranch_vccnz KF_R23
KF_R23_B:
  v_mfma_f32_32x32x16_bf16 v[48:63], a[48:51], v[128:131], v[48:63]
  v_add_f32 v23, v23, v39
  v_fmac_f32 v240, v16, v252
  v_fmac_f32 v241, v17, v252
  v_fmac_f32 v242, v18, v252
  v_mfma_f32_32x32x16_bf16 v[64:79], a[52:55], v[128:131], v[64:79]
  v_fmac_f32 v243, v19, v252
  v_fmac_f32 v244, v20, v252
  v_fmac_f32 v245, v21, v252
  v_fmac_f32 v246, v22, v252
  v_mfma_f32_32x32x16_bf16 v[48:63], a[56:59], v[132:135], v[48:63]
  s_waitcnt vmcnt(6)
  v_max3_u32 v160, v97, v99, v101
  v_max_u32 v160, v160, v103
  v_cmp_eq_u32 vcc, -1, v160
  v_mfma_f32_32x32x16_bf16 v[64:79], a[60:63], v[132:135], v[64:79]
  v_fmac_f32 v247, v23, v252
  v_cvt_pk_bf16_f32 v164, v240, v241
  v_cvt_pk_bf16_f32 v165, v242, v243
  v_cvt_pk_bf16_f32 v166, v244, v245
  s_cbranch_vccnz KF_R24
KF_R24_B:
  v_mfma_f32_32x32x16_bf16 v[48:63], a[64:67], v[96:99], v[48:63]
  v_cvt_pk_bf16_f32 v167, v246, v247
  v_permlane32_swap_b32 v164, v166
  s_nop 0
  v_permlane32_swap_b32 v165, v167
  buffer_store_dwordx4 v[164:167], v251, s[36:39], s60 offen
  v_mfma_f32_32x32x16_bf16 v[64:79], a[68:71], v[96:99], v[64:79]
  v_mfma_f32_32x32x16_bf16 v[48:63], a[72:75], v[100:103], v[48:63]
  s_waitcnt vmcnt(4)
  v_max3_u32 v160, v105, v107, v109
  v_max_u32 v160, v160, v111
  v_cmp_eq_u32 vcc, -1, v160
  v_mfma_f32_32x32x16_bf16 v[64:79], a[76:79], v[100:103], v[64:79]
  s_nop 3
  s_cbranch_vccnz KF_R25
KF_R25_B:
  v_mfma_f32_32x32x16_bf16 v[48:63], a[80:83], v[104:107], v[48:63]
  v_mfma_f32_32x32x16_bf16 v[64:79], a[84:87], v[104:107], v[64:79]
  v_mfma_f32_32x32x16_bf16 v[48:63], a[88:91], v[108:111], v[48:63]
  s_waitcnt vmcnt(2)
  v_max3_u32 v160, v113, v115, v117
  v_max_u32 v160, v160, v119
  v_cmp_eq_u32 vcc, -1, v160
  v_mfma_f32_32x32x16_bf16 v[64:79], a[92:95], v[108:111], v[64:79]
  s_nop 3
  s_cbranch_vccnz KF_R26
KF_R26_B:
  v_mfma_f32_32x32x16_bf16 v[48:63], a[96:99], v[112:115], v[48:63]
  v_mfma_f32_32x32x16_bf16 v[64:79], a[100:103], v[112:115], v[64:79]
  v_mfma_f32_32x32x16_bf16 v[48:63], a[104:107], v[116:119], v[48:63]
  s_waitcnt vmcnt(0)
  v_max3_u32 v160, v137, v139, v141
  v_max_u32 v160, v160, v143
  v_cmp_eq_u32 vcc, -1, v160
  v_mfma_f32_32x32x16_bf16 v[64:79], a[108:111], v[116:119], v[64:79]
  s_nop 3
  s_cbranch_vccnz KF_R27
KF_R27_B:
  v_mfma_f32_32x32x16_bf16 v[48:63], a[112:115], v[136:139], v[48:63]
  v_mfma_f32_32x32x16_bf16 v[64:79], a[116:119], v[136:139], v[64:79]
  v_mfma_f32_32x32x16_bf16 v[48:63], a[120:123], v[140:143], v[48:63]
  v_mfma_f32_32x32x16_bf16 v[64:79], a[124:127], v[140:143], v[64:79]
  s_nop 10
  ds_write_b128 v11, v[48:51] offset:32768
  ds_write_b128 v11, v[52:55] offset:36864
  ds_write_b128 v11, v[56:59] offset:40960
  ds_write_b128 v11, v[60:63] offset:45056
  ds_write_b128 v11, v[64:67] offset:49152
  ds_write_b128 v11, v[68:71] offset:53248
  ds_write_b128 v11, v[72:75] offset:57344
  ds_write_b128 v11, v[76:79] offset:61440
  s_waitcnt lgkmcnt(0)
  s_barrier
  ds_read_b128 v[80:83], v13 offset:32768
  ds_read_b128 v[84:87], v13 offset:36864
  ds_read_b128 v[88:91], v13 offset:33792
  ds_read_b128 v[92:95], v13 offset:37888
  ds_read_b128 v[96:99], v13 offset:34816
  ds_read_b128 v[100:103], v13 offset:38912
  ds_read_b128 v[104:107], v13 offset:35840
  ds_read_b128 v[108:111], v13 offset:39936
  v_lshlrev_b32 v240, 16, v168
  v_and_b32 v241, 0xffff0000, v168
  v_lshlrev_b32 v242, 16, v169
  v_and_b32 v243, 0xffff0000, v169
  v_lshlrev_b32 v244, 16, v170
  v_and_b32 v245, 0xffff0000, v170
  v_lshlrev_b32 v246, 16, v171
  v_and_b32 v247, 0xffff0000, v171
  s_waitcnt lgkmcnt(0)
  v_pk_add_f32 v[80:81], v[80:81], v[88:89]
  v_pk_add_f32 v[82:83], v[82:83], v[90:91]
  v_pk_add_f32 v[84:85], v[84:85], v[92:93]
  v_pk_add_f32 v[86:87], v[86:87], v[94:95]
  v_pk_add_f32 v[96:97], v[96:97], v[104:105]
  v_pk_add_f32 v[98:99], v[98:99], v[106:107]
  v_pk_add_f32 v[100:101], v[100:101], v[108:109]
  v_pk_add_f32 v[102:103], v[102:103], v[110:111]
  v_pk_add_f32 v[80:81], v[80:81], v[96:97]
  v_pk_add_f32 v[82:83], v[82:83], v[98:99]
  v_pk_add_f32 v[84:85], v[84:85], v[100:101]
  v_pk_add_f32 v[86:87], v[86:87], v[102:103]
  v_pk_fma_f32 v[240:241], v[80:81], v[252:253], v[240:241] op_sel:[0,1,0] op_sel_hi:[1,1,1]
  v_pk_fma_f32 v[242:243], v[82:83], v[252:253], v[242:243] op_sel:[0,1,0] op_sel_hi:[1,1,1]
  v_pk_fma_f32 v[244:245], v[84:85], v[252:253], v[244:245] op_sel:[0,1,0] op_sel_hi:[1,1,1]
  v_pk_fma_f32 v[246:247], v[86:87], v[252:253], v[246:247] op_sel:[0,1,0] op_sel_hi:[1,1,1]
  v_cvt_pk_bf16_f32 v168, v240, v241
  v_cvt_pk_bf16_f32 v169, v242, v243
  v_cvt_pk_bf16_f32 v170, v244, v245
  v_cvt_pk_bf16_f32 v171, v246, v247
  s_nop 0
  v_permlane32_swap_b32 v168, v170
  v_permlane32_swap_b32 v169, v171
  buffer_store_dwordx4 v[168:171], v251, s[36:39], s61 offen
KF_END:
  s_endpgm
KF_FL:
  s_add_u32 s72, s72, 1
  s_cmp_gt_u32 s72, 200000
  s_cbranch_scc1 KF_FL_B
  s_sleep 4
  buffer_load_dwordx4 v[184:187], v179, s[40:43], 0 offen sc1
  buffer_load_dword v188, v181, s[40:43], 0 offen sc1
  s_waitcnt vmcnt(0)
  v_min3_u32 v189, v184, v185, v186
  v_max3_u32 v190, v184, v185, v186
  v_min3_u32 v189, v189, v187, v188
  v_max3_u32 v190, v190, v187, v188
  v_xor_b32 v189, s73, v189
  v_xor_b32 v190, s73, v190
  v_or_b32 v189, v189, v190
  v_cmp_ne_u32 vcc, 0, v189
  s_nop 4
  s_cbranch_vccnz KF_FL
  s_branch KF_FL_B
KF_WR0:
  s_add_u32 s72, s72, 1
  s_cmp_gt_u32 s72, 200000
  s_cbranch_scc1 KF_WR0_B
  buffer_load_dwordx4 v[48:51], v2, s[40:43], s54 offen offset:0 sc1
  buffer_load_dwordx4 v[52:55], v2, s[40:43], s54 offen offset:1024 sc1
  buffer_load_dwordx4 v[56:59], v2, s[40:43], s54 offen offset:2048 sc1
  buffer_load_dwordx4 v[60:63], v2, s[40:43], s54 offen offset:3072 sc1
  buffer_load_dwordx4 v[64:67], v10, s[40:43], s54 offen offset:0 sc1
  buffer_load_dwordx4 v[68:71], v10, s[40:43], s54 offen offset:1024 sc1
  buffer_load_dwordx4 v[72:75], v10, s[40:43], s54 offen offset:2048 sc1
  buffer_load_dwordx4 v[76:79], v10, s[40:43], s54 offen offset:3072 sc1
  s_waitcnt vmcnt(0)
  v_max3_u32 v163, v49, v51, v53
  v_max3_u32 v163, v163, v55, v57
  v_max3_u32 v163, v163, v59, v61
  v_max3_u32 v163, v163, v63, v65
  v_max3_u32 v163, v163, v67, v69
  v_max3_u32 v163, v163, v71, v73
  v_max3_u32 v163, v163, v75, v77
  v_max_u32 v163, v163, v79
  v_cmp_eq_u32 vcc, -1, v163
  s_nop 4
  s_cbranch_vccnz KF_WR0
  s_branch KF_WR0_B
KF_HR00:
  s_add_u32 s72, s72, 1
  s_cmp_gt_u32 s72, 200000
  s_cbranch_scc1 KF_HR00_B
  buffer_load_dwordx4 v[48:51], v2, s[40:43], s56 offen offset:0 sc1
  buffer_load_dwordx4 v[52:55], v2, s[40:43], s56 offen offset:1024 sc1
  buffer_load_dwordx4 v[56:59], v2, s[40:43], s56 offen offset:2048 sc1
  buffer_load_dwordx4 v[60:63], v2, s[40:43], s56 offen offset:3072 sc1
  buffer_load_dwordx4 v[64:67], v10, s[40:43], s56 offen offset:0 sc1
  buffer_load_dwordx4 v[68:71], v10, s[40:43], s56 offen offset:1024 sc1
  buffer_load_dwordx4 v[72:75], v10, s[40:43], s56 offen offset:2048 sc1
  buffer_load_dwordx2 v[136:137], v14, s[40:43], s58 offen offset:0 sc1
  buffer_load_dwordx2 v[138:139], v14, s[40:43], s58 offen offset:512 sc1
  buffer_load_dwordx2 v[140:141], v14, s[40:43], s58 offen offset:1024 sc1
  buffer_load_dwordx2 v[142:143], v14, s[40:43], s58 offen offset:1536 sc1
  buffer_load_dwordx4 v[112:115], v15, s[40:43], s63 offen sc1
  buffer_load_dwordx4 v[116:119], v15, s[40:43], s64 offen sc1
  buffer_load_dwordx4 a[224:227], v3, s[40:43], s67 offen offset:0 sc1
  buffer_load_dwordx4 a[228:231], v3, s[40:43], s68 offen offset:0 sc1
  buffer_load_dwordx4 a[232:235], v3, s[40:43], s67 offen offset:1024 sc1
  buffer_load_dwordx4 a[236:239], v3, s[40:43], s68 offen offset:1024 sc1
  s_waitcnt vmcnt(15)
  v_max3_u32 v160, v49, v51, v53
  v_max_u32 v160, v160, v55
  v_cmp_eq_u32 vcc, -1, v160
  s_nop 4
  s_cbranch_vccnz KF_HR00
  s_branch KF_HR00_B
KF_HR01:
  s_add_u32 s72, s72, 1
  s_cmp_gt_u32 s72, 200000
  s_cbranch_scc1 KF_HR01_B
  buffer_load_dwordx4 v[56:59], v2, s[40:43], s56 offen offset:2048 sc1
  buffer_load_dwordx4 v[60:63], v2, s[40:43], s56 offen offset:3072 sc1
  buffer_load_dwordx4 v[64:67], v10, s[40:43], s56 offen offset:0 sc1
  buffer_load_dwordx4 v[68:71], v10, s[40:43], s56 offen offset:1024 sc1
  buffer_load_dwordx4 v[72:75], v10, s[40:43], s56 offen offset:2048 sc1
  buffer_load_dwordx2 v[136:137], v14, s[40:43], s58 offen offset:0 sc1
  buffer_load_dwordx2 v[138:139], v14, s[40:43], s58 offen offset:512 sc1
  buffer_load_dwordx2 v[140:141], v14, s[40:43], s58 offen offset:1024 sc1
  buffer_load_dwordx2 v[142:143], v14, s[40:43], s58 offen offset:1536 sc1
  buffer_load_dwordx4 v[112:115], v15, s[40:43], s63 offen sc1
  buffer_load_dwordx4 v[116:119], v15, s[40:43], s64 offen sc1
  buffer_load_dwordx4 a[224:227], v3, s[40:43], s67 offen offset:0 sc1
  buffer_load_dwordx4 a[228:231], v3, s[40:43], s68 offen offset:0 sc1
  buffer_load_dwordx4 a[232:235], v3, s[40:43], s67 offen offset:1024 sc1
  buffer_load_dwordx4 a[236:239], v3, s[40:43], s68 offen offset:1024 sc1
  s_waitcnt vmcnt(13)
  v_max3_u32 v160, v57, v59, v61
  v_max_u32 v160, v160, v63
  v_cmp_eq_u32 vcc, -1, v160
  s_nop 4
  s_cbranch_vccnz KF_HR01
  s_branch KF_HR01_B
KF_HR02:
  s_add_u32 s72, s72, 1
  s_cmp_gt_u32 s72, 200000
  s_cbranch_scc1 KF_HR02_B
  buffer_load_dwordx4 v[64:67], v10, s[40:43], s56 offen offset:0 sc1
  buffer_load_dwordx4 v[68:71], v10, s[40:43], s56 offen offset:1024 sc1
  buffer_load_dwordx4 v[72:75], v10, s[40:43], s56 offen offset:2048 sc1
  buffer_load_dwordx2 v[136:137], v14, s[40:43], s58 offen offset:0 sc1
  buffer_load_dwordx2 v[138:139], v14, s[40:43], s58 offen offset:512 sc1
  buffer_load_dwordx2 v[140:141], v14, s[40:43], s58 offen offset:1024 sc1
  buffer_load_dwordx2 v[142:143], v14, s[40:43], s58 offen offset:1536 sc1
  buffer_load_dwordx4 v[112:115], v15, s[40:43], s63 offen sc1
  buffer_load_dwordx4 v[116:119], v15, s[40:43], s64 offen sc1
  buffer_load_dwordx4 a[224:227], v3, s[40:43], s67 offen offset:0 sc1
  buffer_load_dwordx4 a[228:231], v3, s[40:43], s68 offen offset:0 sc1
  buffer_load_dwordx4 a[232:235], v3, s[40:43], s67 offen offset:1024 sc1
  buffer_load_dwordx4 a[236:239], v3, s[40:43], s68 offen offset:1024 sc1
  s_waitcnt vmcnt(11)
  v_max3_u32 v160, v65, v67, v69
  v_max_u32 v160, v160, v71
  v_cmp_eq_u32 vcc, -1, v160
  s_nop 4
  s_cbranch_vccnz KF_HR02
  s_branch KF_HR02_B
KF_HR03:
  s_add_u32 s72, s72, 1
  s_cmp_gt_u32 s72, 200000
  s_cbranch_scc1 KF_HR03_B
  buffer_load_dwordx4 v[72:75], v10, s[40:43], s56 offen offset:2048 sc1
  buffer_load_dwordx2 v[136:137], v14, s[40:43], s58 offen offset:0 sc1
  buffer_load_dwordx2 v[138:139], v14, s[40:43], s58 offen offset:512 sc1
  buffer_load_dwordx2 v[140:141], v14, s[40:43], s58 offen offset:1024 sc1
  buffer_load_dwordx2 v[142:143], v14, s[40:43], s58 offen offset:1536 sc1
  buffer_load_dwordx4 v[112:115], v15, s[40:43], s63 offen sc1
  buffer_load_dwordx4 v[116:119], v15, s[40:43], s64 offen sc1
  buffer_load_dwordx4 a[224:227], v3, s[40:43], s67 offen offset:0 sc1
  buffer_load_dwordx4 a[228:231], v3, s[40:43], s68 offen offset:0 sc1
  buffer_load_dwordx4 a[232:235], v3, s[40:43], s67 offen offset:1024 sc1
  buffer_load_dwordx4 a[236:239], v3, s[40:43], s68 offen offset:1024 sc1
  s_waitcnt vmcnt(6)
  v_max3_u32 v160, v73, v75, v137
  v_max3_u32 v160, v160, v139, v141
  v_max_u32 v160, v160, v143
  v_cmp_eq_u32 vcc, -1, v160
  s_nop 4
  s_cbranch_vccnz KF_HR03
  s_branch KF_HR03_B
KF_WR10:
  s_add_u32 s72, s72, 1
  s_cmp_gt_u32 s72, 200000
  s_cbranch_scc1 KF_WR10_B
  buffer_load_dwordx4 v[48:51], v2, s[40:43], s55 offen offset:0 sc1
  buffer_load_dwordx4 v[52:55], v2, s[40:43], s55 offen offset:1024 sc1
  buffer_load_dwordx4 v[56:59], v2, s[40:43], s55 offen offset:2048 sc1
  buffer_load_dwordx4 v[60:63], v2, s[40:43], s55 offen offset:3072 sc1
  buffer_load_dwordx4 v[64:67], v10, s[40:43], s55 offen offset:0 sc1
  buffer_load_dwordx4 v[68:71], v10, s[40:43], s55 offen offset:1024 sc1
  buffer_load_dwordx4 v[72:75], v10, s[40:43], s55 offen offset:2048 sc1
  buffer_load_dwordx4 v[76:79], v10, s[40:43], s55 offen offset:3072 sc1
  s_waitcnt vmcnt(6)
  v_max3_u32 v160, v49, v51, v53
  v_max_u32 v160, v160, v55
  v_cmp_eq_u32 vcc, -1, v160
  s_nop 4
  s_cbranch_vccnz KF_WR10
  s_branch KF_WR10_B
KF_WR11:
  s_add_u32 s72, s72, 1
  s_cmp_gt_u32 s72, 200000
  s_cbranch_scc1 KF_WR11_B
  buffer_load_dwordx4 v[56:59], v2, s[40:43], s55 offen offset:2048 sc1
  buffer_load_dwordx4 v[60:63], v2, s[40:43], s55 offen offset:3072 sc1
  buffer_load_dwordx4 v[64:67], v10, s[40:43], s55 offen offset:0 sc1
  buffer_load_dwordx4 v[68:71], v10, s[40:43], s55 offen offset:1024 sc1
  buffer_load_dwordx4 v[72:75], v10, s[40:43], s55 offen offset:2048 sc1
  buffer_load_dwordx4 v[76:79], v10, s[40:43], s55 offen offset:3072 sc1
  s_waitcnt vmcnt(4)
  v_max3_u32 v160, v57, v59, v61
  v_max_u32 v160, v160, v63
  v_cmp_eq_u32 vcc, -1, v160
  s_nop 4
  s_cbranch_vccnz KF_WR11
  s_branch KF_WR11_B
KF_WR12:
  s_add_u32 s72, s72, 1
  s_cmp_gt_u32 s72, 200000
  s_cbranch_scc1 KF_WR12_B
  buffer_load_dwordx4 v[64:67], v10, s[40:43], s55 offen offset:0 sc1
  buffer_load_dwordx4 v[68:71], v10, s[40:43], s55 offen offset:1024 sc1
  buffer_load_dwordx4 v[72:75], v10, s[40:43], s55 offen offset:2048 sc1
  buffer_load_dwordx4 v[76:79], v10, s[40:43], s55 offen offset:3072 sc1
  s_waitcnt vmcnt(2)
  v_max3_u32 v160, v65, v67, v69
  v_max_u32 v160, v160, v71
  v_cmp_eq_u32 vcc, -1, v160
  s_nop 4
  s_cbranch_vccnz KF_WR12
  s_branch KF_WR12_B
KF_WR13:
  s_add_u32 s72, s72, 1
  s_cmp_gt_u32 s72, 200000
  s_cbranch_scc1 KF_WR13_B
  buffer_load_dwordx4 v[72:75], v10, s[40:43], s55 offen offset:2048 sc1
  buffer_load_dwordx4 v[76:79], v10, s[40:43], s55 offen offset:3072 sc1
  s_waitcnt vmcnt(0)
  v_max3_u32 v160, v73, v75, v77
  v_max_u32 v160, v160, v79
  v_cmp_eq_u32 vcc, -1, v160
  s_nop 4
  s_cbranch_vccnz KF_WR13
  s_branch KF_WR13_B
KF_HR10:
  s_add_u32 s72, s72, 1
  s_cmp_gt_u32 s72, 200000
  s_cbranch_scc1 KF_HR10_B
  buffer_load_dwordx4 v[48:51], v2, s[40:43], s57 offen offset:0 sc1
  buffer_load_dwordx4 v[52:55], v2, s[40:43], s57 offen offset:1024 sc1
  buffer_load_dwordx4 v[56:59], v2, s[40:43], s57 offen offset:2048 sc1
  buffer_load_dwordx4 v[60:63], v2, s[40:43], s57 offen offset:3072 sc1
  buffer_load_dwordx4 v[64:67], v10, s[40:43], s57 offen offset:0 sc1
  buffer_load_dwordx4 v[68:71], v10, s[40:43], s57 offen offset:1024 sc1
  buffer_load_dwordx4 v[72:75], v10, s[40:43], s57 offen offset:2048 sc1
  buffer_load_dwordx2 v[136:137], v14, s[40:43], s59 offen offset:0 sc1
  buffer_load_dwordx2 v[138:139], v14, s[40:43], s59 offen offset:512 sc1
  buffer_load_dwordx2 v[140:141], v14, s[40:43], s59 offen offset:1024 sc1
  buffer_load_dwordx2 v[142:143], v14, s[40:43], s59 offen offset:1536 sc1
  s_waitcnt vmcnt(9)
  v_max3_u32 v160, v49, v51, v53
  v_max_u32 v160, v160, v55
  v_cmp_eq_u32 vcc, -1, v160
  s_nop 4
  s_cbranch_vccnz KF_HR10
  s_branch KF_HR10_B
KF_HR11:
  s_add_u32 s72, s72, 1
  s_cmp_gt_u32 s72, 200000
  s_cbranch_scc1 KF_HR11_B
  buffer_load_dwordx4 v[56:59], v2, s[40:43], s57 offen offset:2048 sc1
  buffer_load_dwordx4 v[60:63], v2, s[40:43], s57 offen offset:3072 sc1
  buffer_load_dwordx4 v[64:67], v10, s[40:43], s57 offen offset:0 sc1
  buffer_load_dwordx4 v[68:71], v10, s[40:43], s57 offen offset:1024 sc1
  buffer_load_dwordx4 v[72:75], v10, s[40:43], s57 offen offset:2048 sc1
  buffer_load_dwordx2 v[136:137], v14, s[40:43], s59 offen offset:0 sc1
  buffer_load_dwordx2 v[138:139], v14, s[40:43], s59 offen offset:512 sc1
  buffer_load_dwordx2 v[140:141], v14, s[40:43], s59 offen offset:1024 sc1
  buffer_load_dwordx2 v[142:143], v14, s[40:43], s59 offen offset:1536 sc1
  s_waitcnt vmcnt(7)
  v_max3_u32 v160, v57, v59, v61
  v_max_u32 v160, v160, v63
  v_cmp_eq_u32 vcc, -1, v160
  s_nop 4
  s_cbranch_vccnz KF_HR11
  s_branch KF_HR11_B
KF_HR12:
  s_add_u32 s72, s72, 1
  s_cmp_gt_u32 s72, 200000
  s_cbranch_scc1 KF_HR12_B
  buffer_load_dwordx4 v[64:67], v10, s[40:43], s57 offen offset:0 sc1
  buffer_load_dwordx4 v[68:71], v10, s[40:43], s57 offen offset:1024 sc1
  buffer_load_dwordx4 v[72:75], v10, s[40:43], s57 offen offset:2048 sc1
  buffer_load_dwordx2 v[136:137], v14, s[40:43], s59 offen offset:0 sc1
  buffer_load_dwordx2 v[138:139], v14, s[40:43], s59 offen offset:512 sc1
  buffer_load_dwordx2 v[140:141], v14, s[40:43], s59 offen offset:1024 sc1
  buffer_load_dwordx2 v[142:143], v14, s[40:43], s59 offen offset:1536 sc1
  s_waitcnt vmcnt(5)
  v_max3_u32 v160, v65, v67, v69
  v_max_u32 v160, v160, v71
  v_cmp_eq_u32 vcc, -1, v160
  s_nop 4
  s_cbranch_vccnz KF_HR12
  s_branch KF_HR12_B
KF_HR13:
  s_add_u32 s72, s72, 1
  s_cmp_gt_u32 s72, 200000
  s_cbranch_scc1 KF_HR13_B
  buffer_load_dwordx4 v[72:75], v10, s[40:43], s57 offen offset:2048 sc1
  buffer_load_dwordx2 v[136:137], v14, s[40:43], s59 offen offset:0 sc1
  buffer_load_dwordx2 v[138:139], v14, s[40:43], s59 offen offset:512 sc1
  buffer_load_dwordx2 v[140:141], v14, s[40:43], s59 offen offset:1024 sc1
  buffer_load_dwordx2 v[142:143], v14, s[40:43], s59 offen offset:1536 sc1
  s_waitcnt vmcnt(0)
  v_max3_u32 v160, v73, v75, v137
  v_max3_u32 v160, v160, v139, v141
  v_max_u32 v160, v160, v143
  v_cmp_eq_u32 vcc, -1, v160
  s_nop 4
  s_cbranch_vccnz KF_HR13
  s_branch KF_HR13_B
KF_R0:
  s_add_u32 s72, s72, 1
  s_cmp_gt_u32 s72, 200000
  s_cbranch_scc1 KF_R0_B
  s_waitcnt lgkmcnt(0)
  buffer_load_dwordx4 v[96:99], v3, s[40:43], s65 offen offset:0 sc1
  buffer_load_dwordx4 v[100:103], v3, s[40:43], s65 offen offset:1024 sc1
  buffer_load_dwordx4 v[104:107], v3, s[40:43], s65 offen offset:2048 sc1
  buffer_load_dwordx4 v[108:111], v3, s[40:43], s65 offen offset:3072 sc1
  buffer_load_dwordx4 v[112:115], v4, s[40:43], s65 offen offset:0 sc1
  buffer_load_dwordx4 v[116:119], v4, s[40:43], s65 offen offset:1024 sc1
  buffer_load_dwordx4 v[136:139], v4, s[40:43], s65 offen offset:2048 sc1
  buffer_load_dwordx4 v[140:143], v4, s[40:43], s65 offen offset:3072 sc1
  buffer_load_dwordx4 v[80:83], v5, s[40:43], s65 offen offset:0 sc1
  buffer_load_dwordx4 v[84:87], v5, s[40:43], s65 offen offset:1024 sc1
  buffer_load_dwordx4 v[88:91], v5, s[40:43], s65 offen offset:2048 sc1
  buffer_load_dwordx4 v[92:95], v5, s[40:43], s65 offen offset:3072 sc1
  buffer_load_dwordx4 v[120:123], v6, s[40:43], s65 offen offset:0 sc1
  buffer_load_dwordx4 v[124:127], v6, s[40:43], s65 offen offset:1024 sc1
  buffer_load_dwordx4 v[128:131], v6, s[40:43], s65 offen offset:2048 sc1
  s_waitcnt vmcnt(13)
  v_max3_u32 v160, v97, v99, v101
  v_max_u32 v160, v160, v103
  v_cmp_eq_u32 vcc, -1, v160
  s_nop 4
  s_cbranch_vccnz KF_R0
  s_branch KF_R0_B
KF_R1:
  s_add_u32 s72, s72, 1
  s_cmp_gt_u32 s72, 200000
  s_cbranch_scc1 KF_R1_B
  s_waitcnt lgkmcnt(0)
  buffer_load_dwordx4 v[104:107], v3, s[40:43], s65 offen offset:2048 sc1
  buffer_load_dwordx4 v[108:111], v3, s[40:43], s65 offen offset:3072 sc1
  buffer_load_dwordx4 v[112:115], v4, s[40:43], s65 offen offset:0 sc1
  buffer_load_dwordx4 v[116:119], v4, s[40:43], s65 offen offset:1024 sc1
  buffer_load_dwordx4 v[136:139], v4, s[40:43], s65 offen offset:2048 sc1
  buffer_load_dwordx4 v[140:143], v4, s[40:43], s65 offen offset:3072 sc1
  buffer_load_dwordx4 v[80:83], v5, s[40:43], s65 offen offset:0 sc1
  buffer_load_dwordx4 v[84:87], v5, s[40:43], s65 offen offset:1024 sc1
  buffer_load_dwordx4 v[88:91], v5, s[40:43], s65 offen offset:2048 sc1
  buffer_load_dwordx4 v[92:95], v5, s[40:43], s65 offen offset:3072 sc1
  buffer_load_dwordx4 v[120:123], v6, s[40:43], s65 offen offset:0 sc1
  buffer_load_dwordx4 v[124:127], v6, s[40:43], s65 offen offset:1024 sc1
  buffer_load_dwordx4 v[128:131], v6, s[40:43], s65 offen offset:2048 sc1
  buffer_load_dwordx4 v[132:135], v6, s[40:43], s65 offen offset:3072 sc1
  buffer_load_dwordx4 v[96:99], v7, s[40:43], s65 offen offset:0 sc1
  s_waitcnt vmcnt(13)
  v_max3_u32 v160, v105, v107, v109
  v_max_u32 v160, v160, v111
  v_cmp_eq_u32 vcc, -1, v160
  s_nop 4
  s_cbranch_vccnz KF_R1
  s_branch KF_R1_B
KF_R2:
  s_add_u32 s72, s72, 1
  s_cmp_gt_u32 s72, 200000
  s_cbranch_scc1 KF_R2_B
  s_waitcnt lgkmcnt(0)
  buffer_load_dwordx4 v[112:115], v4, s[40:43], s65 offen offset:0 sc1
  buffer_load_dwordx4 v[116:119], v4, s[40:43], s65 offen offset:1024 sc1
  buffer_load_dwordx4 v[136:139], v4, s[40:43], s65 offen offset:2048 sc1
  buffer_load_dwordx4 v[140:143], v4, s[40:43], s65 offen offset:3072 sc1
  buffer_load_dwordx4 v[80:83], v5, s[40:43], s65 offen offset:0 sc1
  buffer_load_dwordx4 v[84:87], v5, s[40:43], s65 offen offset:1024 sc1
  buffer_load_dwordx4 v[88:91], v5, s[40:43], s65 offen offset:2048 sc1
  buffer_load_dwordx4 v[92:95], v5, s[40:43], s65 offen offset:3072 sc1
  buffer_load_dwordx4 v[120:123], v6, s[40:43], s65 offen offset:0 sc1
  buffer_load_dwordx4 v[124:127], v6, s[40:43], s65 offen offset:1024 sc1
  buffer_load_dwordx4 v[128:131], v6, s[40:43], s65 offen offset:2048 sc1
  buffer_load_dwordx4 v[132:135], v6, s[40:43], s65 offen offset:3072 sc1
  buffer_load_dwordx4 v[96:99], v7, s[40:43], s65 offen offset:0 sc1
  buffer_load_dwordx4 v[100:103], v7, s[40:43], s65 offen offset:1024 sc1
  buffer_load_dwordx4 v[104:107], v7, s[40:43], s65 offen offset:2048 sc1
  s_waitcnt vmcnt(13)
  v_max3_u32 v160, v113, v115, v117
  v_max_u32 v160, v160, v119
  v_cmp_eq_u32 vcc, -1, v160
  s_nop 4
  s_cbranch_vccnz KF_R2
  s_branch KF_R2_B
KF_R3:
  s_add_u32 s72, s72, 1
  s_cmp_gt_u32 s72, 200000
  s_cbranch_scc1 KF_R3_B
  s_waitcnt lgkmcnt(0)
  buffer_load_dwordx4 v[136:139], v4, s[40:43], s65 offen offset:2048 sc1
  buffer_load_dwordx4 v[140:143], v4, s[40:43], s65 offen offset:3072 sc1
  buffer_load_dwordx4 v[80:83], v5, s[40:43], s65 offen offset:0 sc1
  buffer_load_dwordx4 v[84:87], v5, s[40:43], s65 offen offset:1024 sc1
  buffer_load_dwordx4 v[88:91], v5, s[40:43], s65 offen offset:2048 sc1
  buffer_load_dwordx4 v[92:95], v5, s[40:43], s65 offen offset:3072 sc1
  buffer_load_dwordx4 v[120:123], v6, s[40:43], s65 offen offset:0 sc1
  buffer_load_dwordx4 v[124:127], v6, s[40:43], s65 offen offset:1024 sc1
  buffer_load_dwordx4 v[128:131], v6, s[40:43], s65 offen offset:2048 sc1
  buffer_load_dwordx4 v[132:135], v6, s[40:43], s65 offen offset:3072 sc1
  buffer_load_dwordx4 v[96:99], v7, s[40:43], s65 offen offset:0 sc1
  buffer_load_dwordx4 v[100:103], v7, s[40:43], s65 offen offset:1024 sc1
  buffer_load_dwordx4 v[104:107], v7, s[40:43], s65 offen offset:2048 sc1
  buffer_load_dwordx4 v[108:111], v7, s[40:43], s65 offen offset:3072 sc1
  buffer_load_dwordx4 v[112:115], v8, s[40:43], s65 offen offset:0 sc1
  s_waitcnt vmcnt(13)
  v_max3_u32 v160, v137, v139, v141
  v_max_u32 v160, v160, v143
  v_cmp_eq_u32 vcc, -1, v160
  s_nop 4
  s_cbranch_vccnz KF_R3
  s_branch KF_R3_B
KF_R4:
  s_add_u32 s72, s72, 1
  s_cmp_gt_u32 s72, 200000
  s_cbranch_scc1 KF_R4_B
  s_waitcnt lgkmcnt(0)
  buffer_load_dwordx4 v[80:83], v5, s[40:43], s65 offen offset:0 sc1
  buffer_load_dwordx4 v[84:87], v5, s[40:43], s65 offen offset:1024 sc1
  buffer_load_dwordx4 v[88:91], v5, s[40:43], s65 offen offset:2048 sc1
  buffer_load_dwordx4 v[92:95], v5, s[40:43], s65 offen offset:3072 sc1
  buffer_load_dwordx4 v[120:123], v6, s[40:43], s65 offen offset:0 sc1
  buffer_load_dwordx4 v[124:127], v6, s[40:43], s65 offen offset:1024 sc1
  buffer_load_dwordx4 v[128:131], v6, s[40:43], s65 offen offset:2048 sc1
  buffer_load_dwordx4 v[132:135], v6, s[40:43], s65 offen offset:3072 sc1
  buffer_load_dwordx4 v[96:99], v7, s[40:43], s65 offen offset:0 sc1
  buffer_load_dwordx4 v[100:103], v7, s[40:43], s65 offen offset:1024 sc1
  buffer_load_dwordx4 v[104:107], v7, s[40:43], s65 offen offset:2048 sc1
  buffer_load_dwordx4 v[108:111], v7, s[40:43], s65 offen offset:3072 sc1
  buffer_load_dwordx4 v[112:115], v8, s[40:43], s65 offen offset:0 sc1
  buffer_load_dwordx4 v[116:119], v8, s[40:43], s65 offen offset:1024 sc1
  buffer_load_dwordx4 v[136:139], v8, s[40:43], s65 offen offset:2048 sc1
  s_waitcnt vmcnt(13)
  v_max3_u32 v160, v81, v83, v85
  v_max_u32 v160, v160, v87
  v_cmp_eq_u32 vcc, -1, v160
  s_nop 4
  s_cbranch_vccnz KF_R4
  s_branch KF_R4_B
KF_R5:
  s_add_u32 s72, s72, 1
  s_cmp_gt_u32 s72, 200000
  s_cbranch_scc1 KF_R5_B
  s_waitcnt lgkmcnt(0)
  buffer_load_dwordx4 v[88:91], v5, s[40:43], s65 offen offset:2048 sc1
  buffer_load_dwordx4 v[92:95], v5, s[40:43], s65 offen offset:3072 sc1
  buffer_load_dwordx4 v[120:123], v6, s[40:43], s65 offen offset:0 sc1
  buffer_load_dwordx4 v[124:127], v6, s[40:43], s65 offen offset:1024 sc1
  buffer_load_dwordx4 v[128:131], v6, s[40:43], s65 offen offset:2048 sc1
  buffer_load_dwordx4 v[132:135], v6, s[40:43], s65 offen offset:3072 sc1
  buffer_load_dwordx4 v[96:99], v7, s[40:43], s65 offen offset:0 sc1
  buffer_load_dwordx4 v[100:103], v7, s[40:43], s65 offen offset:1024 sc1
  buffer_load_dwordx4 v[104:107], v7, s[40:43], s65 offen offset:2048 sc1
  buffer_load_dwordx4 v[108:111], v7, s[40:43], s65 offen offset:3072 sc1
  buffer_load_dwordx4 v[112:115], v8, s[40:43], s65 offen offset:0 sc1
  buffer_load_dwordx4 v[116:119], v8, s[40:43], s65 offen offset:1024 sc1
  buffer_load_dwordx4 v[136:139], v8, s[40:43], s65 offen offset:2048 sc1
  buffer_load_dwordx4 v[140:143], v8, s[40:43], s65 offen offset:3072 sc1
  buffer_load_dwordx4 v[80:83], v9, s[40:43], s65 offen offset:0 sc1
  s_waitcnt vmcnt(13)
  v_max3_u32 v160, v89, v91, v93
  v_max_u32 v160, v160, v95
  v_cmp_eq_u32 vcc, -1, v160
  s_nop 4
  s_cbranch_vccnz KF_R5
  s_branch KF_R5_B
KF_R6:
  s_add_u32 s72, s72, 1
  s_cmp_gt_u32 s72, 200000
  s_cbranch_scc1 KF_R6_B
  s_waitcnt lgkmcnt(0)
  buffer_load_dwordx4 v[120:123], v6, s[40:43], s65 offen offset:0 sc1
  buffer_load_dwordx4 v[124:127], v6, s[40:43], s65 offen offset:1024 sc1
  buffer_load_dwordx4 v[128:131], v6, s[40:43], s65 offen offset:2048 sc1
  buffer_load_dwordx4 v[132:135], v6, s[40:43], s65 offen offset:3072 sc1
  buffer_load_dwordx4 v[96:99], v7, s[40:43], s65 offen offset:0 sc1
  buffer_load_dwordx4 v[100:103], v7, s[40:43], s65 offen offset:1024 sc1
  buffer_load_dwordx4 v[104:107], v7, s[40:43], s65 offen offset:2048 sc1
  buffer_load_dwordx4 v[108:111], v7, s[40:43], s65 offen offset:3072 sc1
  buffer_load_dwordx4 v[112:115], v8, s[40:43], s65 offen offset:0 sc1
  buffer_load_dwordx4 v[116:119], v8, s[40:43], s65 offen offset:1024 sc1
  buffer_load_dwordx4 v[136:139], v8, s[40:43], s65 offen offset:2048 sc1
  buffer_load_dwordx4 v[140:143], v8, s[40:43], s65 offen offset:3072 sc1
  buffer_load_dwordx4 v[80:83], v9, s[40:43], s65 offen offset:0 sc1
  buffer_load_dwordx4 v[84:87], v9, s[40:43], s65 offen offset:1024 sc1
  buffer_load_dwordx4 v[88:91], v9, s[40:43], s65 offen offset:2048 sc1
  s_waitcnt vmcnt(13)
  v_max3_u32 v160, v121, v123, v125
  v_max_u32 v160, v160, v127
  v_cmp_eq_u32 vcc, -1, v160
  s_nop 4
  s_cbranch_vccnz KF_R6
  s_branch KF_R6_B
KF_R7:
  s_add_u32 s72, s72, 1
  s_cmp_gt_u32 s72, 200000
  s_cbranch_scc1 KF_R7_B
  s_waitcnt lgkmcnt(0)
  buffer_load_dwordx4 v[128:131], v6, s[40:43], s65 offen offset:2048 sc1
  buffer_load_dwordx4 v[132:135], v6, s[40:43], s65 offen offset:3072 sc1
  buffer_load_dwordx4 v[96:99], v7, s[40:43], s65 offen offset:0 sc1
  buffer_load_dwordx4 v[100:103], v7, s[40:43], s65 offen offset:1024 sc1
  buffer_load_dwordx4 v[104:107], v7, s[40:43], s65 offen offset:2048 sc1
  buffer_load_dwordx4 v[108:111], v7, s[40:43], s65 offen offset:3072 sc1
  buffer_load_dwordx4 v[112:115], v8, s[40:43], s65 offen offset:0 sc1
  buffer_load_dwordx4 v[116:119], v8, s[40:43], s65 offen offset:1024 sc1
  buffer_load_dwordx4 v[136:139], v8, s[40:43], s65 offen offset:2048 sc1
  buffer_load_dwordx4 v[140:143], v8, s[40:43], s65 offen offset:3072 sc1
  buffer_load_dwordx4 v[80:83], v9, s[40:43], s65 offen offset:0 sc1
  buffer_load_dwordx4 v[84:87], v9, s[40:43], s65 offen offset:1024 sc1
  buffer_load_dwordx4 v[88:91], v9, s[40:43], s65 offen offset:2048 sc1
  buffer_load_dwordx4 v[92:95], v9, s[40:43], s65 offen offset:3072 sc1
  buffer_load_dwordx4 v[120:123], v3, s[40:43], s66 offen offset:0 sc1
  s_waitcnt vmcnt(13)
  v_max3_u32 v160, v129, v131, v133
  v_max_u32 v160, v160, v135
  v_cmp_eq_u32 vcc, -1, v160
  s_nop 4
  s_cbranch_vccnz KF_R7
  s_branch KF_R7_B
KF_R8:
  s_add_u32 s72, s72, 1
  s_cmp_gt_u32 s72, 200000
  s_cbranch_scc1 KF_R8_B
  s_waitcnt lgkmcnt(0)
  buffer_load_dwordx4 v[96:99], v7, s[40:43], s65 offen offset:0 sc1
  buffer_load_dwordx4 v[100:103], v7, s[40:43], s65 offen offset:1024 sc1
  buffer_load_dwordx4 v[104:107], v7, s[40:43], s65 offen offset:2048 sc1
  buffer_load_dwordx4 v[108:111], v7, s[40:43], s65 offen offset:3072 sc1
  buffer_load_dwordx4 v[112:115], v8, s[40:43], s65 offen offset:0 sc1
  buffer_load_dwordx4 v[116:119], v8, s[40:43], s65 offen offset:1024 sc1
  buffer_load_dwordx4 v[136:139], v8, s[40:43], s65 offen offset:2048 sc1
  buffer_load_dwordx4 v[140:143], v8, s[40:43], s65 offen offset:3072 sc1
  buffer_load_dwordx4 v[80:83], v9, s[40:43], s65 offen offset:0 sc1
  buffer_load_dwordx4 v[84:87], v9, s[40:43], s65 offen offset:1024 sc1
  buffer_load_dwordx4 v[88:91], v9, s[40:43], s65 offen offset:2048 sc1
  buffer_load_dwordx4 v[92:95], v9, s[40:43], s65 offen offset:3072 sc1
  buffer_load_dwordx4 v[120:123], v3, s[40:43], s66 offen offset:0 sc1
  buffer_load_dwordx4 v[124:127], v3, s[40:43], s66 offen offset:1024 sc1
  buffer_load_dwordx4 v[128:131], v3, s[40:43], s66 offen offset:2048 sc1
  s_waitcnt vmcnt(13)
  v_max3_u32 v160, v97, v99, v101
  v_max_u32 v160, v160, v103
  v_cmp_eq_u32 vcc, -1, v160
  s_nop 4
  s_cbranch_vccnz KF_R8
  s_branch KF_R8_B
KF_R9:
  s_add_u32 s72, s72, 1
  s_cmp_gt_u32 s72, 200000
  s_cbranch_scc1 KF_R9_B
  s_waitcnt lgkmcnt(0)
  buffer_load_dwordx4 v[104:107], v7, s[40:43], s65 offen offset:2048 sc1
  buffer_load_dwordx4 v[108:111], v7, s[40:43], s65 offen offset:3072 sc1
  buffer_load_dwordx4 v[112:115], v8, s[40:43], s65 offen offset:0 sc1
  buffer_load_dwordx4 v[116:119], v8, s[40:43], s65 offen offset:1024 sc1
  buffer_load_dwordx4 v[136:139], v8, s[40:43], s65 offen offset:2048 sc1
  buffer_load_dwordx4 v[140:143], v8, s[40:43], s65 offen offset:3072 sc1
  buffer_load_dwordx4 v[80:83], v9, s[40:43], s65 offen offset:0 sc1
  buffer_load_dwordx4 v[84:87], v9, s[40:43], s65 offen offset:1024 sc1
  buffer_load_dwordx4 v[88:91], v9, s[40:43], s65 offen offset:2048 sc1
  buffer_load_dwordx4 v[92:95], v9, s[40:43], s65 offen offset:3072 sc1
  buffer_load_dwordx4 v[120:123], v3, s[40:43], s66 offen offset:0 sc1
  buffer_load_dwordx4 v[124:127], v3, s[40:43], s66 offen offset:1024 sc1
  buffer_load_dwordx4 v[128:131], v3, s[40:43], s66 offen offset:2048 sc1
  buffer_load_dwordx4 v[132:135], v3, s[40:43], s66 offen offset:3072 sc1
  buffer_load_dwordx4 v[96:99], v4, s[40:43], s66 offen offset:0 sc1
  s_waitcnt vmcnt(13)
  v_max3_u32 v160, v105, v107, v109
  v_max_u32 v160, v160, v111
  v_cmp_eq_u32 vcc, -1, v160
  s_nop 4
  s_cbranch_vccnz KF_R9
  s_branch KF_R9_B
KF_R10:
  s_add_u32 s72, s72, 1
  s_cmp_gt_u32 s72, 200000
  s_cbranch_scc1 KF_R10_B
  s_waitcnt lgkmcnt(0)
  buffer_load_dwordx4 v[112:115], v8, s[40:43], s65 offen offset:0 sc1
  buffer_load_dwordx4 v[116:119], v8, s[40:43], s65 offen offset:1024 sc1
  buffer_load_dwordx4 v[136:139], v8, s[40:43], s65 offen offset:2048 sc1
  buffer_load_dwordx4 v[140:143], v8, s[40:43], s65 offen offset:3072 sc1
  buffer_load_dwordx4 v[80:83], v9, s[40:43], s65 offen offset:0 sc1
  buffer_load_dwordx4 v[84:87], v9, s[40:43], s65 offen offset:1024 sc1
  buffer_load_dwordx4 v[88:91], v9, s[40:43], s65 offen offset:2048 sc1
  buffer_load_dwordx4 v[92:95], v9, s[40:43], s65 offen offset:3072 sc1
  buffer_load_dwordx4 v[120:123], v3, s[40:43], s66 offen offset:0 sc1
  buffer_load_dwordx4 v[124:127], v3, s[40:43], s66 offen offset:1024 sc1
  buffer_load_dwordx4 v[128:131], v3, s[40:43], s66 offen offset:2048 sc1
  buffer_load_dwordx4 v[132:135], v3, s[40:43], s66 offen offset:3072 sc1
  buffer_load_dwordx4 v[96:99], v4, s[40:43], s66 offen offset:0 sc1
  buffer_load_dwordx4 v[100:103], v4, s[40:43], s66 offen offset:1024 sc1
  buffer_load_dwordx4 v[104:107], v4, s[40:43], s66 offen offset:2048 sc1
  s_waitcnt vmcnt(13)
  v_max3_u32 v160, v113, v115, v117
  v_max_u32 v160, v160, v119
  v_cmp_eq_u32 vcc, -1, v160
  s_nop 4
  s_cbranch_vccnz KF_R10
  s_branch KF_R10_B
KF_R11:
  s_add_u32 s72, s72, 1
  s_cmp_gt_u32 s72, 200000
  s_cbranch_scc1 KF_R11_B
  s_waitcnt lgkmcnt(0)
  buffer_load_dwordx4 v[136:139], v8, s[40:43], s65 offen offset:2048 sc1
  buffer_load_dwordx4 v[140:143], v8, s[40:43], s65 offen offset:3072 sc1
  buffer_load_dwordx4 v[80:83], v9, s[40:43], s65 offen offset:0 sc1
  buffer_load_dwordx4 v[84:87], v9, s[40:43], s65 offen offset:1024 sc1
  buffer_load_dwordx4 v[88:91], v9, s[40:43], s65 offen offset:2048 sc1
  buffer_load_dwordx4 v[92:95], v9, s[40:43], s65 offen offset:3072 sc1
  buffer_load_dwordx4 v[120:123], v3, s[40:43], s66 offen offset:0 sc1
  buffer_load_dwordx4 v[124:127], v3, s[40:43], s66 offen offset:1024 sc1
  buffer_load_dwordx4 v[128:131], v3, s[40:43], s66 offen offset:2048 sc1
  buffer_load_dwordx4 v[132:135], v3, s[40:43], s66 offen offset:3072 sc1
  buffer_load_dwordx4 v[96:99], v4, s[40:43], s66 offen offset:0 sc1
  buffer_load_dwordx4 v[100:103], v4, s[40:43], s66 offen offset:1024 sc1
  buffer_load_dwordx4 v[104:107], v4, s[40:43], s66 offen offset:2048 sc1
  buffer_load_dwordx4 v[108:111], v4, s[40:43], s66 offen offset:3072 sc1
  buffer_load_dwordx4 v[112:115], v5, s[40:43], s66 offen offset:0 sc1
  s_waitcnt vmcnt(13)
  v_max3_u32 v160, v137, v139, v141
  v_max_u32 v160, v160, v143
  v_cmp_eq_u32 vcc, -1, v160
  s_nop 4
  s_cbranch_vccnz KF_R11
  s_branch KF_R11_B
KF_R12:
  s_add_u32 s72, s72, 1
  s_cmp_gt_u32 s72, 200000
  s_cbranch_scc1 KF_R12_B
  s_waitcnt lgkmcnt(0)
  buffer_load_dwordx4 v[80:83], v9, s[40:43], s65 offen offset:0 sc1
  buffer_load_dwordx4 v[84:87], v9, s[40:43], s65 offen offset:1024 sc1
  buffer_load_dwordx4 v[88:91], v9, s[40:43], s65 offen offset:2048 sc1
  buffer_load_dwordx4 v[92:95], v9, s[40:43], s65 offen offset:3072 sc1
  buffer_load_dwordx4 v[120:123], v3, s[40:43], s66 offen offset:0 sc1
  buffer_load_dwordx4 v[124:127], v3, s[40:43], s66 offen offset:1024 sc1
  buffer_load_dwordx4 v[128:131], v3, s[40:43], s66 offen offset:2048 sc1
  buffer_load_dwordx4 v[132:135], v3, s[40:43], s66 offen offset:3072 sc1
  buffer_load_dwordx4 v[96:99], v4, s[40:43], s66 offen offset:0 sc1
  buffer_load_dwordx4 v[100:103], v4, s[40:43], s66 offen offset:1024 sc1
  buffer_load_dwordx4 v[104:107], v4, s[40:43], s66 offen offset:2048 sc1
  buffer_load_dwordx4 v[108:111], v4, s[40:43], s66 offen offset:3072 sc1
  buffer_load_dwordx4 v[112:115], v5, s[40:43], s66 offen offset:0 sc1
  buffer_load_dwordx4 v[116:119], v5, s[40:43], s66 offen offset:1024 sc1
  buffer_load_dwordx4 v[136:139], v5, s[40:43], s66 offen offset:2048 sc1
  s_waitcnt vmcnt(13)
  v_max3_u32 v160, v81, v83, v85
  v_max_u32 v160, v160, v87
  v_cmp_eq_u32 vcc, -1, v160
  s_nop 4
  s_cbranch_vccnz KF_R12
  s_branch KF_R12_B
KF_R13:
  s_add_u32 s72, s72, 1
  s_cmp_gt_u32 s72, 200000
  s_cbranch_scc1 KF_R13_B
  s_waitcnt lgkmcnt(0)
  buffer_load_dwordx4 v[88:91], v9, s[40:43], s65 offen offset:2048 sc1
  buffer_load_dwordx4 v[92:95], v9, s[40:43], s65 offen offset:3072 sc1
  buffer_load_dwordx4 v[120:123], v3, s[40:43], s66 offen offset:0 sc1
  buffer_load_dwordx4 v[124:127], v3, s[40:43], s66 offen offset:1024 sc1
  buffer_load_dwordx4 v[128:131], v3, s[40:43], s66 offen offset:2048 sc1
  buffer_load_dwordx4 v[132:135], v3, s[40:43], s66 offen offset:3072 sc1
  buffer_load_dwordx4 v[96:99], v4, s[40:43], s66 offen offset:0 sc1
  buffer_load_dwordx4 v[100:103], v4, s[40:43], s66 offen offset:1024 sc1
  buffer_load_dwordx4 v[104:107], v4, s[40:43], s66 offen offset:2048 sc1
  buffer_load_dwordx4 v[108:111], v4, s[40:43], s66 offen offset:3072 sc1
  buffer_load_dwordx4 v[112:115], v5, s[40:43], s66 offen offset:0 sc1
  buffer_load_dwordx4 v[116:119], v5, s[40:43], s66 offen offset:1024 sc1
  buffer_load_dwordx4 v[136:139], v5, s[40:43], s66 offen offset:2048 sc1
  buffer_load_dwordx4 v[140:143], v5, s[40:43], s66 offen offset:3072 sc1
  buffer_load_dwordx4 v[80:83], v6, s[40:43], s66 offen offset:0 sc1
  s_waitcnt vmcnt(13)
  v_max3_u32 v160, v89, v91, v93
  v_max_u32 v160, v160, v95
  v_cmp_eq_u32 vcc, -1, v160
  s_nop 4
  s_cbranch_vccnz KF_R13
  s_branch KF_R13_B
KF_R14:
  s_add_u32 s72, s72, 1
  s_cmp_gt_u32 s72, 200000
  s_cbranch_scc1 KF_R14_B
  s_waitcnt lgkmcnt(0)
  buffer_load_dwordx4 v[120:123], v3, s[40:43], s66 offen offset:0 sc1
  buffer_load_dwordx4 v[124:127], v3, s[40:43], s66 offen offset:1024 sc1
  buffer_load_dwordx4 v[128:131], v3, s[40:43], s66 offen offset:2048 sc1
  buffer_load_dwordx4 v[132:135], v3, s[40:43], s66 offen offset:3072 sc1
  buffer_load_dwordx4 v[96:99], v4, s[40:43], s66 offen offset:0 sc1
  buffer_load_dwordx4 v[100:103], v4, s[40:43], s66 offen offset:1024 sc1
  buffer_load_dwordx4 v[104:107], v4, s[40:43], s66 offen offset:2048 sc1
  buffer_load_dwordx4 v[108:111], v4, s[40:43], s66 offen offset:3072 sc1
  buffer_load_dwordx4 v[112:115], v5, s[40:43], s66 offen offset:0 sc1
  buffer_load_dwordx4 v[116:119], v5, s[40:43], s66 offen offset:1024 sc1
  buffer_load_dwordx4 v[136:139], v5, s[40:43], s66 offen offset:2048 sc1
  buffer_load_dwordx4 v[140:143], v5, s[40:43], s66 offen offset:3072 sc1
  buffer_load_dwordx4 v[80:83], v6, s[40:43], s66 offen offset:0 sc1
  buffer_load_dwordx4 v[84:87], v6, s[40:43], s66 offen offset:1024 sc1
  buffer_load_dwordx4 v[88:91], v6, s[40:43], s66 offen offset:2048 sc1
  s_waitcnt vmcnt(13)
  v_max3_u32 v160, v121, v123, v125
  v_max_u32 v160, v160, v127
  v_cmp_eq_u32 vcc, -1, v160
  s_nop 4
  s_cbranch_vccnz KF_R14
  s_branch KF_R14_B
KF_R15:
  s_add_u32 s72, s72, 1
  s_cmp_gt_u32 s72, 200000
  s_cbranch_scc1 KF_R15_B
  s_waitcnt lgkmcnt(0)
  buffer_load_dwordx4 v[128:131], v3, s[40:43], s66 offen offset:2048 sc1
  buffer_load_dwordx4 v[132:135], v3, s[40:43], s66 offen offset:3072 sc1
  buffer_load_dwordx4 v[96:99], v4, s[40:43], s66 offen offset:0 sc1
  buffer_load_dwordx4 v[100:103], v4, s[40:43], s66 offen offset:1024 sc1
  buffer_load_dwordx4 v[104:107], v4, s[40:43], s66 offen offset:2048 sc1
  buffer_load_dwordx4 v[108:111], v4, s[40:43], s66 offen offset:3072 sc1
  buffer_load_dwordx4 v[112:115], v5, s[40:43], s66 offen offset:0 sc1
  buffer_load_dwordx4 v[116:119], v5, s[40:43], s66 offen offset:1024 sc1
  buffer_load_dwordx4 v[136:139], v5, s[40:43], s66 offen offset:2048 sc1
  buffer_load_dwordx4 v[140:143], v5, s[40:43], s66 offen offset:3072 sc1
  buffer_load_dwordx4 v[80:83], v6, s[40:43], s66 offen offset:0 sc1
  buffer_load_dwordx4 v[84:87], v6, s[40:43], s66 offen offset:1024 sc1
  buffer_load_dwordx4 v[88:91], v6, s[40:43], s66 offen offset:2048 sc1
  buffer_load_dwordx4 v[92:95], v6, s[40:43], s66 offen offset:3072 sc1
  buffer_load_dwordx4 v[120:123], v7, s[40:43], s66 offen offset:0 sc1
  s_waitcnt vmcnt(13)
  v_max3_u32 v160, v129, v131, v133
  v_max_u32 v160, v160, v135
  v_cmp_eq_u32 vcc, -1, v160
  s_nop 4
  s_cbranch_vccnz KF_R15
  s_branch KF_R15_B
KF_R16:
  s_add_u32 s72, s72, 1
  s_cmp_gt_u32 s72, 200000
  s_cbranch_scc1 KF_R16_B
  s_waitcnt lgkmcnt(0)
  buffer_load_dwordx4 v[96:99], v4, s[40:43], s66 offen offset:0 sc1
  buffer_load_dwordx4 v[100:103], v4, s[40:43], s66 offen offset:1024 sc1
  buffer_load_dwordx4 v[104:107], v4, s[40:43], s66 offen offset:2048 sc1
  buffer_load_dwordx4 v[108:111], v4, s[40:43], s66 offen offset:3072 sc1
  buffer_load_dwordx4 v[112:115], v5, s[40:43], s66 offen offset:0 sc1
  buffer_load_dwordx4 v[116:119], v5, s[40:43], s66 offen offset:1024 sc1
  buffer_load_dwordx4 v[136:139], v5, s[40:43], s66 offen offset:2048 sc1
  buffer_load_dwordx4 v[140:143], v5, s[40:43], s66 offen offset:3072 sc1
  buffer_load_dwordx4 v[80:83], v6, s[40:43], s66 offen offset:0 sc1
  buffer_load_dwordx4 v[84:87], v6, s[40:43], s66 offen offset:1024 sc1
  buffer_load_dwordx4 v[88:91], v6, s[40:43], s66 offen offset:2048 sc1
  buffer_load_dwordx4 v[92:95], v6, s[40:43], s66 offen offset:3072 sc1
  buffer_load_dwordx4 v[120:123], v7, s[40:43], s66 offen offset:0 sc1
  buffer_load_dwordx4 v[124:127], v7, s[40:43], s66 offen offset:1024 sc1
  buffer_load_dwordx4 v[128:131], v7, s[40:43], s66 offen offset:2048 sc1
  s_waitcnt vmcnt(13)
  v_max3_u32 v160, v97, v99, v101
  v_max_u32 v160, v160, v103
  v_cmp_eq_u32 vcc, -1, v160
  s_nop 4
  s_cbranch_vccnz KF_R16
  s_branch KF_R16_B
KF_R17:
  s_add_u32 s72, s72, 1
  s_cmp_gt_u32 s72, 200000
  s_cbranch_scc1 KF_R17_B
  s_waitcnt lgkmcnt(0)
  buffer_load_dwordx4 v[104:107], v4, s[40:43], s66 offen offset:2048 sc1
  buffer_load_dwordx4 v[108:111], v4, s[40:43], s66 offen offset:3072 sc1
  buffer_load_dwordx4 v[112:115], v5, s[40:43], s66 offen offset:0 sc1
  buffer_load_dwordx4 v[116:119], v5, s[40:43], s66 offen offset:1024 sc1
  buffer_load_dwordx4 v[136:139], v5, s[40:43], s66 offen offset:2048 sc1
  buffer_load_dwordx4 v[140:143], v5, s[40:43], s66 offen offset:3072 sc1
  buffer_load_dwordx4 v[80:83], v6, s[40:43], s66 offen offset:0 sc1
  buffer_load_dwordx4 v[84:87], v6, s[40:43], s66 offen offset:1024 sc1
  buffer_load_dwordx4 v[88:91], v6, s[40:43], s66 offen offset:2048 sc1
  buffer_load_dwordx4 v[92:95], v6, s[40:43], s66 offen offset:3072 sc1
  buffer_load_dwordx4 v[120:123], v7, s[40:43], s66 offen offset:0 sc1
  buffer_load_dwordx4 v[124:127], v7, s[40:43], s66 offen offset:1024 sc1
  buffer_load_dwordx4 v[128:131], v7, s[40:43], s66 offen offset:2048 sc1
  buffer_load_dwordx4 v[132:135], v7, s[40:43], s66 offen offset:3072 sc1
  buffer_load_dwordx4 v[96:99], v8, s[40:43], s66 offen offset:0 sc1
  s_waitcnt vmcnt(13)
  v_max3_u32 v160, v105, v107, v109
  v_max_u32 v160, v160, v111
  v_cmp_eq_u32 vcc, -1, v160
  s_nop 4
  s_cbranch_vccnz KF_R17
  s_branch KF_R17_B
KF_R18:
  s_add_u32 s72, s72, 1
  s_cmp_gt_u32 s72, 200000
  s_cbranch_scc1 KF_R18_B
  s_waitcnt lgkmcnt(0)
  buffer_load_dwordx4 v[112:115], v5, s[40:43], s66 offen offset:0 sc1
  buffer_load_dwordx4 v[116:119], v5, s[40:43], s66 offen offset:1024 sc1
  buffer_load_dwordx4 v[136:139], v5, s[40:43], s66 offen offset:2048 sc1
  buffer_load_dwordx4 v[140:143], v5, s[40:43], s66 offen offset:3072 sc1
  buffer_load_dwordx4 v[80:83], v6, s[40:43], s66 offen offset:0 sc1
  buffer_load_dwordx4 v[84:87], v6, s[40:43], s66 offen offset:1024 sc1
  buffer_load_dwordx4 v[88:91], v6, s[40:43], s66 offen offset:2048 sc1
  buffer_load_dwordx4 v[92:95], v6, s[40:43], s66 offen offset:3072 sc1
  buffer_load_dwordx4 v[120:123], v7, s[40:43], s66 offen offset:0 sc1
  buffer_load_dwordx4 v[124:127], v7, s[40:43], s66 offen offset:1024 sc1
  buffer_load_dwordx4 v[128:131], v7, s[40:43], s66 offen offset:2048 sc1
  buffer_load_dwordx4 v[132:135], v7, s[40:43], s66 offen offset:3072 sc1
  buffer_load_dwordx4 v[96:99], v8, s[40:43], s66 offen offset:0 sc1
  buffer_load_dwordx4 v[100:103], v8, s[40:43], s66 offen offset:1024 sc1
  buffer_load_dwordx4 v[104:107], v8, s[40:43], s66 offen offset:2048 sc1
  s_waitcnt vmcnt(13)
  v_max3_u32 v160, v113, v115, v117
  v_max_u32 v160, v160, v119
  v_cmp_eq_u32 vcc, -1, v160
  s_nop 4
  s_cbranch_vccnz KF_R18
  s_branch KF_R18_B
KF_R19:
  s_add_u32 s72, s72, 1
  s_cmp_gt_u32 s72, 200000
  s_cbranch_scc1 KF_R19_B
  s_waitcnt lgkmcnt(0)
  buffer_load_dwordx4 v[136:139], v5, s[40:43], s66 offen offset:2048 sc1
  buffer_load_dwordx4 v[140:143], v5, s[40:43], s66 offen offset:3072 sc1
  buffer_load_dwordx4 v[80:83], v6, s[40:43], s66 offen offset:0 sc1
  buffer_load_dwordx4 v[84:87], v6, s[40:43], s66 offen offset:1024 sc1
  buffer_load_dwordx4 v[88:91], v6, s[40:43], s66 offen offset:2048 sc1
  buffer_load_dwordx4 v[92:95], v6, s[40:43], s66 offen offset:3072 sc1
  buffer_load_dwordx4 v[120:123], v7, s[40:43], s66 offen offset:0 sc1
  buffer_load_dwordx4 v[124:127], v7, s[40:43], s66 offen offset:1024 sc1
  buffer_load_dwordx4 v[128:131], v7, s[40:43], s66 offen offset:2048 sc1
  buffer_load_dwordx4 v[132:135], v7, s[40:43], s66 offen offset:3072 sc1
  buffer_load_dwordx4 v[96:99], v8, s[40:43], s66 offen offset:0 sc1
  buffer_load_dwordx4 v[100:103], v8, s[40:43], s66 offen offset:1024 sc1
  buffer_load_dwordx4 v[104:107], v8, s[40:43], s66 offen offset:2048 sc1
  buffer_load_dwordx4 v[108:111], v8, s[40:43], s66 offen offset:3072 sc1
  buffer_load_dwordx4 v[112:115], v9, s[40:43], s66 offen offset:0 sc1
  s_waitcnt vmcnt(13)
  v_max3_u32 v160, v137, v139, v141
  v_max_u32 v160, v160, v143
  v_cmp_eq_u32 vcc, -1, v160
  s_nop 4
  s_cbranch_vccnz KF_R19
  s_branch KF_R19_B
KF_R20:
  s_add_u32 s72, s72, 1
  s_cmp_gt_u32 s72, 200000
  s_cbranch_scc1 KF_R20_B
  s_waitcnt lgkmcnt(0)
  buffer_load_dwordx4 v[80:83], v6, s[40:43], s66 offen offset:0 sc1
  buffer_load_dwordx4 v[84:87], v6, s[40:43], s66 offen offset:1024 sc1
  buffer_load_dwordx4 v[88:91], v6, s[40:43], s66 offen offset:2048 sc1
  buffer_load_dwordx4 v[92:95], v6, s[40:43], s66 offen offset:3072 sc1
  buffer_load_dwordx4 v[120:123], v7, s[40:43], s66 offen offset:0 sc1
  buffer_load_dwordx4 v[124:127], v7, s[40:43], s66 offen offset:1024 sc1
  buffer_load_dwordx4 v[128:131], v7, s[40:43], s66 offen offset:2048 sc1
  buffer_load_dwordx4 v[132:135], v7, s[40:43], s66 offen offset:3072 sc1
  buffer_load_dwordx4 v[96:99], v8, s[40:43], s66 offen offset:0 sc1
  buffer_load_dwordx4 v[100:103], v8, s[40:43], s66 offen offset:1024 sc1
  buffer_load_dwordx4 v[104:107], v8, s[40:43], s66 offen offset:2048 sc1
  buffer_load_dwordx4 v[108:111], v8, s[40:43], s66 offen offset:3072 sc1
  buffer_load_dwordx4 v[112:115], v9, s[40:43], s66 offen offset:0 sc1
  buffer_load_dwordx4 v[116:119], v9, s[40:43], s66 offen offset:1024 sc1
  buffer_load_dwordx4 v[136:139], v9, s[40:43], s66 offen offset:2048 sc1
  s_waitcnt vmcnt(13)
  v_max3_u32 v160, v81, v83, v85
  v_max_u32 v160, v160, v87
  v_cmp_eq_u32 vcc, -1, v160
  s_nop 4
  s_cbranch_vccnz KF_R20
  s_branch KF_R20_B
KF_R21:
  s_add_u32 s72, s72, 1
  s_cmp_gt_u32 s72, 200000
  s_cbranch_scc1 KF_R21_B
  s_waitcnt lgkmcnt(0)
  buffer_load_dwordx4 v[88:91], v6, s[40:43], s66 offen offset:2048 sc1
  buffer_load_dwordx4 v[92:95], v6, s[40:43], s66 offen offset:3072 sc1
  buffer_load_dwordx4 v[120:123], v7, s[40:43], s66 offen offset:0 sc1
  buffer_load_dwordx4 v[124:127], v7, s[40:43], s66 offen offset:1024 sc1
  buffer_load_dwordx4 v[128:131], v7, s[40:43], s66 offen offset:2048 sc1
  buffer_load_dwordx4 v[132:135], v7, s[40:43], s66 offen offset:3072 sc1
  buffer_load_dwordx4 v[96:99], v8, s[40:43], s66 offen offset:0 sc1
  buffer_load_dwordx4 v[100:103], v8, s[40:43], s66 offen offset:1024 sc1
  buffer_load_dwordx4 v[104:107], v8, s[40:43], s66 offen offset:2048 sc1
  buffer_load_dwordx4 v[108:111], v8, s[40:43], s66 offen offset:3072 sc1
  buffer_load_dwordx4 v[112:115], v9, s[40:43], s66 offen offset:0 sc1
  buffer_load_dwordx4 v[116:119], v9, s[40:43], s66 offen offset:1024 sc1
  buffer_load_dwordx4 v[136:139], v9, s[40:43], s66 offen offset:2048 sc1
  buffer_load_dwordx4 v[140:143], v9, s[40:43], s66 offen offset:3072 sc1
  s_waitcnt vmcnt(12)
  v_max3_u32 v160, v89, v91, v93
  v_max_u32 v160, v160, v95
  v_cmp_eq_u32 vcc, -1, v160
  s_nop 4
  s_cbranch_vccnz KF_R21
  s_branch KF_R21_B
KF_R22:
  s_add_u32 s72, s72, 1
  s_cmp_gt_u32 s72, 200000
  s_cbranch_scc1 KF_R22_B
  s_waitcnt lgkmcnt(0)
  buffer_load_dwordx4 v[120:123], v7, s[40:43], s66 offen offset:0 sc1
  buffer_load_dwordx4 v[124:127], v7, s[40:43], s66 offen offset:1024 sc1
  buffer_load_dwordx4 v[128:131], v7, s[40:43], s66 offen offset:2048 sc1
  buffer_load_dwordx4 v[132:135], v7, s[40:43], s66 offen offset:3072 sc1
  buffer_load_dwordx4 v[96:99], v8, s[40:43], s66 offen offset:0 sc1
  buffer_load_dwordx4 v[100:103], v8, s[40:43], s66 offen offset:1024 sc1
  buffer_load_dwordx4 v[104:107], v8, s[40:43], s66 offen offset:2048 sc1
  buffer_load_dwordx4 v[108:111], v8, s[40:43], s66 offen offset:3072 sc1
  buffer_load_dwordx4 v[112:115], v9, s[40:43], s66 offen offset:0 sc1
  buffer_load_dwordx4 v[116:119], v9, s[40:43], s66 offen offset:1024 sc1
  buffer_load_dwordx4 v[136:139], v9, s[40:43], s66 offen offset:2048 sc1
  buffer_load_dwordx4 v[140:143], v9, s[40:43], s66 offen offset:3072 sc1
  s_waitcnt vmcnt(10)
  v_max3_u32 v160, v121, v123, v125
  v_max_u32 v160, v160, v127
  v_cmp_eq_u32 vcc, -1, v160
  s_nop 4
  s_cbranch_vccnz KF_R22
  s_branch KF_R22_B
KF_R23:
  s_add_u32 s72, s72, 1
  s_cmp_gt_u32 s72, 200000
  s_cbranch_scc1 KF_R23_B
  s_waitcnt lgkmcnt(0)
  buffer_load_dwordx4 v[128:131], v7, s[40:43], s66 offen offset:2048 sc1
  buffer_load_dwordx4 v[132:135], v7, s[40:43], s66 offen offset:3072 sc1
  buffer_load_dwordx4 v[96:99], v8, s[40:43], s66 offen offset:0 sc1
  buffer_load_dwordx4 v[100:103], v8, s[40:43], s66 offen offset:1024 sc1
  buffer_load_dwordx4 v[104:107], v8, s[40:43], s66 offen offset:2048 sc1
  buffer_load_dwordx4 v[108:111], v8, s[40:43], s66 offen offset:3072 sc1
  buffer_load_dwordx4 v[112:115], v9, s[40:43], s66 offen offset:0 sc1
  buffer_load_dwordx4 v[116:119], v9, s[40:43], s66 offen offset:1024 sc1
  buffer_load_dwordx4 v[136:139], v9, s[40:43], s66 offen offset:2048 sc1
  buffer_load_dwordx4 v[140:143], v9, s[40:43], s66 offen offset:3072 sc1
  s_waitcnt vmcnt(8)
  v_max3_u32 v160, v129, v131, v133
  v_max_u32 v160, v160, v135
  v_cmp_eq_u32 vcc, -1, v160
  s_nop 4
  s_cbranch_vccnz KF_R23
  s_branch KF_R23_B
KF_R24:
  s_add_u32 s72, s72, 1
  s_cmp_gt_u32 s72, 200000
  s_cbranch_scc1 KF_R24_B
  s_waitcnt lgkmcnt(0)
  buffer_load_dwordx4 v[96:99], v8, s[40:43], s66 offen offset:0 sc1
  buffer_load_dwordx4 v[100:103], v8, s[40:43], s66 offen offset:1024 sc1
  buffer_load_dwordx4 v[104:107], v8, s[40:43], s66 offen offset:2048 sc1
  buffer_load_dwordx4 v[108:111], v8, s[40:43], s66 offen offset:3072 sc1
  buffer_load_dwordx4 v[112:115], v9, s[40:43], s66 offen offset:0 sc1
  buffer_load_dwordx4 v[116:119], v9, s[40:43], s66 offen offset:1024 sc1
  buffer_load_dwordx4 v[136:139], v9, s[40:43], s66 offen offset:2048 sc1
  buffer_load_dwordx4 v[140:143], v9, s[40:43], s66 offen offset:3072 sc1
  s_waitcnt vmcnt(6)
  v_max3_u32 v160, v97, v99, v101
  v_max_u32 v160, v160, v103
  v_cmp_eq_u32 vcc, -1, v160
  s_nop 4
  s_cbranch_vccnz KF_R24
  s_branch KF_R24_B
KF_R25:
  s_add_u32 s72, s72, 1
  s_cmp_gt_u32 s72, 200000
  s_cbranch_scc1 KF_R25_B
  s_waitcnt lgkmcnt(0)
  buffer_load_dwordx4 v[104:107], v8, s[40:43], s66 offen offset:2048 sc1
  buffer_load_dwordx4 v[108:111], v8, s[40:43], s66 offen offset:3072 sc1
  buffer_load_dwordx4 v[112:115], v9, s[40:43], s66 offen offset:0 sc1
  buffer_load_dwordx4 v[116:119], v9, s[40:43], s66 offen offset:1024 sc1
  buffer_load_dwordx4 v[136:139], v9, s[40:43], s66 offen offset:2048 sc1
  buffer_load_dwordx4 v[140:143], v9, s[40:43], s66 offen offset:3072 sc1
  s_waitcnt vmcnt(4)
  v_max3_u32 v160, v105, v107, v109
  v_max_u32 v160, v160, v111
  v_cmp_eq_u32 vcc, -1, v160
  s_nop 4
  s_cbranch_vccnz KF_R25
  s_branch KF_R25_B
KF_R26:
  s_add_u32 s72, s72, 1
  s_cmp_gt_u32 s72, 200000
  s_cbranch_scc1 KF_R26_B
  s_waitcnt lgkmcnt(0)
  buffer_load_dwordx4 v[112:115], v9, s[40:43], s66 offen offset:0 sc1
  buffer_load_dwordx4 v[116:119], v9, s[40:43], s66 offen offset:1024 sc1
  buffer_load_dwordx4 v[136:139], v9, s[40:43], s66 offen offset:2048 sc1
  buffer_load_dwordx4 v[140:143], v9, s[40:43], s66 offen offset:3072 sc1
  s_waitcnt vmcnt(2)
  v_max3_u32 v160, v113, v115, v117
  v_max_u32 v160, v160, v119
  v_cmp_eq_u32 vcc, -1, v160
  s_nop 4
  s_cbranch_vccnz KF_R26
  s_branch KF_R26_B
KF_R27:
  s_add_u32 s72, s72, 1
  s_cmp_gt_u32 s72, 200000
  s_cbranch_scc1 KF_R27_B
  s_waitcnt lgkmcnt(0)
  buffer_load_dwordx4 v[136:139], v9, s[40:43], s66 offen offset:2048 sc1
  buffer_load_dwordx4 v[140:143], v9, s[40:43], s66 offen offset:3072 sc1
  s_waitcnt vmcnt(0)
  v_max3_u32 v160, v137, v139, v141
  v_max_u32 v160, v160, v143
  v_cmp_eq_u32 vcc, -1, v160
  s_nop 4
  s_cbranch_vccnz KF_R27
  s_branch KF_R27_B
KF_SLOW0:
  s_waitcnt lgkmcnt(0)
  s_barrier
  s_mov_b32 s69, 0
  s_mov_b32 s70, 0
  s_mov_b32 s62, 16
  v_cndmask_b32 v22, v22, 0, s[52:53]
  v_mov_b32 v152, 0xfe967699
  v_cndmask_b32 v30, v30, 0, s[52:53]
  v_mov_b32 v153, 0xfe967699
  v_mov_b32 v48, 0
  v_mov_b32 v49, 0
  v_mov_b32 v50, 0
  v_mov_b32 v51, 0
  v_mov_b32 v52, 0
  v_mov_b32 v53, 0
  v_mov_b32 v54, 0
  v_mov_b32 v55, 0
  v_mov_b32 v56, 0
  v_mov_b32 v57, 0
  v_mov_b32 v58, 0
  v_mov_b32 v59, 0
  v_mov_b32 v60, 0
  v_mov_b32 v61, 0
  v_mov_b32 v62, 0
  v_mov_b32 v63, 0
  v_mov_b32 v64, 0
  v_mov_b32 v65, 0
  v_mov_b32 v66, 0
  v_mov_b32 v67, 0
  v_mov_b32 v68, 0
  v_mov_b32 v69, 0
  v_mov_b32 v70, 0
  v_mov_b32 v71, 0
  v_mov_b32 v72, 0
  v_mov_b32 v73, 0
  v_mov_b32 v74, 0
  v_mov_b32 v75, 0
  v_mov_b32 v76, 0
  v_mov_b32 v77, 0
  v_mov_b32 v78, 0
  v_mov_b32 v79, 0
KF_FB_LOOP0:
  buffer_load_dwordx4 v[192:195], v175, s[40:43], s70 offen offset:0 sc1
  buffer_load_dwordx4 v[196:199], v175, s[40:43], s70 offen offset:1024 sc1
  buffer_load_dwordx4 v[200:203], v175, s[40:43], s70 offen offset:2048 sc1
  buffer_load_dwordx4 v[204:207], v175, s[40:43], s70 offen offset:3072 sc1
  s_add_u32 s70, s70, 4096
  s_waitcnt vmcnt(0)
  v_mfma_f32_32x32x16_bf16 v[208:223], v[192:195], v[16:19], 0
  v_mfma_f32_32x32x16_bf16 v[208:223], v[196:199], v[20:23], v[208:223]
  s_nop 11
  v_max3_f32 v156, v208, v209, v210
  v_max3_f32 v156, v156, v211, v212
  v_max3_f32 v156, v156, v213, v214
  v_max3_f32 v156, v156, v215, v216
  v_max3_f32 v156, v156, v217, v218
  v_max3_f32 v156, v156, v219, v220
  v_max3_f32 v156, v156, v221, v222
  v_max_f32 v156, v156, v223
  v_mov_b32 v157, v156
  s_nop 1
  v_permlane32_swap_b32 v156, v157
  v_max_f32 v156, v156, v157
  v_max_f32 v156, v156, v152
  v_sub_f32 v157, v152, v156
  v_exp_f32 v157, v157
  v_mov_b32 v152, v156
  v_sub_f32 v208, v208, v156
  v_sub_f32 v209, v209, v156
  v_sub_f32 v210, v210, v156
  v_sub_f32 v211, v211, v156
  v_sub_f32 v212, v212, v156
  v_sub_f32 v213, v213, v156
  v_sub_f32 v214, v214, v156
  v_sub_f32 v215, v215, v156
  v_sub_f32 v216, v216, v156
  v_sub_f32 v217, v217, v156
  v_sub_f32 v218, v218, v156
  v_sub_f32 v219, v219, v156
  v_sub_f32 v220, v220, v156
  v_sub_f32 v221, v221, v156
  v_sub_f32 v222, v222, v156
  v_sub_f32 v223, v223, v156
  v_exp_f32 v208, v208
  v_exp_f32 v209, v209
  v_exp_f32 v210, v210
  v_exp_f32 v211, v211
  v_exp_f32 v212, v212
  v_exp_f32 v213, v213
  v_exp_f32 v214, v214
  v_exp_f32 v215, v215
  v_exp_f32 v216, v216
  v_exp_f32 v217, v217
  v_exp_f32 v218, v218
  v_exp_f32 v219, v219
  v_exp_f32 v220, v220
  v_exp_f32 v221, v221
  v_exp_f32 v222, v222
  v_exp_f32 v223, v223
  v_mul_f32 v48, v48, v157
  v_mul_f32 v49, v49, v157
  v_mul_f32 v50, v50, v157
  v_mul_f32 v51, v51, v157
  v_mul_f32 v52, v52, v157
  v_mul_f32 v53, v53, v157
  v_mul_f32 v54, v54, v157
  v_mul_f32 v55, v55, v157
  v_mul_f32 v56, v56, v157
  v_mul_f32 v57, v57, v157
  v_mul_f32 v58, v58, v157
  v_mul_f32 v59, v59, v157
  v_mul_f32 v60, v60, v157
  v_mul_f32 v61, v61, v157
  v_mul_f32 v62, v62, v157
  v_mul_f32 v63, v63, v157
  v_cvt_pk_bf16_f32 v224, v208, v209
  v_cvt_pk_bf16_f32 v225, v210, v211
  v_cvt_pk_bf16_f32 v226, v212, v213
  v_cvt_pk_bf16_f32 v227, v214, v215
  v_cvt_pk_bf16_f32 v228, v216, v217
  v_cvt_pk_bf16_f32 v229, v218, v219
  v_cvt_pk_bf16_f32 v230, v220, v221
  v_cvt_pk_bf16_f32 v231, v222, v223
  v_mfma_f32_32x32x16_bf16 v[48:63], v[200:203], v[224:227], v[48:63]
  s_nop 0
  v_mfma_f32_32x32x16_bf16 v[48:63], v[204:207], v[228:231], v[48:63]
  v_mfma_f32_32x32x16_bf16 v[208:223], v[192:195], v[24:27], 0
  v_mfma_f32_32x32x16_bf16 v[208:223], v[196:199], v[28:31], v[208:223]
  s_nop 11
  v_max3_f32 v156, v208, v209, v210
  v_max3_f32 v156, v156, v211, v212
  v_max3_f32 v156, v156, v213, v214
  v_max3_f32 v156, v156, v215, v216
  v_max3_f32 v156, v156, v217, v218
  v_max3_f32 v156, v156, v219, v220
  v_max3_f32 v156, v156, v221, v222
  v_max_f32 v156, v156, v223
  v_mov_b32 v157, v156
  s_nop 1
  v_permlane32_swap_b32 v156, v157
  v_max_f32 v156, v156, v157
  v_max_f32 v156, v156, v153
  v_sub_f32 v157, v153, v156
  v_exp_f32 v157, v157
  v_mov_b32 v153, v156
  v_sub_f32 v208, v208, v156
  v_sub_f32 v209, v209, v156
  v_sub_f32 v210, v210, v156
  v_sub_f32 v211, v211, v156
  v_sub_f32 v212, v212, v156
  v_sub_f32 v213, v213, v156
  v_sub_f32 v214, v214, v156
  v_sub_f32 v215, v215, v156
  v_sub_f32 v216, v216, v156
  v_sub_f32 v217, v217, v156
  v_sub_f32 v218, v218, v156
  v_sub_f32 v219, v219, v156
  v_sub_f32 v220, v220, v156
  v_sub_f32 v221, v221, v156
  v_sub_f32 v222, v222, v156
  v_sub_f32 v223, v223, v156
  v_exp_f32 v208, v208
  v_exp_f32 v209, v209
  v_exp_f32 v210, v210
  v_exp_f32 v211, v211
  v_exp_f32 v212, v212
  v_exp_f32 v213, v213
  v_exp_f32 v214, v214
  v_exp_f32 v215, v215
  v_exp_f32 v216, v216
  v_exp_f32 v217, v217
  v_exp_f32 v218, v218
  v_exp_f32 v219, v219
  v_exp_f32 v220, v220
  v_exp_f32 v221, v221
  v_exp_f32 v222, v222
  v_exp_f32 v223, v223
  v_mul_f32 v64, v64, v157
  v_mul_f32 v65, v65, v157
  v_mul_f32 v66, v66, v157
  v_mul_f32 v67, v67, v157
  v_mul_f32 v68, v68, v157
  v_mul_f32 v69, v69, v157
  v_mul_f32 v70, v70, v157
  v_mul_f32 v71, v71, v157
  v_mul_f32 v72, v72, v157
  v_mul_f32 v73, v73, v157
  v_mul_f32 v74, v74, v157
  v_mul_f32 v75, v75, v157
  v_mul_f32 v76, v76, v157
  v_mul_f32 v77, v77, v157
  v_mul_f32 v78, v78, v157
  v_mul_f32 v79, v79, v157
  v_cvt_pk_bf16_f32 v224, v208, v209
  v_cvt_pk_bf16_f32 v225, v210, v211
  v_cvt_pk_bf16_f32 v226, v212, v213
  v_cvt_pk_bf16_f32 v227, v214, v215
  v_cvt_pk_bf16_f32 v228, v216, v217
  v_cvt_pk_bf16_f32 v229, v218, v219
  v_cvt_pk_bf16_f32 v230, v220, v221
  v_cvt_pk_bf16_f32 v231, v222, v223
  v_mfma_f32_32x32x16_bf16 v[64:79], v[200:203], v[224:227], v[64:79]
  s_nop 0
  v_mfma_f32_32x32x16_bf16 v[64:79], v[204:207], v[228:231], v[64:79]
  s_sub_u32 s62, s62, 1
  s_cmp_lg_u32 s62, 0
  s_cbranch_scc1 KF_FB_LOOP0
  v_xor_b32 v152, 0x80000000, v152
  v_xor_b32 v153, 0x80000000, v153
  ds_write_b128 v11, v[48:51] offset:0
  ds_write_b128 v11, v[52:55] offset:4096
  ds_write_b128 v11, v[56:59] offset:8192
  ds_write_b128 v11, v[60:63] offset:12288
  ds_write_b32 v15, v152 offset:0
  s_nop 1
  ds_write_b128 v11, v[64:67] offset:16384
  ds_write_b128 v11, v[68:71] offset:20480
  ds_write_b128 v11, v[72:75] offset:24576
  ds_write_b128 v11, v[76:79] offset:28672
  ds_write_b32 v15, v153 offset:1024
  s_waitcnt lgkmcnt(0)
  s_barrier
  ds_read_b32 v244, v248 offset:0
  ds_read_b32 v245, v248 offset:256
  ds_read_b32 v246, v248 offset:512
  ds_read_b32 v247, v248 offset:768
  ds_read_b32 v240, v14 offset:0
  ds_read_b32 v241, v14 offset:1024
  ds_read_b32 v242, v14 offset:2048
  ds_read_b32 v243, v14 offset:3072
  s_waitcnt lgkmcnt(0)
  ds_read_b128 v[208:211], v12 offset:0
  ds_read_b128 v[212:215], v12 offset:4096
  ds_read_b128 v[216:219], v12 offset:1024
  ds_read_b128 v[220:223], v12 offset:5120
  ds_read_b128 v[224:227], v12 offset:2048
  ds_read_b128 v[228:231], v12 offset:6144
  ds_read_b128 v[232:235], v12 offset:3072
  ds_read_b128 v[236:239], v12 offset:7168
  v_min3_f32 v160, v244, v245, v246
  v_min_f32 v160, v160, v247
  v_sub_f32 v156, v160, v244
  v_sub_f32 v157, v160, v245
  v_sub_f32 v158, v160, v246
  v_sub_f32 v159, v160, v247
  v_exp_f32 v156, v156
  v_exp_f32 v157, v157
  v_exp_f32 v158, v158
  v_exp_f32 v159, v159
  v_mul_f32 v160, v156, v240
  v_fmac_f32 v160, v157, v241
  v_fmac_f32 v160, v158, v242
  v_fmac_f32 v160, v159, v243
  v_rcp_f32 v160, v160
  s_nop 0
  v_mul_f32 v156, v156, v160
  v_mul_f32 v157, v157, v160
  v_mul_f32 v158, v158, v160
  v_mul_f32 v159, v159, v160
  s_waitcnt lgkmcnt(0)
  v_pk_mul_f32 v[208:209], v[208:209], v[156:157] op_sel_hi:[1,0]
  v_pk_mul_f32 v[210:211], v[210:211], v[156:157] op_sel_hi:[1,0]
  v_pk_mul_f32 v[212:213], v[212:213], v[156:157] op_sel_hi:[1,0]
  v_pk_mul_f32 v[214:215], v[214:215], v[156:157] op_sel_hi:[1,0]
  v_pk_fma_f32 v[208:209], v[216:217], v[156:157], v[208:209] op_sel:[0,1,0] op_sel_hi:[1,1,1]
  v_pk_fma_f32 v[210:211], v[218:219], v[156:157], v[210:211] op_sel:[0,1,0] op_sel_hi:[1,1,1]
  v_pk_fma_f32 v[212:213], v[220:221], v[156:157], v[212:213] op_sel:[0,1,0] op_sel_hi:[1,1,1]
  v_pk_fma_f32 v[214:215], v[222:223], v[156:157], v[214:215] op_sel:[0,1,0] op_sel_hi:[1,1,1]
  v_pk_fma_f32 v[208:209], v[224:225], v[158:159], v[208:209] op_sel:[0,0,0] op_sel_hi:[1,0,1]
  v_pk_fma_f32 v[210:211], v[226:227], v[158:159], v[210:211] op_sel:[0,0,0] op_sel_hi:[1,0,1]
  v_pk_fma_f32 v[212:213], v[228:229], v[158:159], v[212:213] op_sel:[0,0,0] op_sel_hi:[1,0,1]
  v_pk_fma_f32 v[214:215], v[230:231], v[158:159], v[214:215] op_sel:[0,0,0] op_sel_hi:[1,0,1]
  v_pk_fma_f32 v[208:209], v[232:233], v[158:159], v[208:209] op_sel:[0,1,0] op_sel_hi:[1,1,1]
  v_pk_fma_f32 v[210:211], v[234:235], v[158:159], v[210:211] op_sel:[0,1,0] op_sel_hi:[1,1,1]
  v_pk_fma_f32 v[212:213], v[236:237], v[158:159], v[212:213] op_sel:[0,1,0] op_sel_hi:[1,1,1]
  v_pk_fma_f32 v[214:215], v[238:239], v[158:159], v[214:215] op_sel:[0,1,0] op_sel_hi:[1,1,1]
  v_cvt_pk_bf16_f32 v240, v208, v209
  v_cvt_pk_bf16_f32 v241, v210, v211
  v_cvt_pk_bf16_f32 v242, v212, v213
  v_cvt_pk_bf16_f32 v243, v214, v215
  v_cndmask_b32 v242, v242, 0, s[14:15]
  v_min_u32 v241, -2, v241
  v_min_u32 v243, -2, v243
  s_branch KF_SLOW0_B
KF_SLOW1:
  s_waitcnt lgkmcnt(0)
  s_barrier
  s_mov_b32 s69, 0
  s_mov_b32 s70, 0
  s_mov_b32 s62, 16
  v_cndmask_b32 v38, v38, 0, s[52:53]
  v_mov_b32 v154, 0xfe967699
  v_cndmask_b32 v46, v46, 0, s[52:53]
  v_mov_b32 v155, 0xfe967699
  v_mov_b32 v80, 0
  v_mov_b32 v81, 0
  v_mov_b32 v82, 0
  v_mov_b32 v83, 0
  v_mov_b32 v84, 0
  v_mov_b32 v85, 0
  v_mov_b32 v86, 0
  v_mov_b32 v87, 0
  v_mov_b32 v88, 0
  v_mov_b32 v89, 0
  v_mov_b32 v90, 0
  v_mov_b32 v91, 0
  v_mov_b32 v92, 0
  v_mov_b32 v93, 0
  v_mov_b32 v94, 0
  v_mov_b32 v95, 0
  v_mov_b32 v96, 0
  v_mov_b32 v97, 0
  v_mov_b32 v98, 0
  v_mov_b32 v99, 0
  v_mov_b32 v100, 0
  v_mov_b32 v101, 0
  v_mov_b32 v102, 0
  v_mov_b32 v103, 0
  v_mov_b32 v104, 0
  v_mov_b32 v105, 0
  v_mov_b32 v106, 0
  v_mov_b32 v107, 0
  v_mov_b32 v108, 0
  v_mov_b32 v109, 0
  v_mov_b32 v110, 0
  v_mov_b32 v111, 0
KF_FB_LOOP1:
  buffer_load_dwordx4 v[192:195], v175, s[40:43], s70 offen offset:0 sc1
  buffer_load_dwordx4 v[196:199], v175, s[40:43], s70 offen offset:1024 sc1
  buffer_load_dwordx4 v[200:203], v175, s[40:43], s70 offen offset:2048 sc1
  buffer_load_dwordx4 v[204:207], v175, s[40:43], s70 offen offset:3072 sc1
  s_add_u32 s70, s70, 4096
  s_waitcnt vmcnt(0)
  v_mfma_f32_32x32x16_bf16 v[208:223], v[192:195], v[32:35], 0
  v_mfma_f32_32x32x16_bf16 v[208:223], v[196:199], v[36:39], v[208:223]
  s_nop 11
  v_max3_f32 v156, v208, v209, v210
  v_max3_f32 v156, v156, v211, v212
  v_max3_f32 v156, v156, v213, v214
  v_max3_f32 v156, v156, v215, v216
  v_max3_f32 v156, v156, v217, v218
  v_max3_f32 v156, v156, v219, v220
  v_max3_f32 v156, v156, v221, v222
  v_max_f32 v156, v156, v223
  v_mov_b32 v157, v156
  s_nop 1
  v_permlane32_swap_b32 v156, v157
  v_max_f32 v156, v156, v157
  v_max_f32 v156, v156, v154
  v_sub_f32 v157, v154, v156
  v_exp_f32 v157, v157
  v_mov_b32 v154, v156
  v_sub_f32 v208, v208, v156
  v_sub_f32 v209, v209, v156
  v_sub_f32 v210, v210, v156
  v_sub_f32 v211, v211, v156
  v_sub_f32 v212, v212, v156
  v_sub_f32 v213, v213, v156
  v_sub_f32 v214, v214, v156
  v_sub_f32 v215, v215, v156
  v_sub_f32 v216, v216, v156
  v_sub_f32 v217, v217, v156
  v_sub_f32 v218, v218, v156
  v_sub_f32 v219, v219, v156
  v_sub_f32 v220, v220, v156
  v_sub_f32 v221, v221, v156
  v_sub_f32 v222, v222, v156
  v_sub_f32 v223, v223, v156
  v_exp_f32 v208, v208
  v_exp_f32 v209, v209
  v_exp_f32 v210, v210
  v_exp_f32 v211, v211
  v_exp_f32 v212, v212
  v_exp_f32 v213, v213
  v_exp_f32 v214, v214
  v_exp_f32 v215, v215
  v_exp_f32 v216, v216
  v_exp_f32 v217, v217
  v_exp_f32 v218, v218
  v_exp_f32 v219, v219
  v_exp_f32 v220, v220
  v_exp_f32 v221, v221
  v_exp_f32 v222, v222
  v_exp_f32 v223, v223
  v_mul_f32 v80, v80, v157
  v_mul_f32 v81, v81, v157
  v_mul_f32 v82, v82, v157
  v_mul_f32 v83, v83, v157
  v_mul_f32 v84, v84, v157
  v_mul_f32 v85, v85, v157
  v_mul_f32 v86, v86, v157
  v_mul_f32 v87, v87, v157
  v_mul_f32 v88, v88, v157
  v_mul_f32 v89, v89, v157
  v_mul_f32 v90, v90, v157
  v_mul_f32 v91, v91, v157
  v_mul_f32 v92, v92, v157
  v_mul_f32 v93, v93, v157
  v_mul_f32 v94, v94, v157
  v_mul_f32 v95, v95, v157
  v_cvt_pk_bf16_f32 v224, v208, v209
  v_cvt_pk_bf16_f32 v225, v210, v211
  v_cvt_pk_bf16_f32 v226, v212, v213
  v_cvt_pk_bf16_f32 v227, v214, v215
  v_cvt_pk_bf16_f32 v228, v216, v217
  v_cvt_pk_bf16_f32 v229, v218, v219
  v_cvt_pk_bf16_f32 v230, v220, v221
  v_cvt_pk_bf16_f32 v231, v222, v223
  v_mfma_f32_32x32x16_bf16 v[80:95], v[200:203], v[224:227], v[80:95]
  s_nop 0
  v_mfma_f32_32x32x16_bf16 v[80:95], v[204:207], v[228:231], v[80:95]
  v_mfma_f32_32x32x16_bf16 v[208:223], v[192:195], v[40:43], 0
  v_mfma_f32_32x32x16_bf16 v[208:223], v[196:199], v[44:47], v[208:223]
  s_nop 11
  v_max3_f32 v156, v208, v209, v210
  v_max3_f32 v156, v156, v211, v212
  v_max3_f32 v156, v156, v213, v214
  v_max3_f32 v156, v156, v215, v216
  v_max3_f32 v156, v156, v217, v218
  v_max3_f32 v156, v156, v219, v220
  v_max3_f32 v156, v156, v221, v222
  v_max_f32 v156, v156, v223
  v_mov_b32 v157, v156
  s_nop 1
  v_permlane32_swap_b32 v156, v157
  v_max_f32 v156, v156, v157
  v_max_f32 v156, v156, v155
  v_sub_f32 v157, v155, v156
  v_exp_f32 v157, v157
  v_mov_b32 v155, v156
  v_sub_f32 v208, v208, v156
  v_sub_f32 v209, v209, v156
  v_sub_f32 v210, v210, v156
  v_sub_f32 v211, v211, v156
  v_sub_f32 v212, v212, v156
  v_sub_f32 v213, v213, v156
  v_sub_f32 v214, v214, v156
  v_sub_f32 v215, v215, v156
  v_sub_f32 v216, v216, v156
  v_sub_f32 v217, v217, v156
  v_sub_f32 v218, v218, v156
  v_sub_f32 v219, v219, v156
  v_sub_f32 v220, v220, v156
  v_sub_f32 v221, v221, v156
  v_sub_f32 v222, v222, v156
  v_sub_f32 v223, v223, v156
  v_exp_f32 v208, v208
  v_exp_f32 v209, v209
  v_exp_f32 v210, v210
  v_exp_f32 v211, v211
  v_exp_f32 v212, v212
  v_exp_f32 v213, v213
  v_exp_f32 v214, v214
  v_exp_f32 v215, v215
  v_exp_f32 v216, v216
  v_exp_f32 v217, v217
  v_exp_f32 v218, v218
  v_exp_f32 v219, v219
  v_exp_f32 v220, v220
  v_exp_f32 v221, v221
  v_exp_f32 v222, v222
  v_exp_f32 v223, v223
  v_mul_f32 v96, v96, v157
  v_mul_f32 v97, v97, v157
  v_mul_f32 v98, v98, v157
  v_mul_f32 v99, v99, v157
  v_mul_f32 v100, v100, v157
  v_mul_f32 v101, v101, v157
  v_mul_f32 v102, v102, v157
  v_mul_f32 v103, v103, v157
  v_mul_f32 v104, v104, v157
  v_mul_f32 v105, v105, v157
  v_mul_f32 v106, v106, v157
  v_mul_f32 v107, v107, v157
  v_mul_f32 v108, v108, v157
  v_mul_f32 v109, v109, v157
  v_mul_f32 v110, v110, v157
  v_mul_f32 v111, v111, v157
  v_cvt_pk_bf16_f32 v224, v208, v209
  v_cvt_pk_bf16_f32 v225, v210, v211
  v_cvt_pk_bf16_f32 v226, v212, v213
  v_cvt_pk_bf16_f32 v227, v214, v215
  v_cvt_pk_bf16_f32 v228, v216, v217
  v_cvt_pk_bf16_f32 v229, v218, v219
  v_cvt_pk_bf16_f32 v230, v220, v221
  v_cvt_pk_bf16_f32 v231, v222, v223
  v_mfma_f32_32x32x16_bf16 v[96:111], v[200:203], v[224:227], v[96:111]
  s_nop 0
  v_mfma_f32_32x32x16_bf16 v[96:111], v[204:207], v[228:231], v[96:111]
  s_sub_u32 s62, s62, 1
  s_cmp_lg_u32 s62, 0
  s_cbranch_scc1 KF_FB_LOOP1
  v_xor_b32 v154, 0x80000000, v154
  v_xor_b32 v155, 0x80000000, v155
  ds_write_b128 v11, v[80:83] offset:32768
  ds_write_b128 v11, v[84:87] offset:36864
  ds_write_b128 v11, v[88:91] offset:40960
  ds_write_b128 v11, v[92:95] offset:45056
  ds_write_b32 v15, v154 offset:2048
  s_nop 1
  ds_write_b128 v11, v[96:99] offset:49152
  ds_write_b128 v11, v[100:103] offset:53248
  ds_write_b128 v11, v[104:107] offset:57344
  ds_write_b128 v11, v[108:111] offset:61440
  ds_write_b32 v15, v155 offset:3072
  s_waitcnt lgkmcnt(0)
  s_barrier
  ds_read_b32 v244, v248 offset:2048
  ds_read_b32 v245, v248 offset:2304
  ds_read_b32 v246, v248 offset:2560
  ds_read_b32 v247, v248 offset:2816
  ds_read_b32 v240, v14 offset:32768
  ds_read_b32 v241, v14 offset:33792
  ds_read_b32 v242, v14 offset:34816
  ds_read_b32 v243, v14 offset:35840
  s_waitcnt lgkmcnt(0)
  ds_read_b128 v[208:211], v12 offset:32768
  ds_read_b128 v[212:215], v12 offset:36864
  ds_read_b128 v[216:219], v12 offset:33792
  ds_read_b128 v[220:223], v12 offset:37888
  ds_read_b128 v[224:227], v12 offset:34816
  ds_read_b128 v[228:231], v12 offset:38912
  ds_read_b128 v[232:235], v12 offset:35840
  ds_read_b128 v[236:239], v12 offset:39936
  v_min3_f32 v160, v244, v245, v246
  v_min_f32 v160, v160, v247
  v_sub_f32 v156, v160, v244
  v_sub_f32 v157, v160, v245
  v_sub_f32 v158, v160, v246
  v_sub_f32 v159, v160, v247
  v_exp_f32 v156, v156
  v_exp_f32 v157, v157
  v_exp_f32 v158, v158
  v_exp_f32 v159, v159
  v_mul_f32 v160, v156, v240
  v_fmac_f32 v160, v157, v241
  v_fmac_f32 v160, v158, v242
  v_fmac_f32 v160, v159, v243
  v_rcp_f32 v160, v160
  s_nop 0
  v_mul_f32 v156, v156, v160
  v_mul_f32 v157, v157, v160
  v_mul_f32 v158, v158, v160
  v_mul_f32 v159, v159, v160
  s_waitcnt lgkmcnt(0)
  v_pk_mul_f32 v[208:209], v[208:209], v[156:157] op_sel_hi:[1,0]
  v_pk_mul_f32 v[210:211], v[210:211], v[156:157] op_sel_hi:[1,0]
  v_pk_mul_f32 v[212:213], v[212:213], v[156:157] op_sel_hi:[1,0]
  v_pk_mul_f32 v[214:215], v[214:215], v[156:157] op_sel_hi:[1,0]
  v_pk_fma_f32 v[208:209], v[216:217], v[156:157], v[208:209] op_sel:[0,1,0] op_sel_hi:[1,1,1]
  v_pk_fma_f32 v[210:211], v[218:219], v[156:157], v[210:211] op_sel:[0,1,0] op_sel_hi:[1,1,1]
  v_pk_fma_f32 v[212:213], v[220:221], v[156:157], v[212:213] op_sel:[0,1,0] op_sel_hi:[1,1,1]
  v_pk_fma_f32 v[214:215], v[222:223], v[156:157], v[214:215] op_sel:[0,1,0] op_sel_hi:[1,1,1]
  v_pk_fma_f32 v[208:209], v[224:225], v[158:159], v[208:209] op_sel:[0,0,0] op_sel_hi:[1,0,1]
  v_pk_fma_f32 v[210:211], v[226:227], v[158:159], v[210:211] op_sel:[0,0,0] op_sel_hi:[1,0,1]
  v_pk_fma_f32 v[212:213], v[228:229], v[158:159], v[212:213] op_sel:[0,0,0] op_sel_hi:[1,0,1]
  v_pk_fma_f32 v[214:215], v[230:231], v[158:159], v[214:215] op_sel:[0,0,0] op_sel_hi:[1,0,1]
  v_pk_fma_f32 v[208:209], v[232:233], v[158:159], v[208:209] op_sel:[0,1,0] op_sel_hi:[1,1,1]
  v_pk_fma_f32 v[210:211], v[234:235], v[158:159], v[210:211] op_sel:[0,1,0] op_sel_hi:[1,1,1]
  v_pk_fma_f32 v[212:213], v[236:237], v[158:159], v[212:213] op_sel:[0,1,0] op_sel_hi:[1,1,1]
  v_pk_fma_f32 v[214:215], v[238:239], v[158:159], v[214:215] op_sel:[0,1,0] op_sel_hi:[1,1,1]
  v_cvt_pk_bf16_f32 v240, v208, v209
  v_cvt_pk_bf16_f32 v241, v210, v211
  v_cvt_pk_bf16_f32 v242, v212, v213
  v_cvt_pk_bf16_f32 v243, v214, v215
  v_cndmask_b32 v242, v242, 0, s[14:15]
  v_min_u32 v241, -2, v241
  v_min_u32 v243, -2, v243
  s_branch KF_SLOW1_B
KF_CODE_END:
.section .rodata,"a"
.p2align 6
.amdhsa_kernel sequential_preLN__mha_block__dense_activation_silu__prompt_kernel
  .amdhsa_next_free_vgpr 512
  .amdhsa_next_free_sgpr 102
  .amdhsa_accum_offset 256
  .amdhsa_group_segment_fixed_size 0
  .amdhsa_kernarg_size 72
  .amdhsa_user_sgpr_count 2
  .amdhsa_user_sgpr_kernarg_segment_ptr 1
  .amdhsa_system_sgpr_workgroup_id_x 1
.end_amdhsa_kernel
```
